```python
import torch

def _softmax(x, axis=-1):
    return torch.softmax(x, dim=axis)
def _gelu(x):
    return torch.nn.functional.gelu(x, approximate="tanh")
def _silu(x):
    return torch.nn.functional.silu(x)
def _sigmoid(x):
    return torch.sigmoid(x)
def _layernorm(x, axis=-1, eps=1e-5):
    m = x.mean(dim=axis, keepdim=True)
    v = x.var(dim=axis, keepdim=True, unbiased=False)
    return (x - m) / torch.sqrt(v + eps)
def _scatter_add(tgt, idx, src, axis=0):
    return tgt.clone().index_add_(axis, idx, src)
def _segment_sum(src, seg, n):
    out = torch.zeros((n,) + src.shape[1:], dtype=src.dtype)
    return out.index_add_(0, seg, src)
def _pad(x, pw):
    flat = tuple(v for pair in reversed(pw) for v in pair)
    return torch.nn.functional.pad(x, flat)

kernel_name = 'parallel_sum__ssm_conv_h3__glu_gated_glu__prompt'

def setup_inputs():

    _w = (lambda a: (lambda t: t.to(torch.bfloat16) if t.is_floating_point() else t)(torch.as_tensor(a)))
    def _A_setup():
        B, S, D = 1, 2048, 1024
        ks = 4
        return {
            "q": _w((lambda *s: torch.randn(*s, dtype=torch.bfloat16) * 0.05)(B, S, D)),
            "k": _w((lambda *s: torch.randn(*s, dtype=torch.bfloat16) * 0.8)(B, S, D)),
            "v": _w((lambda *s: torch.randn(*s, dtype=torch.bfloat16) * 0.8)(B, S, D)),
            "shift_k": _w((lambda *s: torch.randn(*s, dtype=torch.bfloat16) * 0.8)(D, ks) * 0.5),
            "ssm_k": _w((lambda *s: torch.randn(*s, dtype=torch.bfloat16) * 0.8)(D, S) * (1.0 / S ** 0.5)),
            "ssm_D": _w((lambda *s: torch.randn(*s, dtype=torch.bfloat16) * 0.8)(D)),
        }
    _A_in = _A_setup()

    def _B_setup():
        B, S, D, F = 1, 2048, 1024, 3584
        return {
            "x": _w((lambda *s: torch.randn(*s, dtype=torch.bfloat16) * 0.05)(B, S, D)),
            "w_gate": _w((lambda *s: torch.randn(*s, dtype=torch.bfloat16) * 0.05)(D, F)),
            "w_up": _w((lambda *s: torch.randn(*s, dtype=torch.bfloat16) * 0.05)(D, F)),
            "w_down": _w((lambda *s: torch.randn(*s, dtype=torch.bfloat16) * 0.05)(F, D)),
        }
    _B_in = _B_setup()

    return {
        "A_q": _A_in["q"],
        "A_k": _A_in["k"],
        "A_v": _A_in["v"],
        "A_shift_k": _A_in["shift_k"],
        "A_ssm_k": _A_in["ssm_k"],
        "A_ssm_D": _A_in["ssm_D"],
        "B_x": _B_in["x"],
        "B_w_gate": _B_in["w_gate"],
        "B_w_up": _B_in["w_up"],
        "B_w_down": _B_in["w_down"],
    }

def reference(A_q, A_k, A_v, A_shift_k, A_ssm_k, A_ssm_D, B_x, B_w_gate, B_w_up, B_w_down):
    def _A_ref(q, k, v, shift_k, ssm_k, ssm_D):
        B, S, D = q.shape
        ks = shift_k.shape[-1]
        k_pad = _pad(k, ((0, 0), (ks - 1, 0), (0, 0)))
        k_shift = torch.zeros_like(k)
        for t in range(ks):
            k_shift = k_shift + k_pad[:, t:t + S, :] * shift_k[:, ks - 1 - t][None, None, :]
        kv = k_shift * v
        L = 2 * S
        kv_pad = _pad(kv, ((0, 0), (0, S), (0, 0)))
        kf_pad = _pad(ssm_k, ((0, 0), (0, S)))
        kv_f = (lambda x, axes=(-2,-1): torch.fft.rfft2(x.float(), dim=axes))(kv_pad[:, None, :, :], axes=(1, 2))
        kf_f = (lambda x, axes=(-2,-1): torch.fft.rfft2(x.float(), dim=axes))(kf_pad[:, None, :], axes=(1, 2))
        kf_f = (lambda x, *d: x.permute(*d))(kf_f, 1, 2, 0)
        y_f = kv_f * kf_f[None, :, :, :]
        y = (lambda x, s, axes=(-2,-1): torch.fft.irfft2(x, s=s, dim=axes).to(torch.bfloat16))(y_f, (1, L), axes=(1, 2))[:, 0, :S, :]
        y = y + kv * ssm_D[None, None, :]
        return q * y

    def _B_ref(x, w_gate, w_up, w_down):
        g = torch.einsum("bsd,df->bsf", x, w_gate)
        u = torch.einsum("bsd,df->bsf", x, w_up)
        h = _sigmoid(g) * u
        return torch.einsum("bsf,fd->bsd", h, w_down)

    x = A_q
    xn = _layernorm(x, axis=-1)
    return x + _A_ref(xn, A_k, A_v, A_shift_k, A_ssm_k, A_ssm_D) + _B_ref(xn, B_w_gate, B_w_up, B_w_down)
```

```asm
; @launch grid=(256,1,1) block=(256,1,1) lds=156928
.amdgcn_target "amdgcn-amd-amdhsa--gfx950"
.text
.globl parallel_sum__ssm_conv_h3__glu_gated_glu__prompt_kernel
.p2align 8
.type parallel_sum__ssm_conv_h3__glu_gated_glu__prompt_kernel,@function
parallel_sum__ssm_conv_h3__glu_gated_glu__prompt_kernel:
    s_cmp_ge_u32 s2, 256
    s_cbranch_scc1 k_end
    s_load_dwordx16 s[4:19], s[0:1], 0
    s_load_dwordx8 s[20:27], s[0:1], 64
    s_load_dwordx2 s[28:29], s[0:1], 96
    v_and_b32 v1, 63, v0
    v_lshrrev_b32 v2, 6, v0
    v_and_b32 v13, 7, v1
    v_readfirstlane_b32 s3, v2
    v_lshrrev_b32 v14, 3, v1
    s_lshr_b32 s67, s2, 3
    s_lshl_b32 s67, s67, 2
    s_add_u32 s67, s67, s3
    s_cmp_ge_u32 s67, CODE_WAVES
    s_cbranch_scc1 no_cpf
    s_getpc_b64 s[68:69]
cpf_pc:
    s_sub_u32 s68, s68, cpf_pc-parallel_sum__ssm_conv_h3__glu_gated_glu__prompt_kernel
    s_subb_u32 s69, s69, 0
    s_lshl_b32 s67, s67, 13
    v_lshlrev_b32 v68, 7, v1
    v_add_u32 v68, s67, v68
    v_min_u32 v68, CODE_LAST, v68
    global_load_dword v193, v68, s[68:69]
no_cpf:
    v_lshlrev_b32 v63, 11, v13
    v_lshl_add_u32 v15, v2, 9, v63
    v_lshl_add_u32 v15, v14, 4, v15
    v_lshrrev_b32 v64, 5, v1
    v_and_b32 v65, 3, v14
    s_lshl_b32 s66, s2, 14
    s_waitcnt lgkmcnt(0)
    s_mov_b32 s36, s4
    s_mov_b32 s37, s5
    s_mov_b32 s38, 4194304
    s_mov_b32 s39, 0x20000
    buffer_load_ushort v62, v63, s[36:39], s66 offen
    buffer_load_dwordx4 v[16:19], v15, s[36:39], s66 offen offset:0
    buffer_load_dwordx4 v[20:23], v15, s[36:39], s66 offen offset:128
    buffer_load_dwordx4 v[24:27], v15, s[36:39], s66 offen offset:256
    buffer_load_dwordx4 v[28:31], v15, s[36:39], s66 offen offset:384
    s_cmp_ge_u32 s3, 2
    s_cselect_b32 s56, s20, s18
    s_cselect_b32 s57, s21, s19
    s_mov_b32 s58, 7340032
    s_mov_b32 s59, 0x20000
    s_mov_b32 s18, 0xffff0000
    s_memrealtime s[20:21]
    s_mov_b32 s52, s26
    s_mov_b32 s53, s27
    s_mov_b32 s54, 256
    s_mov_b32 s55, 0x20000
    s_add_u32 s60, s28, 29360128
    s_addc_u32 s61, s29, 0
    s_mov_b32 s62, 16384
    s_mov_b32 s63, 0x20000
    s_or_b32 s66, s2, s3
    s_cmp_lg_u32 s66, 0
    s_cbranch_scc1 no_epoch
    s_memrealtime s[66:67]
    s_waitcnt lgkmcnt(0)
    s_or_b32 s67, s67, 0x40000000
    s_mov_b64 exec, 1
    v_mov_b32 v68, s66
    v_mov_b32 v69, s67
    v_mov_b32 v70, 0
    buffer_store_dwordx2 v[68:69], v70, s[52:55], 0 offen sc1
    s_mov_b64 exec, -1
no_epoch:
    s_and_b32 s66, s2, 7
    s_lshr_b32 s67, s2, 3
    s_lshl_b32 s31, s66, 2
    s_and_b32 s68, s67, 3
    s_add_u32 s31, s31, s68
    s_lshr_b32 s30, s2, 5
    s_lshr_b32 s32, s66, 1
    s_lshl_b32 s32, s32, 2
    s_lshr_b32 s68, s67, 3
    s_add_u32 s32, s32, s68
    s_and_b32 s33, s66, 1
    s_lshl_b32 s33, s33, 3
    s_and_b32 s68, s67, 7
    s_add_u32 s33, s33, s68
    s_lshl_b32 s34, s2, 2
    s_add_u32 s34, s34, s3
    v_lshl_add_u32 v66, v2, 3, v64
    v_lshlrev_b32 v66, 12, v66
    v_lshl_add_u32 v66, v65, 8, v66
    v_lshl_add_u32 v66, v13, 4, v66
    s_add_u32 s36, s28, 0
    s_addc_u32 s37, s29, 0
    s_mov_b32 s38, 4194304
    s_mov_b32 s39, 0x20000
    s_add_u32 s40, s28, 28311552
    s_addc_u32 s41, s29, 0
    s_mov_b32 s42, 16384
    s_mov_b32 s43, 0x20000
    v_lshlrev_b32 v64, 5, v13
    v_lshl_add_u32 v65, v2, 3, v64
    v_add_u32 v64, 114688, v64
    v_add_u32 v65, 114688, v65
    s_lshr_b32 s68, s2, 3
    s_lshl_b32 s68, s68, 17
    s_lshr_b32 s67, s2, 1
    s_and_b32 s67, s67, 3
    s_lshl_b32 s67, s67, 10
    s_add_u32 s68, s68, s67
    s_and_b32 s67, s2, 1
    s_lshl_b32 s67, s67, 7
    s_add_u32 s68, s68, s67
    v_lshlrev_b32 v67, 3, v0
    v_cmp_gt_u32 vcc, 8, v0
    v_mov_b32 v69, 0x100000
    s_lshl_b32 s69, s2, 6
    v_cndmask_b32 v67, v69, v67, vcc
    v_add_u32 v68, 0, v1
    v_mul_u32_u24 v69, 4682, v68
    v_lshrrev_b32 v69, 16, v69
    v_mul_u32_u24 v70, 14, v69
    v_sub_u32 v70, v68, v70
    v_and_b32 v68, 3, v69
    v_bfe_u32 v71, v69, 2, 2
    v_lshl_add_u32 v68, v71, 3, v68
    v_lshrrev_b32 v69, 4, v69
    v_lshl_add_u32 v69, v69, 2, v68
    v_mul_u32_u24 v69, 7168, v69
    v_lshl_add_u32 v3, v70, 4, v69
    v_add_u32 v68, 64, v1
    v_mul_u32_u24 v69, 4682, v68
    v_lshrrev_b32 v69, 16, v69
    v_mul_u32_u24 v70, 14, v69
    v_sub_u32 v70, v68, v70
    v_and_b32 v68, 3, v69
    v_bfe_u32 v71, v69, 2, 2
    v_lshl_add_u32 v68, v71, 3, v68
    v_lshrrev_b32 v69, 4, v69
    v_lshl_add_u32 v69, v69, 2, v68
    v_mul_u32_u24 v69, 7168, v69
    v_lshl_add_u32 v4, v70, 4, v69
    v_subrev_u32 v4, 1024, v4
    v_add_u32 v68, 128, v1
    v_mul_u32_u24 v69, 4682, v68
    v_lshrrev_b32 v69, 16, v69
    v_mul_u32_u24 v70, 14, v69
    v_sub_u32 v70, v68, v70
    v_and_b32 v68, 3, v69
    v_bfe_u32 v71, v69, 2, 2
    v_lshl_add_u32 v68, v71, 3, v68
    v_lshrrev_b32 v69, 4, v69
    v_lshl_add_u32 v69, v69, 2, v68
    v_mul_u32_u24 v69, 7168, v69
    v_lshl_add_u32 v5, v70, 4, v69
    v_subrev_u32 v5, 2048, v5
    v_add_u32 v68, 192, v1
    v_mul_u32_u24 v69, 4682, v68
    v_lshrrev_b32 v69, 16, v69
    v_mul_u32_u24 v70, 14, v69
    v_sub_u32 v70, v68, v70
    v_and_b32 v68, 3, v69
    v_bfe_u32 v71, v69, 2, 2
    v_lshl_add_u32 v68, v71, 3, v68
    v_lshrrev_b32 v69, 4, v69
    v_lshl_add_u32 v69, v69, 2, v68
    v_mul_u32_u24 v69, 7168, v69
    v_lshl_add_u32 v6, v70, 4, v69
    v_subrev_u32 v6, 3072, v6
    v_add_u32 v68, 256, v1
    v_mul_u32_u24 v69, 4682, v68
    v_lshrrev_b32 v69, 16, v69
    v_mul_u32_u24 v70, 14, v69
    v_sub_u32 v70, v68, v70
    v_and_b32 v68, 3, v69
    v_bfe_u32 v71, v69, 2, 2
    v_lshl_add_u32 v68, v71, 3, v68
    v_lshrrev_b32 v69, 4, v69
    v_lshl_add_u32 v69, v69, 2, v68
    v_mul_u32_u24 v69, 7168, v69
    v_lshl_add_u32 v7, v70, 4, v69
    v_add_u32 v68, 320, v1
    v_mul_u32_u24 v69, 4682, v68
    v_lshrrev_b32 v69, 16, v69
    v_mul_u32_u24 v70, 14, v69
    v_sub_u32 v70, v68, v70
    v_and_b32 v68, 3, v69
    v_bfe_u32 v71, v69, 2, 2
    v_lshl_add_u32 v68, v71, 3, v68
    v_lshrrev_b32 v69, 4, v69
    v_lshl_add_u32 v69, v69, 2, v68
    v_mul_u32_u24 v69, 7168, v69
    v_lshl_add_u32 v8, v70, 4, v69
    v_subrev_u32 v8, 1024, v8
    v_add_u32 v68, 384, v1
    v_mul_u32_u24 v69, 4682, v68
    v_lshrrev_b32 v69, 16, v69
    v_mul_u32_u24 v70, 14, v69
    v_sub_u32 v70, v68, v70
    v_and_b32 v68, 3, v69
    v_bfe_u32 v71, v69, 2, 2
    v_lshl_add_u32 v68, v71, 3, v68
    v_lshrrev_b32 v69, 4, v69
    v_lshl_add_u32 v69, v69, 2, v68
    v_mul_u32_u24 v69, 7168, v69
    v_lshl_add_u32 v9, v70, 4, v69
    v_subrev_u32 v9, 2048, v9
    v_lshlrev_b32 v10, 4, v1
    v_lshrrev_b32 v68, 2, v1
    v_mul_u32_u24 v68, 224, v68
    v_and_b32 v69, 3, v1
    v_lshl_add_u32 v11, v69, 3, v68
    s_and_b32 s66, s3, 1
    s_mul_i32 s72, s66, 229376
    s_mul_i32 s67, s31, 224
    s_add_u32 s72, s72, s67
    s_mul_i32 s74, s66, 7168
    s_lshr_b32 s66, s3, 1
    s_mul_i32 s66, s66, 14336
    s_add_u32 s74, s74, s66
    s_mov_b32 s73, s74
    s_add_u32 s75, s74, 143360
    s_mov_b32 s76, 0
    s_mov_b32 s77, 0
    s_mov_b32 s17, 0
    s_mov_b32 s16, s68
    s_mov_b32 s79, s69
    s_waitcnt vmcnt(0)
    v_mov_b32 v70, 0
    buffer_load_dwordx2 v[184:185], v70, s[52:55], 0 offen sc1
    s_lshr_b32 s66, s2, 3
    s_lshl_b32 s66, s66, 1
    s_and_b32 s67, s3, 1
    s_add_u32 s66, s66, s67
    s_mul_i32 s66, s66, 28
    s_add_u32 s66, s66, 0
    v_min_u32 v72, 27, v1
    v_add_u32 v72, s66, v72
    v_mul_u32_u24 v73, 9363, v72
    v_lshrrev_b32 v73, 16, v73
    v_mul_u32_u24 v74, 7, v73
    v_sub_u32 v74, v72, v74
    v_mul_u32_u24 v73, 7168, v73
    v_lshl_add_u32 v73, v74, 7, v73
    s_and_b32 s66, s2, 7
    s_mul_i32 s66, s66, 896
    buffer_load_dword v192, v73, s[56:59], s66 offen
ln_body:
    v_lshlrev_b32 v186, 16, v62
    v_lshlrev_b32 v187, 16, v62
    v_lshlrev_b32 v96, 16, v16
    v_and_b32 v97, s18, v16
    v_lshlrev_b32 v98, 16, v17
    v_and_b32 v99, s18, v17
    v_lshlrev_b32 v100, 16, v18
    v_and_b32 v101, s18, v18
    v_lshlrev_b32 v102, 16, v19
    v_and_b32 v103, s18, v19
    v_lshlrev_b32 v104, 16, v20
    v_and_b32 v105, s18, v20
    v_lshlrev_b32 v106, 16, v21
    v_and_b32 v107, s18, v21
    v_lshlrev_b32 v108, 16, v22
    v_and_b32 v109, s18, v22
    v_lshlrev_b32 v110, 16, v23
    v_and_b32 v111, s18, v23
    v_lshlrev_b32 v112, 16, v24
    v_and_b32 v113, s18, v24
    v_lshlrev_b32 v114, 16, v25
    v_and_b32 v115, s18, v25
    v_lshlrev_b32 v116, 16, v26
    v_and_b32 v117, s18, v26
    v_lshlrev_b32 v118, 16, v27
    v_and_b32 v119, s18, v27
    v_lshlrev_b32 v120, 16, v28
    v_and_b32 v121, s18, v28
    v_lshlrev_b32 v122, 16, v29
    v_and_b32 v123, s18, v29
    v_lshlrev_b32 v124, 16, v30
    v_and_b32 v125, s18, v30
    v_lshlrev_b32 v126, 16, v31
    v_and_b32 v127, s18, v31
    v_pk_add_f32 v[188:189], v[96:97], v[186:187] neg_lo:[0,1] neg_hi:[0,1]
    v_mov_b32 v68, v188
    v_mov_b32 v69, v189
    v_pk_mul_f32 v[70:71], v[188:189], v[188:189]
    v_pk_add_f32 v[190:191], v[98:99], v[186:187] neg_lo:[0,1] neg_hi:[0,1]
    v_pk_add_f32 v[68:69], v[68:69], v[190:191]
    v_fmac_f32 v70, v190, v190
    v_fmac_f32 v71, v191, v191
    v_pk_add_f32 v[188:189], v[100:101], v[186:187] neg_lo:[0,1] neg_hi:[0,1]
    v_pk_add_f32 v[68:69], v[68:69], v[188:189]
    v_fmac_f32 v70, v188, v188
    v_fmac_f32 v71, v189, v189
    v_pk_add_f32 v[190:191], v[102:103], v[186:187] neg_lo:[0,1] neg_hi:[0,1]
    v_pk_add_f32 v[68:69], v[68:69], v[190:191]
    v_fmac_f32 v70, v190, v190
    v_fmac_f32 v71, v191, v191
    v_pk_add_f32 v[188:189], v[104:105], v[186:187] neg_lo:[0,1] neg_hi:[0,1]
    v_pk_add_f32 v[68:69], v[68:69], v[188:189]
    v_fmac_f32 v70, v188, v188
    v_fmac_f32 v71, v189, v189
    v_pk_add_f32 v[190:191], v[106:107], v[186:187] neg_lo:[0,1] neg_hi:[0,1]
    v_pk_add_f32 v[68:69], v[68:69], v[190:191]
    v_fmac_f32 v70, v190, v190
    v_fmac_f32 v71, v191, v191
    v_pk_add_f32 v[188:189], v[108:109], v[186:187] neg_lo:[0,1] neg_hi:[0,1]
    v_pk_add_f32 v[68:69], v[68:69], v[188:189]
    v_fmac_f32 v70, v188, v188
    v_fmac_f32 v71, v189, v189
    v_pk_add_f32 v[190:191], v[110:111], v[186:187] neg_lo:[0,1] neg_hi:[0,1]
    v_pk_add_f32 v[68:69], v[68:69], v[190:191]
    v_fmac_f32 v70, v190, v190
    v_fmac_f32 v71, v191, v191
    v_pk_add_f32 v[188:189], v[112:113], v[186:187] neg_lo:[0,1] neg_hi:[0,1]
    v_pk_add_f32 v[68:69], v[68:69], v[188:189]
    v_fmac_f32 v70, v188, v188
    v_fmac_f32 v71, v189, v189
    v_pk_add_f32 v[190:191], v[114:115], v[186:187] neg_lo:[0,1] neg_hi:[0,1]
    v_pk_add_f32 v[68:69], v[68:69], v[190:191]
    v_fmac_f32 v70, v190, v190
    v_fmac_f32 v71, v191, v191
    v_pk_add_f32 v[188:189], v[116:117], v[186:187] neg_lo:[0,1] neg_hi:[0,1]
    v_pk_add_f32 v[68:69], v[68:69], v[188:189]
    v_fmac_f32 v70, v188, v188
    v_fmac_f32 v71, v189, v189
    v_pk_add_f32 v[190:191], v[118:119], v[186:187] neg_lo:[0,1] neg_hi:[0,1]
    v_pk_add_f32 v[68:69], v[68:69], v[190:191]
    v_fmac_f32 v70, v190, v190
    v_fmac_f32 v71, v191, v191
    v_pk_add_f32 v[188:189], v[120:121], v[186:187] neg_lo:[0,1] neg_hi:[0,1]
    v_pk_add_f32 v[68:69], v[68:69], v[188:189]
    v_fmac_f32 v70, v188, v188
    v_fmac_f32 v71, v189, v189
    v_pk_add_f32 v[190:191], v[122:123], v[186:187] neg_lo:[0,1] neg_hi:[0,1]
    v_pk_add_f32 v[68:69], v[68:69], v[190:191]
    v_fmac_f32 v70, v190, v190
    v_fmac_f32 v71, v191, v191
    v_pk_add_f32 v[188:189], v[124:125], v[186:187] neg_lo:[0,1] neg_hi:[0,1]
    v_pk_add_f32 v[68:69], v[68:69], v[188:189]
    v_fmac_f32 v70, v188, v188
    v_fmac_f32 v71, v189, v189
    v_pk_add_f32 v[190:191], v[126:127], v[186:187] neg_lo:[0,1] neg_hi:[0,1]
    v_pk_add_f32 v[68:69], v[68:69], v[190:191]
    v_fmac_f32 v70, v190, v190
    v_fmac_f32 v71, v191, v191
    v_add_f32 v68, v68, v69
    v_add_f32 v69, v70, v71
    s_nop 0
    v_add_f32_dpp v68, v68, v68 row_ror:8 row_mask:0xf bank_mask:0xf
    v_add_f32_dpp v69, v69, v69 row_ror:8 row_mask:0xf bank_mask:0xf
    v_mov_b32 v70, v68
    v_mov_b32 v71, v69
    s_nop 0
    v_permlane16_swap_b32 v68, v70
    v_permlane16_swap_b32 v69, v71
    v_pk_add_f32 v[68:69], v[68:69], v[70:71]
    v_mov_b32 v70, v68
    v_mov_b32 v71, v69
    s_nop 0
    v_permlane32_swap_b32 v68, v70
    v_permlane32_swap_b32 v69, v71
    v_pk_add_f32 v[68:69], v[68:69], v[70:71]
    ds_write_b64 v65, v[68:69]
    s_waitcnt lgkmcnt(0)
    s_barrier
    ds_read_b128 v[68:71], v64
    ds_read_b128 v[188:191], v64 offset:16
    s_waitcnt lgkmcnt(0)
    v_pk_add_f32 v[68:69], v[68:69], v[70:71]
    v_pk_add_f32 v[188:189], v[188:189], v[190:191]
    v_pk_add_f32 v[68:69], v[68:69], v[188:189]
    v_mul_f32 v68, 0x3a800000, v68
    v_mul_f32 v69, 0x3a800000, v69
    v_fma_f32 v188, -v68, v68, v69
    v_max_f32 v188, 0, v188
    v_add_f32 v186, v186, v68
    v_cvt_pk_bf16_f32 v188, v188, v188
    v_and_b32 v188, s18, v188
    v_cvt_pk_bf16_f32 v186, v186, v186
    v_and_b32 v186, s18, v186
    v_add_f32 v188, 0x3727c5ac, v188
    v_cvt_pk_bf16_f32 v188, v188, v188
    v_and_b32 v188, s18, v188
    v_sqrt_f32 v188, v188
    v_mov_b32 v187, v186
    v_cvt_pk_bf16_f32 v188, v188, v188
    v_and_b32 v188, s18, v188
    v_rcp_f32 v188, v188
    s_nop 0
    v_mov_b32 v189, v188
    v_pk_add_f32 v[96:97], v[96:97], v[186:187] neg_lo:[0,1] neg_hi:[0,1]
    v_pk_add_f32 v[98:99], v[98:99], v[186:187] neg_lo:[0,1] neg_hi:[0,1]
    v_pk_add_f32 v[100:101], v[100:101], v[186:187] neg_lo:[0,1] neg_hi:[0,1]
    v_pk_add_f32 v[102:103], v[102:103], v[186:187] neg_lo:[0,1] neg_hi:[0,1]
    v_cvt_pk_bf16_f32 v96, v96, v97
    v_and_b32 v97, s18, v96
    v_lshlrev_b32 v96, 16, v96
    v_cvt_pk_bf16_f32 v98, v98, v99
    v_and_b32 v99, s18, v98
    v_lshlrev_b32 v98, 16, v98
    v_cvt_pk_bf16_f32 v100, v100, v101
    v_and_b32 v101, s18, v100
    v_lshlrev_b32 v100, 16, v100
    v_cvt_pk_bf16_f32 v102, v102, v103
    v_and_b32 v103, s18, v102
    v_lshlrev_b32 v102, 16, v102
    v_pk_mul_f32 v[96:97], v[96:97], v[188:189]
    v_pk_mul_f32 v[98:99], v[98:99], v[188:189]
    v_pk_mul_f32 v[100:101], v[100:101], v[188:189]
    v_pk_mul_f32 v[102:103], v[102:103], v[188:189]
    v_cvt_pk_bf16_f32 v72, v96, v97
    v_cvt_pk_bf16_f32 v73, v98, v99
    v_cvt_pk_bf16_f32 v74, v100, v101
    v_cvt_pk_bf16_f32 v75, v102, v103
    buffer_store_dwordx4 v[72:75], v66, s[36:39], s16 offen sc1
    s_add_u32 s16, s16, 8192
    v_pk_add_f32 v[104:105], v[104:105], v[186:187] neg_lo:[0,1] neg_hi:[0,1]
    v_pk_add_f32 v[106:107], v[106:107], v[186:187] neg_lo:[0,1] neg_hi:[0,1]
    v_pk_add_f32 v[108:109], v[108:109], v[186:187] neg_lo:[0,1] neg_hi:[0,1]
    v_pk_add_f32 v[110:111], v[110:111], v[186:187] neg_lo:[0,1] neg_hi:[0,1]
    v_cvt_pk_bf16_f32 v104, v104, v105
    v_and_b32 v105, s18, v104
    v_lshlrev_b32 v104, 16, v104
    v_cvt_pk_bf16_f32 v106, v106, v107
    v_and_b32 v107, s18, v106
    v_lshlrev_b32 v106, 16, v106
    v_cvt_pk_bf16_f32 v108, v108, v109
    v_and_b32 v109, s18, v108
    v_lshlrev_b32 v108, 16, v108
    v_cvt_pk_bf16_f32 v110, v110, v111
    v_and_b32 v111, s18, v110
    v_lshlrev_b32 v110, 16, v110
    v_pk_mul_f32 v[104:105], v[104:105], v[188:189]
    v_pk_mul_f32 v[106:107], v[106:107], v[188:189]
    v_pk_mul_f32 v[108:109], v[108:109], v[188:189]
    v_pk_mul_f32 v[110:111], v[110:111], v[188:189]
    v_cvt_pk_bf16_f32 v76, v104, v105
    v_cvt_pk_bf16_f32 v77, v106, v107
    v_cvt_pk_bf16_f32 v78, v108, v109
    v_cvt_pk_bf16_f32 v79, v110, v111
    buffer_store_dwordx4 v[76:79], v66, s[36:39], s16 offen sc1
    s_add_u32 s16, s16, 8192
    v_pk_add_f32 v[112:113], v[112:113], v[186:187] neg_lo:[0,1] neg_hi:[0,1]
    v_pk_add_f32 v[114:115], v[114:115], v[186:187] neg_lo:[0,1] neg_hi:[0,1]
    v_pk_add_f32 v[116:117], v[116:117], v[186:187] neg_lo:[0,1] neg_hi:[0,1]
    v_pk_add_f32 v[118:119], v[118:119], v[186:187] neg_lo:[0,1] neg_hi:[0,1]
    v_cvt_pk_bf16_f32 v112, v112, v113
    v_and_b32 v113, s18, v112
    v_lshlrev_b32 v112, 16, v112
    v_cvt_pk_bf16_f32 v114, v114, v115
    v_and_b32 v115, s18, v114
    v_lshlrev_b32 v114, 16, v114
    v_cvt_pk_bf16_f32 v116, v116, v117
    v_and_b32 v117, s18, v116
    v_lshlrev_b32 v116, 16, v116
    v_cvt_pk_bf16_f32 v118, v118, v119
    v_and_b32 v119, s18, v118
    v_lshlrev_b32 v118, 16, v118
    v_pk_mul_f32 v[112:113], v[112:113], v[188:189]
    v_pk_mul_f32 v[114:115], v[114:115], v[188:189]
    v_pk_mul_f32 v[116:117], v[116:117], v[188:189]
    v_pk_mul_f32 v[118:119], v[118:119], v[188:189]
    v_cvt_pk_bf16_f32 v80, v112, v113
    v_cvt_pk_bf16_f32 v81, v114, v115
    v_cvt_pk_bf16_f32 v82, v116, v117
    v_cvt_pk_bf16_f32 v83, v118, v119
    buffer_store_dwordx4 v[80:83], v66, s[36:39], s16 offen sc1
    s_add_u32 s16, s16, 8192
    v_pk_add_f32 v[120:121], v[120:121], v[186:187] neg_lo:[0,1] neg_hi:[0,1]
    v_pk_add_f32 v[122:123], v[122:123], v[186:187] neg_lo:[0,1] neg_hi:[0,1]
    v_pk_add_f32 v[124:125], v[124:125], v[186:187] neg_lo:[0,1] neg_hi:[0,1]
    v_pk_add_f32 v[126:127], v[126:127], v[186:187] neg_lo:[0,1] neg_hi:[0,1]
    v_cvt_pk_bf16_f32 v120, v120, v121
    v_and_b32 v121, s18, v120
    v_lshlrev_b32 v120, 16, v120
    v_cvt_pk_bf16_f32 v122, v122, v123
    v_and_b32 v123, s18, v122
    v_lshlrev_b32 v122, 16, v122
    v_cvt_pk_bf16_f32 v124, v124, v125
    v_and_b32 v125, s18, v124
    v_lshlrev_b32 v124, 16, v124
    v_cvt_pk_bf16_f32 v126, v126, v127
    v_and_b32 v127, s18, v126
    v_lshlrev_b32 v126, 16, v126
    v_pk_mul_f32 v[120:121], v[120:121], v[188:189]
    v_pk_mul_f32 v[122:123], v[122:123], v[188:189]
    v_pk_mul_f32 v[124:125], v[124:125], v[188:189]
    v_pk_mul_f32 v[126:127], v[126:127], v[188:189]
    v_cvt_pk_bf16_f32 v84, v120, v121
    v_cvt_pk_bf16_f32 v85, v122, v123
    v_cvt_pk_bf16_f32 v86, v124, v125
    v_cvt_pk_bf16_f32 v87, v126, v127
    buffer_store_dwordx4 v[84:87], v66, s[36:39], s16 offen sc1
    v_mov_b32 v187, v188
    buffer_store_dwordx2 v[186:187], v67, s[40:43], s79 offen sc1
    s_lshr_b32 s66, s2, 3
    s_lshl_b32 s66, s66, 1
    s_and_b32 s67, s3, 1
    s_add_u32 s66, s66, s67
    s_mul_i32 s66, s66, 7
    v_min_u32 v16, 6, v1
    v_add_u32 v16, s66, v16
    v_mul_u32_u24 v17, 9363, v16
    v_lshrrev_b32 v17, 16, v17
    v_mul_u32_u24 v18, 7, v17
    v_sub_u32 v18, v16, v18
    v_mul_u32_u24 v17, 7168, v17
    v_lshl_add_u32 v22, v18, 7, v17
    s_and_b32 s66, s2, 7
    s_mul_i32 s66, s66, 896
    s_add_u32 s66, s66, 1376256
    v_add_u32 v22, s66, v22
    v_mov_b32 v23, 458752
    v_mov_b32 v24, 7340028
    v_mov_b32 v20, s56
    v_mov_b32 v21, s57
    s_mul_i32 s66, s34, 7168
    s_sub_u32 s66, s66, 512
    s_mov_b32 exec_lo, 0x3c000
    s_mov_b32 exec_hi, 0x0
    v_subrev_u32 v16, 14, v1
    v_mul_u32_u24 v16, 128, v16
    v_add_u32 v22, s66, v16
    v_mov_b32 v23, 512
    v_mov_b32 v24, 7340028
    v_mov_b32 v20, s22
    v_mov_b32 v21, s23
    s_mov_b64 exec, -1
    s_lshr_b32 s66, s2, 4
    s_lshl_b32 s66, s66, 2
    s_add_u32 s66, s66, s3
    s_lshl_b32 s66, s66, 16
    s_and_b32 s67, s2, 15
    s_lshl_b32 s67, s67, 7
    s_add_u32 s66, s66, s67
    s_sub_u32 s66, s66, 18432
    s_sub_u32 s67, s66, 6144
    s_lshl_b32 s66, s34, 12
    s_sub_u32 s66, s66, 1152
    s_mov_b32 s40, s22
    s_mov_b32 s41, s23
    s_mov_b32 s42, 7340032
    s_mov_b32 s43, 0x20000
    s_add_u32 s44, s28, 30408704
    s_addc_u32 s45, s29, 0
    s_mov_b32 s46, 917504
    s_mov_b32 s47, 0x20000
    s_lshr_b32 s71, s22, 7
    s_sub_u32 s71, 3, s71
    s_and_b32 s71, s71, 7
    s_mul_i32 s66, s3, 56
    s_mul_i32 s67, s2, 14
    v_add_u32 v16, s66, v1
    v_lshrrev_b32 v17, 4, v16
    v_add_u32 v17, s67, v17
    v_bfe_u32 v18, v16, 3, 1
    v_and_b32 v16, 7, v16
    v_lshlrev_b32 v19, 11, v17
    v_lshl_add_u32 v19, v18, 10, v19
    v_lshl_add_u32 v19, v16, 4, v19
    v_lshlrev_b32 v25, 1, v17
    v_and_b32 v25, 4, v25
    v_xor_b32 v16, v16, v25
    v_mul_u32_u24 v18, 458752, v18
    v_lshl_add_u32 v18, v17, 7, v18
    v_lshl_add_u32 v30, v16, 4, v18
    v_cmp_gt_u32 vcc, 56, v1
    v_mov_b32 v25, 0x40000000
    s_lshl_b32 s70, s71, 7
    v_cndmask_b32 v19, v25, v19, vcc
    v_cndmask_b32 v30, v25, v30, vcc
    s_and_b32 s66, s33, 7
    s_cmp_eq_u32 s66, s71
    s_cselect_b32 s35, 1, 0
    s_add_u32 s66, s3, 1
    s_mul_i32 s35, s35, s66
    s_lshl_b32 s16, s32, 2
    s_add_u32 s16, s16, s3
    s_lshl_b32 s16, s16, 16
    s_lshl_b32 s66, s33, 7
    s_add_u32 s16, s16, s66
    v_and_b32 v28, 31, v1
    v_lshlrev_b32 v28, 11, v28
    v_lshrrev_b32 v29, 5, v1
    v_lshl_add_u32 v28, v29, 3, v28
    v_and_b32 v29, 15, v1
    v_bfe_u32 v15, v1, 4, 1
    v_add_u32 v29, v29, v15
    v_subrev_u32 v29, 16, v29
    v_lshlrev_b32 v29, 2, v29
    s_waitcnt vmcnt(0)
    s_mov_b32 s66, 0
ep_chk:
    v_readfirstlane_b32 s64, v184
    v_readfirstlane_b32 s65, v185
    s_nop 1
    s_sub_u32 s67, s20, s64
    s_cmp_eq_u32 s65, 0
    s_cselect_b32 s67, 0x7fffffff, s67
    s_cmp_lt_i32 s67, 200000
    s_cbranch_scc1 ep_ok
    s_add_u32 s66, s66, 1
    s_cmp_ge_u32 s66, 0x40000
    s_cbranch_scc1 ep_ok
    v_mov_b32 v70, 0
    buffer_load_dwordx2 v[184:185], v70, s[52:55], 0 offen sc1
    s_waitcnt vmcnt(0)
    s_branch ep_chk
ep_ok:
    s_barrier
    s_lshl_b32 s67, s2, 3
    s_cmp_lg_u32 s3, 0
    s_cbranch_scc1 nosig_1
    s_mov_b64 exec, 1
    v_mov_b32 v186, s64
    v_mov_b32 v187, s65
    v_mov_b32 v188, 0
    buffer_store_dwordx2 v[186:187], v188, s[60:63], s67 offen sc1
    s_mov_b64 exec, -1
nosig_1:
    s_mov_b32 m0, s73
    s_nop 0
    buffer_load_dwordx4 v3, s[56:59], s72 offen offset:0 lds
    buffer_load_dwordx4 v4, s[56:59], s72 offen offset:1024 lds
    buffer_load_dwordx4 v5, s[56:59], s72 offen offset:2048 lds
    buffer_load_dwordx4 v6, s[56:59], s72 offen offset:3072 lds
    s_add_u32 m0, s73, 4096
    s_nop 0
    buffer_load_dwordx4 v7, s[56:59], s72 offen offset:0 lds
    buffer_load_dwordx4 v8, s[56:59], s72 offen offset:1024 lds
    buffer_load_dwordx4 v9, s[56:59], s72 offen offset:2048 lds
    s_add_u32 s72, s72, 458752
    s_add_u32 s73, s73, 28672
    s_cmp_ge_u32 s73, s75
    s_cselect_b32 s73, s74, s73
    s_mov_b32 m0, s73
    s_nop 0
    buffer_load_dwordx4 v3, s[56:59], s72 offen offset:0 lds
    buffer_load_dwordx4 v4, s[56:59], s72 offen offset:1024 lds
    buffer_load_dwordx4 v5, s[56:59], s72 offen offset:2048 lds
    buffer_load_dwordx4 v6, s[56:59], s72 offen offset:3072 lds
    s_add_u32 m0, s73, 4096
    s_nop 0
    buffer_load_dwordx4 v7, s[56:59], s72 offen offset:0 lds
    buffer_load_dwordx4 v8, s[56:59], s72 offen offset:1024 lds
    buffer_load_dwordx4 v9, s[56:59], s72 offen offset:2048 lds
    s_add_u32 s72, s72, 458752
    s_add_u32 s73, s73, 28672
    s_cmp_ge_u32 s73, s75
    s_cselect_b32 s73, s74, s73
    s_mov_b32 m0, s73
    s_nop 0
    buffer_load_dwordx4 v3, s[56:59], s72 offen offset:0 lds
    buffer_load_dwordx4 v4, s[56:59], s72 offen offset:1024 lds
    buffer_load_dwordx4 v5, s[56:59], s72 offen offset:2048 lds
    buffer_load_dwordx4 v6, s[56:59], s72 offen offset:3072 lds
    s_add_u32 m0, s73, 4096
    s_nop 0
    buffer_load_dwordx4 v7, s[56:59], s72 offen offset:0 lds
    buffer_load_dwordx4 v8, s[56:59], s72 offen offset:1024 lds
    buffer_load_dwordx4 v9, s[56:59], s72 offen offset:2048 lds
    s_add_u32 s72, s72, 458752
    s_add_u32 s73, s73, 28672
    s_cmp_ge_u32 s73, s75
    s_cselect_b32 s73, s74, s73
    s_mov_b32 m0, s73
    s_nop 0
    buffer_load_dwordx4 v3, s[56:59], s72 offen offset:0 lds
    buffer_load_dwordx4 v4, s[56:59], s72 offen offset:1024 lds
    buffer_load_dwordx4 v5, s[56:59], s72 offen offset:2048 lds
    buffer_load_dwordx4 v6, s[56:59], s72 offen offset:3072 lds
    s_lshl_b32 s66, s30, 2
    s_add_u32 s66, s66, s3
    s_lshl_b32 s66, s66, 17
    s_add_u32 s66, s66, 0
    s_add_u32 s36, s28, s66
    s_addc_u32 s37, s29, 0
    s_mov_b32 s38, 131072
    s_mov_b32 s39, 0x20000
    v_lshlrev_b32 v13, 3, v1
    s_lshl_b32 s67, s30, 8
    s_lshl_b32 s66, s3, 6
    s_add_u32 s67, s67, s66
    v_mov_b32 v14, 0
    v_mov_b32 v15, 0
    s_mov_b32 exec_lo, 0xff
    s_mov_b32 exec_hi, 0
    s_mov_b32 s66, 0
poll_2:
    v_cmp_ne_u64 vcc, s[64:65], v[14:15]
    s_nop 1
    s_cmp_eq_u64 vcc, 0
    s_cbranch_scc1 polled_3
    s_add_u32 s66, s66, 1
    s_cmp_ge_u32 s66, 0x40000
    s_cbranch_scc1 polled_3
    buffer_load_dwordx2 v[14:15], v13, s[60:63], s67 offen sc1
    s_waitcnt vmcnt(0)
    s_branch poll_2
polled_3:
    s_mov_b64 exec, -1
    buffer_load_dwordx4 a[64:67], v10, s[36:39], s77 offen offset:0 sc1
    buffer_load_dwordx4 a[68:71], v10, s[36:39], s77 offen offset:1024 sc1
    buffer_load_dwordx4 a[72:75], v10, s[36:39], s77 offen offset:2048 sc1
    buffer_load_dwordx4 a[76:79], v10, s[36:39], s77 offen offset:3072 sc1
    s_add_u32 s77, s77, 4096
    buffer_load_dwordx4 a[80:83], v10, s[36:39], s77 offen offset:0 sc1
    buffer_load_dwordx4 a[84:87], v10, s[36:39], s77 offen offset:1024 sc1
    buffer_load_dwordx4 a[88:91], v10, s[36:39], s77 offen offset:2048 sc1
    buffer_load_dwordx4 a[92:95], v10, s[36:39], s77 offen offset:3072 sc1
    s_add_u32 s77, s77, 4096
    s_waitcnt vmcnt(26)
    s_barrier
    v_mov_b32 v12, v11
    ds_read_b64_tr_b16 a[0:1], v12 offset:0
    ds_read_b64_tr_b16 a[2:3], v12 offset:3584
    ds_read_b64_tr_b16 a[4:5], v12 offset:14336
    ds_read_b64_tr_b16 a[6:7], v12 offset:17920
    ds_read_b64_tr_b16 a[8:9], v12 offset:32
    ds_read_b64_tr_b16 a[10:11], v12 offset:3616
    ds_read_b64_tr_b16 a[12:13], v12 offset:14368
    ds_read_b64_tr_b16 a[14:15], v12 offset:17952
    ds_read_b64_tr_b16 a[16:17], v12 offset:64
    ds_read_b64_tr_b16 a[18:19], v12 offset:3648
    ds_read_b64_tr_b16 a[20:21], v12 offset:14400
    ds_read_b64_tr_b16 a[22:23], v12 offset:17984
    ds_read_b64_tr_b16 a[24:25], v12 offset:96
    ds_read_b64_tr_b16 a[26:27], v12 offset:3680
    ds_read_b64_tr_b16 a[28:29], v12 offset:14432
    ds_read_b64_tr_b16 a[30:31], v12 offset:18016
    ds_read_b64_tr_b16 a[32:33], v12 offset:128
    ds_read_b64_tr_b16 a[34:35], v12 offset:3712
    ds_read_b64_tr_b16 a[36:37], v12 offset:14464
    ds_read_b64_tr_b16 a[38:39], v12 offset:18048
    ds_read_b64_tr_b16 a[40:41], v12 offset:160
    ds_read_b64_tr_b16 a[42:43], v12 offset:3744
    ds_read_b64_tr_b16 a[44:45], v12 offset:14496
    ds_read_b64_tr_b16 a[46:47], v12 offset:18080
    ds_read_b64_tr_b16 a[48:49], v12 offset:192
    ds_read_b64_tr_b16 a[50:51], v12 offset:3776
    ds_read_b64_tr_b16 a[52:53], v12 offset:14528
    ds_read_b64_tr_b16 a[54:55], v12 offset:18112
    s_waitcnt lgkmcnt(0)
    s_waitcnt vmcnt(4) lgkmcnt(4)
    v_mfma_f32_16x16x32_bf16 v[32:35], a[0:3], a[64:67], 0
    s_add_u32 m0, s73, 4096
    s_nop 0
    buffer_load_dwordx4 v7, s[56:59], s72 offen offset:0 lds
    v_mfma_f32_16x16x32_bf16 v[88:91], a[0:3], a[68:71], 0
    buffer_load_dwordx4 a[96:99], v10, s[36:39], s77 offen offset:0 sc1
    v_mfma_f32_16x16x32_bf16 v[144:147], a[0:3], a[72:75], 0
    v_mfma_f32_16x16x32_bf16 v[200:203], a[0:3], a[76:79], 0
    ds_read_b64_tr_b16 a[0:1], v12 offset:7168
    v_mfma_f32_16x16x32_bf16 v[36:39], a[4:7], a[64:67], 0
    ds_read_b64_tr_b16 a[2:3], v12 offset:10752
    v_mfma_f32_16x16x32_bf16 v[92:95], a[4:7], a[68:71], 0
    buffer_load_dwordx4 v8, s[56:59], s72 offen offset:1024 lds
    v_mfma_f32_16x16x32_bf16 v[148:151], a[4:7], a[72:75], 0
    buffer_load_dwordx4 a[100:103], v10, s[36:39], s77 offen offset:1024 sc1
    v_mfma_f32_16x16x32_bf16 v[204:207], a[4:7], a[76:79], 0
    ds_read_b64_tr_b16 a[4:5], v12 offset:21504
    v_mfma_f32_16x16x32_bf16 v[40:43], a[8:11], a[64:67], 0
    ds_read_b64_tr_b16 a[6:7], v12 offset:25088
    v_mfma_f32_16x16x32_bf16 v[96:99], a[8:11], a[68:71], 0
    v_mfma_f32_16x16x32_bf16 v[152:155], a[8:11], a[72:75], 0
    buffer_load_dwordx4 v9, s[56:59], s72 offen offset:2048 lds
    s_add_u32 s72, s72, 458752
    s_add_u32 s73, s73, 28672
    s_cmp_ge_u32 s73, s75
    s_cselect_b32 s73, s74, s73
    v_mfma_f32_16x16x32_bf16 v[208:211], a[8:11], a[76:79], 0
    ds_read_b64_tr_b16 a[8:9], v12 offset:7200
    v_mfma_f32_16x16x32_bf16 v[44:47], a[12:15], a[64:67], 0
    ds_read_b64_tr_b16 a[10:11], v12 offset:10784
    v_mfma_f32_16x16x32_bf16 v[100:103], a[12:15], a[68:71], 0
    s_add_u32 s76, s76, 28672
    v_mfma_f32_16x16x32_bf16 v[156:159], a[12:15], a[72:75], 0
    s_cmp_ge_u32 s76, 143360
    s_cselect_b32 s76, 0, s76
    v_mfma_f32_16x16x32_bf16 v[212:215], a[12:15], a[76:79], 0
    ds_read_b64_tr_b16 a[12:13], v12 offset:21536
    v_mfma_f32_16x16x32_bf16 v[48:51], a[16:19], a[64:67], 0
    ds_read_b64_tr_b16 a[14:15], v12 offset:25120
    v_mfma_f32_16x16x32_bf16 v[104:107], a[16:19], a[68:71], 0
    v_add_u32 v14, s76, v11
    v_mfma_f32_16x16x32_bf16 v[160:163], a[16:19], a[72:75], 0
    v_mfma_f32_16x16x32_bf16 v[216:219], a[16:19], a[76:79], 0
    ds_read_b64_tr_b16 a[16:17], v12 offset:7232
    v_mfma_f32_16x16x32_bf16 v[52:55], a[20:23], a[64:67], 0
    ds_read_b64_tr_b16 a[18:19], v12 offset:10816
    v_mfma_f32_16x16x32_bf16 v[108:111], a[20:23], a[68:71], 0
    buffer_load_dwordx4 a[104:107], v10, s[36:39], s77 offen offset:2048 sc1
    v_mfma_f32_16x16x32_bf16 v[164:167], a[20:23], a[72:75], 0
    buffer_load_dwordx4 a[108:111], v10, s[36:39], s77 offen offset:3072 sc1
    s_add_u32 s77, s77, 4096
    v_mfma_f32_16x16x32_bf16 v[220:223], a[20:23], a[76:79], 0
    ds_read_b64_tr_b16 a[20:21], v12 offset:21568
    v_mfma_f32_16x16x32_bf16 v[56:59], a[24:27], a[64:67], 0
    ds_read_b64_tr_b16 a[22:23], v12 offset:25152
    v_mfma_f32_16x16x32_bf16 v[112:115], a[24:27], a[68:71], 0
    v_mfma_f32_16x16x32_bf16 v[168:171], a[24:27], a[72:75], 0
    buffer_load_dwordx4 a[112:115], v10, s[36:39], s77 offen offset:0 sc1
    v_mfma_f32_16x16x32_bf16 v[224:227], a[24:27], a[76:79], 0
    ds_read_b64_tr_b16 a[24:25], v12 offset:7264
    v_mfma_f32_16x16x32_bf16 v[60:63], a[28:31], a[64:67], 0
    ds_read_b64_tr_b16 a[26:27], v12 offset:10848
    v_mfma_f32_16x16x32_bf16 v[116:119], a[28:31], a[68:71], 0
    v_mfma_f32_16x16x32_bf16 v[172:175], a[28:31], a[72:75], 0
    buffer_load_dwordx4 a[116:119], v10, s[36:39], s77 offen offset:1024 sc1
    v_mfma_f32_16x16x32_bf16 v[228:231], a[28:31], a[76:79], 0
    ds_read_b64_tr_b16 a[28:29], v12 offset:21600
    s_waitcnt lgkmcnt(8)
    v_mfma_f32_16x16x32_bf16 v[64:67], a[32:35], a[64:67], 0
    ds_read_b64_tr_b16 a[30:31], v12 offset:25184
    v_mfma_f32_16x16x32_bf16 v[120:123], a[32:35], a[68:71], 0
    buffer_load_dwordx4 a[120:123], v10, s[36:39], s77 offen offset:2048 sc1
    v_mfma_f32_16x16x32_bf16 v[176:179], a[32:35], a[72:75], 0
    v_mfma_f32_16x16x32_bf16 v[232:235], a[32:35], a[76:79], 0
    ds_read_b64_tr_b16 a[32:33], v12 offset:7296
    v_mfma_f32_16x16x32_bf16 v[68:71], a[36:39], a[64:67], 0
    ds_read_b64_tr_b16 a[34:35], v12 offset:10880
    v_mfma_f32_16x16x32_bf16 v[124:127], a[36:39], a[68:71], 0
    buffer_load_dwordx4 a[124:127], v10, s[36:39], s77 offen offset:3072 sc1
    s_add_u32 s77, s77, 4096
    v_mfma_f32_16x16x32_bf16 v[180:183], a[36:39], a[72:75], 0
    v_mfma_f32_16x16x32_bf16 v[236:239], a[36:39], a[76:79], 0
    ds_read_b64_tr_b16 a[36:37], v12 offset:21632
    v_mfma_f32_16x16x32_bf16 v[72:75], a[40:43], a[64:67], 0
    ds_read_b64_tr_b16 a[38:39], v12 offset:25216
    v_mfma_f32_16x16x32_bf16 v[76:79], a[44:47], a[64:67], 0
    v_mfma_f32_16x16x32_bf16 v[80:83], a[48:51], a[64:67], 0
    v_mfma_f32_16x16x32_bf16 v[84:87], a[52:55], a[64:67], 0
    buffer_load_dwordx4 a[64:67], v10, s[36:39], s77 offen offset:0 sc1
    v_mfma_f32_16x16x32_bf16 v[128:131], a[40:43], a[68:71], 0
    v_mfma_f32_16x16x32_bf16 v[132:135], a[44:47], a[68:71], 0
    v_mfma_f32_16x16x32_bf16 v[136:139], a[48:51], a[68:71], 0
    v_mfma_f32_16x16x32_bf16 v[140:143], a[52:55], a[68:71], 0
    buffer_load_dwordx4 a[68:71], v10, s[36:39], s77 offen offset:1024 sc1
    v_mfma_f32_16x16x32_bf16 v[184:187], a[40:43], a[72:75], 0
    v_mfma_f32_16x16x32_bf16 v[188:191], a[44:47], a[72:75], 0
    v_mfma_f32_16x16x32_bf16 v[192:195], a[48:51], a[72:75], 0
    v_mfma_f32_16x16x32_bf16 v[196:199], a[52:55], a[72:75], 0
    buffer_load_dwordx4 a[72:75], v10, s[36:39], s77 offen offset:2048 sc1
    v_mfma_f32_16x16x32_bf16 v[240:243], a[40:43], a[76:79], 0
    ds_read_b64_tr_b16 a[40:41], v12 offset:7328
    v_mfma_f32_16x16x32_bf16 v[244:247], a[44:47], a[76:79], 0
    ds_read_b64_tr_b16 a[44:45], v12 offset:21664
    v_mfma_f32_16x16x32_bf16 v[248:251], a[48:51], a[76:79], 0
    ds_read_b64_tr_b16 a[48:49], v12 offset:7360
    v_mfma_f32_16x16x32_bf16 v[252:255], a[52:55], a[76:79], 0
    ds_read_b64_tr_b16 a[52:53], v12 offset:21696
    s_waitcnt vmcnt(14) lgkmcnt(4)
    v_mfma_f32_16x16x32_bf16 v[32:35], a[0:3], a[80:83], v[32:35]
    buffer_load_dwordx4 a[76:79], v10, s[36:39], s77 offen offset:3072 sc1
    s_add_u32 s77, s77, 4096
    v_add_u32 v22, v22, v23
    v_mfma_f32_16x16x32_bf16 v[88:91], a[0:3], a[84:87], v[88:91]
    s_waitcnt vmcnt(34)
    v_min_u32 v25, v22, v24
    v_mfma_f32_16x16x32_bf16 v[144:147], a[0:3], a[88:91], v[144:147]
    s_barrier
    v_add_co_u32 v26, vcc, v20, v25
    v_mfma_f32_16x16x32_bf16 v[200:203], a[0:3], a[92:95], v[200:203]
    ds_read_b64_tr_b16 a[0:1], v14 offset:0
    s_nop 0
    v_mfma_f32_16x16x32_bf16 v[36:39], a[4:7], a[80:83], v[36:39]
    ds_read_b64_tr_b16 a[2:3], v14 offset:3584
    v_addc_co_u32 v27, vcc, 0, v21, vcc
    v_mfma_f32_16x16x32_bf16 v[92:95], a[4:7], a[84:87], v[92:95]
    ds_read_b64_tr_b16 a[42:43], v12 offset:10912
    global_load_dword v31, v[26:27], off
    v_mfma_f32_16x16x32_bf16 v[148:151], a[4:7], a[88:91], v[148:151]
    ds_read_b64_tr_b16 a[46:47], v12 offset:25248
    buffer_load_dwordx4 a[168:171], v19, s[40:43], s70 offen
    v_mfma_f32_16x16x32_bf16 v[204:207], a[4:7], a[92:95], v[204:207]
    ds_read_b64_tr_b16 a[4:5], v14 offset:14336
    v_mfma_f32_16x16x32_bf16 v[40:43], a[8:11], a[80:83], v[40:43]
    ds_read_b64_tr_b16 a[6:7], v14 offset:17920
    v_mfma_f32_16x16x32_bf16 v[96:99], a[8:11], a[84:87], v[96:99]
    ds_read_b64_tr_b16 a[50:51], v12 offset:10944
    v_mfma_f32_16x16x32_bf16 v[152:155], a[8:11], a[88:91], v[152:155]
    ds_read_b64_tr_b16 a[54:55], v12 offset:25280
    v_mfma_f32_16x16x32_bf16 v[208:211], a[8:11], a[92:95], v[208:211]
    ds_read_b64_tr_b16 a[8:9], v14 offset:32
    v_mfma_f32_16x16x32_bf16 v[44:47], a[12:15], a[80:83], v[44:47]
    ds_read_b64_tr_b16 a[10:11], v14 offset:3616
    v_mfma_f32_16x16x32_bf16 v[100:103], a[12:15], a[84:87], v[100:103]
    s_mov_b32 m0, s73
    s_nop 0
    buffer_load_dwordx4 v3, s[56:59], s72 offen offset:0 lds
    v_mfma_f32_16x16x32_bf16 v[156:159], a[12:15], a[88:91], v[156:159]
    v_mfma_f32_16x16x32_bf16 v[212:215], a[12:15], a[92:95], v[212:215]
    ds_read_b64_tr_b16 a[12:13], v14 offset:14368
    v_mfma_f32_16x16x32_bf16 v[48:51], a[16:19], a[80:83], v[48:51]
    ds_read_b64_tr_b16 a[14:15], v14 offset:17952
    v_mfma_f32_16x16x32_bf16 v[104:107], a[16:19], a[84:87], v[104:107]
    v_mfma_f32_16x16x32_bf16 v[160:163], a[16:19], a[88:91], v[160:163]
    buffer_load_dwordx4 v4, s[56:59], s72 offen offset:1024 lds
    v_mfma_f32_16x16x32_bf16 v[216:219], a[16:19], a[92:95], v[216:219]
    ds_read_b64_tr_b16 a[16:17], v14 offset:64
    v_mfma_f32_16x16x32_bf16 v[52:55], a[20:23], a[80:83], v[52:55]
    ds_read_b64_tr_b16 a[18:19], v14 offset:3648
    v_mfma_f32_16x16x32_bf16 v[108:111], a[20:23], a[84:87], v[108:111]
    v_mfma_f32_16x16x32_bf16 v[164:167], a[20:23], a[88:91], v[164:167]
    v_mfma_f32_16x16x32_bf16 v[220:223], a[20:23], a[92:95], v[220:223]
    ds_read_b64_tr_b16 a[20:21], v14 offset:14400
    v_mfma_f32_16x16x32_bf16 v[56:59], a[24:27], a[80:83], v[56:59]
    ds_read_b64_tr_b16 a[22:23], v14 offset:17984
    v_mfma_f32_16x16x32_bf16 v[112:115], a[24:27], a[84:87], v[112:115]
    v_mfma_f32_16x16x32_bf16 v[168:171], a[24:27], a[88:91], v[168:171]
    buffer_load_dwordx4 v5, s[56:59], s72 offen offset:2048 lds
    v_mfma_f32_16x16x32_bf16 v[224:227], a[24:27], a[92:95], v[224:227]
    ds_read_b64_tr_b16 a[24:25], v14 offset:96
    v_mfma_f32_16x16x32_bf16 v[60:63], a[28:31], a[80:83], v[60:63]
    ds_read_b64_tr_b16 a[26:27], v14 offset:3680
    v_mfma_f32_16x16x32_bf16 v[116:119], a[28:31], a[84:87], v[116:119]
    v_mfma_f32_16x16x32_bf16 v[172:175], a[28:31], a[88:91], v[172:175]
    v_mfma_f32_16x16x32_bf16 v[228:231], a[28:31], a[92:95], v[228:231]
    ds_read_b64_tr_b16 a[28:29], v14 offset:14432
    s_waitcnt lgkmcnt(8)
    v_mfma_f32_16x16x32_bf16 v[64:67], a[32:35], a[80:83], v[64:67]
    ds_read_b64_tr_b16 a[30:31], v14 offset:18016
    v_mfma_f32_16x16x32_bf16 v[120:123], a[32:35], a[84:87], v[120:123]
    buffer_load_dwordx4 v6, s[56:59], s72 offen offset:3072 lds
    v_mfma_f32_16x16x32_bf16 v[176:179], a[32:35], a[88:91], v[176:179]
    v_mfma_f32_16x16x32_bf16 v[232:235], a[32:35], a[92:95], v[232:235]
    ds_read_b64_tr_b16 a[32:33], v14 offset:128
    v_mfma_f32_16x16x32_bf16 v[68:71], a[36:39], a[80:83], v[68:71]
    ds_read_b64_tr_b16 a[34:35], v14 offset:3712
    v_mfma_f32_16x16x32_bf16 v[124:127], a[36:39], a[84:87], v[124:127]
    v_mfma_f32_16x16x32_bf16 v[180:183], a[36:39], a[88:91], v[180:183]
    v_mfma_f32_16x16x32_bf16 v[236:239], a[36:39], a[92:95], v[236:239]
    ds_read_b64_tr_b16 a[36:37], v14 offset:14464
    v_mfma_f32_16x16x32_bf16 v[72:75], a[40:43], a[80:83], v[72:75]
    ds_read_b64_tr_b16 a[38:39], v14 offset:18048
    v_mfma_f32_16x16x32_bf16 v[76:79], a[44:47], a[80:83], v[76:79]
    v_mfma_f32_16x16x32_bf16 v[80:83], a[48:51], a[80:83], v[80:83]
    v_mfma_f32_16x16x32_bf16 v[84:87], a[52:55], a[80:83], v[84:87]
    buffer_load_dwordx4 a[80:83], v10, s[36:39], s77 offen offset:0 sc1
    v_mfma_f32_16x16x32_bf16 v[128:131], a[40:43], a[84:87], v[128:131]
    v_mfma_f32_16x16x32_bf16 v[132:135], a[44:47], a[84:87], v[132:135]
    v_mfma_f32_16x16x32_bf16 v[136:139], a[48:51], a[84:87], v[136:139]
    v_mfma_f32_16x16x32_bf16 v[140:143], a[52:55], a[84:87], v[140:143]
    buffer_load_dwordx4 a[84:87], v10, s[36:39], s77 offen offset:1024 sc1
    v_mfma_f32_16x16x32_bf16 v[184:187], a[40:43], a[88:91], v[184:187]
    v_mfma_f32_16x16x32_bf16 v[188:191], a[44:47], a[88:91], v[188:191]
    v_mfma_f32_16x16x32_bf16 v[192:195], a[48:51], a[88:91], v[192:195]
    v_mfma_f32_16x16x32_bf16 v[196:199], a[52:55], a[88:91], v[196:199]
    buffer_load_dwordx4 a[88:91], v10, s[36:39], s77 offen offset:2048 sc1
    v_mfma_f32_16x16x32_bf16 v[240:243], a[40:43], a[92:95], v[240:243]
    ds_read_b64_tr_b16 a[40:41], v14 offset:160
    v_mfma_f32_16x16x32_bf16 v[244:247], a[44:47], a[92:95], v[244:247]
    ds_read_b64_tr_b16 a[44:45], v14 offset:14496
    v_mfma_f32_16x16x32_bf16 v[248:251], a[48:51], a[92:95], v[248:251]
    ds_read_b64_tr_b16 a[48:49], v14 offset:192
    v_mfma_f32_16x16x32_bf16 v[252:255], a[52:55], a[92:95], v[252:255]
    ds_read_b64_tr_b16 a[52:53], v14 offset:14528
    s_waitcnt vmcnt(17) lgkmcnt(4)
    v_mfma_f32_16x16x32_bf16 v[32:35], a[0:3], a[96:99], v[32:35]
    buffer_load_dwordx4 a[92:95], v10, s[36:39], s77 offen offset:3072 sc1
    s_add_u32 s77, s77, 4096
    v_add_u32 v22, v22, v23
    v_mfma_f32_16x16x32_bf16 v[88:91], a[0:3], a[100:103], v[88:91]
    ds_read_b64_tr_b16 a[42:43], v14 offset:3744
    v_min_u32 v25, v22, v24
    v_mfma_f32_16x16x32_bf16 v[144:147], a[0:3], a[104:107], v[144:147]
    s_add_u32 m0, s73, 4096
    s_nop 0
    buffer_load_dwordx4 v7, s[56:59], s72 offen offset:0 lds
    v_add_co_u32 v26, vcc, v20, v25
    v_mfma_f32_16x16x32_bf16 v[200:203], a[0:3], a[108:111], v[200:203]
    ds_read_b64_tr_b16 a[0:1], v14 offset:7168
    s_nop 0
    v_mfma_f32_16x16x32_bf16 v[36:39], a[4:7], a[96:99], v[36:39]
    ds_read_b64_tr_b16 a[2:3], v14 offset:10752
    v_addc_co_u32 v27, vcc, 0, v21, vcc
    v_mfma_f32_16x16x32_bf16 v[92:95], a[4:7], a[100:103], v[92:95]
    ds_read_b64_tr_b16 a[46:47], v14 offset:18080
    global_load_dword v31, v[26:27], off
    v_mfma_f32_16x16x32_bf16 v[148:151], a[4:7], a[104:107], v[148:151]
    ds_read_b64_tr_b16 a[50:51], v14 offset:3776
    v_mfma_f32_16x16x32_bf16 v[204:207], a[4:7], a[108:111], v[204:207]
    ds_read_b64_tr_b16 a[4:5], v14 offset:21504
    v_mfma_f32_16x16x32_bf16 v[40:43], a[8:11], a[96:99], v[40:43]
    ds_read_b64_tr_b16 a[6:7], v14 offset:25088
    v_mfma_f32_16x16x32_bf16 v[96:99], a[8:11], a[100:103], v[96:99]
    ds_read_b64_tr_b16 a[54:55], v14 offset:18112
    v_mfma_f32_16x16x32_bf16 v[152:155], a[8:11], a[104:107], v[152:155]
    v_mfma_f32_16x16x32_bf16 v[208:211], a[8:11], a[108:111], v[208:211]
    ds_read_b64_tr_b16 a[8:9], v14 offset:7200
    v_mfma_f32_16x16x32_bf16 v[44:47], a[12:15], a[96:99], v[44:47]
    ds_read_b64_tr_b16 a[10:11], v14 offset:10784
    v_mfma_f32_16x16x32_bf16 v[100:103], a[12:15], a[100:103], v[100:103]
    s_add_u32 s76, s76, 28672
    v_mfma_f32_16x16x32_bf16 v[156:159], a[12:15], a[104:107], v[156:159]
    s_cmp_ge_u32 s76, 143360
    s_cselect_b32 s76, 0, s76
    v_mfma_f32_16x16x32_bf16 v[212:215], a[12:15], a[108:111], v[212:215]
    ds_read_b64_tr_b16 a[12:13], v14 offset:21536
    v_mfma_f32_16x16x32_bf16 v[48:51], a[16:19], a[96:99], v[48:51]
    ds_read_b64_tr_b16 a[14:15], v14 offset:25120
    v_mfma_f32_16x16x32_bf16 v[104:107], a[16:19], a[100:103], v[104:107]
    v_add_u32 v12, s76, v11
    v_mfma_f32_16x16x32_bf16 v[160:163], a[16:19], a[104:107], v[160:163]
    v_mfma_f32_16x16x32_bf16 v[216:219], a[16:19], a[108:111], v[216:219]
    ds_read_b64_tr_b16 a[16:17], v14 offset:7232
    v_mfma_f32_16x16x32_bf16 v[52:55], a[20:23], a[96:99], v[52:55]
    ds_read_b64_tr_b16 a[18:19], v14 offset:10816
    v_mfma_f32_16x16x32_bf16 v[108:111], a[20:23], a[100:103], v[108:111]
    v_mfma_f32_16x16x32_bf16 v[164:167], a[20:23], a[104:107], v[164:167]
    buffer_load_dwordx4 v8, s[56:59], s72 offen offset:1024 lds
    v_mfma_f32_16x16x32_bf16 v[220:223], a[20:23], a[108:111], v[220:223]
    ds_read_b64_tr_b16 a[20:21], v14 offset:21568
    v_mfma_f32_16x16x32_bf16 v[56:59], a[24:27], a[96:99], v[56:59]
    ds_read_b64_tr_b16 a[22:23], v14 offset:25152
    v_mfma_f32_16x16x32_bf16 v[112:115], a[24:27], a[100:103], v[112:115]
    v_mfma_f32_16x16x32_bf16 v[168:171], a[24:27], a[104:107], v[168:171]
    v_mfma_f32_16x16x32_bf16 v[224:227], a[24:27], a[108:111], v[224:227]
    ds_read_b64_tr_b16 a[24:25], v14 offset:7264
    v_mfma_f32_16x16x32_bf16 v[60:63], a[28:31], a[96:99], v[60:63]
    ds_read_b64_tr_b16 a[26:27], v14 offset:10848
    v_mfma_f32_16x16x32_bf16 v[116:119], a[28:31], a[100:103], v[116:119]
    v_mfma_f32_16x16x32_bf16 v[172:175], a[28:31], a[104:107], v[172:175]
    buffer_load_dwordx4 v9, s[56:59], s72 offen offset:2048 lds
    s_add_u32 s72, s72, 458752
    s_add_u32 s73, s73, 28672
    s_cmp_ge_u32 s73, s75
    s_cselect_b32 s73, s74, s73
    v_mfma_f32_16x16x32_bf16 v[228:231], a[28:31], a[108:111], v[228:231]
    ds_read_b64_tr_b16 a[28:29], v14 offset:21600
    s_waitcnt lgkmcnt(8)
    v_mfma_f32_16x16x32_bf16 v[64:67], a[32:35], a[96:99], v[64:67]
    ds_read_b64_tr_b16 a[30:31], v14 offset:25184
    v_mfma_f32_16x16x32_bf16 v[120:123], a[32:35], a[100:103], v[120:123]
    v_mfma_f32_16x16x32_bf16 v[176:179], a[32:35], a[104:107], v[176:179]
    v_mfma_f32_16x16x32_bf16 v[232:235], a[32:35], a[108:111], v[232:235]
    ds_read_b64_tr_b16 a[32:33], v14 offset:7296
    v_mfma_f32_16x16x32_bf16 v[68:71], a[36:39], a[96:99], v[68:71]
    ds_read_b64_tr_b16 a[34:35], v14 offset:10880
    v_mfma_f32_16x16x32_bf16 v[124:127], a[36:39], a[100:103], v[124:127]
    v_mfma_f32_16x16x32_bf16 v[180:183], a[36:39], a[104:107], v[180:183]
    v_mfma_f32_16x16x32_bf16 v[236:239], a[36:39], a[108:111], v[236:239]
    ds_read_b64_tr_b16 a[36:37], v14 offset:21632
    v_mfma_f32_16x16x32_bf16 v[72:75], a[40:43], a[96:99], v[72:75]
    ds_read_b64_tr_b16 a[38:39], v14 offset:25216
    v_mfma_f32_16x16x32_bf16 v[76:79], a[44:47], a[96:99], v[76:79]
    v_mfma_f32_16x16x32_bf16 v[80:83], a[48:51], a[96:99], v[80:83]
    v_mfma_f32_16x16x32_bf16 v[84:87], a[52:55], a[96:99], v[84:87]
    buffer_load_dwordx4 a[96:99], v10, s[36:39], s77 offen offset:0 sc1
    v_mfma_f32_16x16x32_bf16 v[128:131], a[40:43], a[100:103], v[128:131]
    v_mfma_f32_16x16x32_bf16 v[132:135], a[44:47], a[100:103], v[132:135]
    v_mfma_f32_16x16x32_bf16 v[136:139], a[48:51], a[100:103], v[136:139]
    v_mfma_f32_16x16x32_bf16 v[140:143], a[52:55], a[100:103], v[140:143]
    buffer_load_dwordx4 a[100:103], v10, s[36:39], s77 offen offset:1024 sc1
    v_mfma_f32_16x16x32_bf16 v[184:187], a[40:43], a[104:107], v[184:187]
    v_mfma_f32_16x16x32_bf16 v[188:191], a[44:47], a[104:107], v[188:191]
    v_mfma_f32_16x16x32_bf16 v[192:195], a[48:51], a[104:107], v[192:195]
    v_mfma_f32_16x16x32_bf16 v[196:199], a[52:55], a[104:107], v[196:199]
    buffer_load_dwordx4 a[104:107], v10, s[36:39], s77 offen offset:2048 sc1
    v_mfma_f32_16x16x32_bf16 v[240:243], a[40:43], a[108:111], v[240:243]
    ds_read_b64_tr_b16 a[40:41], v14 offset:7328
    v_mfma_f32_16x16x32_bf16 v[244:247], a[44:47], a[108:111], v[244:247]
    ds_read_b64_tr_b16 a[44:45], v14 offset:21664
    v_mfma_f32_16x16x32_bf16 v[248:251], a[48:51], a[108:111], v[248:251]
    ds_read_b64_tr_b16 a[48:49], v14 offset:7360
    v_mfma_f32_16x16x32_bf16 v[252:255], a[52:55], a[108:111], v[252:255]
    ds_read_b64_tr_b16 a[52:53], v14 offset:21696
    s_waitcnt vmcnt(21) lgkmcnt(4)
    v_mfma_f32_16x16x32_bf16 v[32:35], a[0:3], a[112:115], v[32:35]
    buffer_load_dwordx4 a[108:111], v10, s[36:39], s77 offen offset:3072 sc1
    s_add_u32 s77, s77, 4096
    v_mfma_f32_16x16x32_bf16 v[88:91], a[0:3], a[116:119], v[88:91]
    s_waitcnt vmcnt(45)
    v_mfma_f32_16x16x32_bf16 v[144:147], a[0:3], a[120:123], v[144:147]
    s_barrier
    v_mfma_f32_16x16x32_bf16 v[200:203], a[0:3], a[124:127], v[200:203]
    ds_read_b64_tr_b16 a[0:1], v12 offset:0
    v_mfma_f32_16x16x32_bf16 v[36:39], a[4:7], a[112:115], v[36:39]
    ds_read_b64_tr_b16 a[2:3], v12 offset:3584
    v_mfma_f32_16x16x32_bf16 v[92:95], a[4:7], a[116:119], v[92:95]
    ds_read_b64_tr_b16 a[42:43], v14 offset:10912
    v_mfma_f32_16x16x32_bf16 v[148:151], a[4:7], a[120:123], v[148:151]
    ds_read_b64_tr_b16 a[46:47], v14 offset:25248
    v_mfma_f32_16x16x32_bf16 v[204:207], a[4:7], a[124:127], v[204:207]
    ds_read_b64_tr_b16 a[4:5], v12 offset:14336
    v_mfma_f32_16x16x32_bf16 v[40:43], a[8:11], a[112:115], v[40:43]
    ds_read_b64_tr_b16 a[6:7], v12 offset:17920
    v_mfma_f32_16x16x32_bf16 v[96:99], a[8:11], a[116:119], v[96:99]
    ds_read_b64_tr_b16 a[50:51], v14 offset:10944
    v_mfma_f32_16x16x32_bf16 v[152:155], a[8:11], a[120:123], v[152:155]
    ds_read_b64_tr_b16 a[54:55], v14 offset:25280
    v_mfma_f32_16x16x32_bf16 v[208:211], a[8:11], a[124:127], v[208:211]
    ds_read_b64_tr_b16 a[8:9], v12 offset:32
    v_mfma_f32_16x16x32_bf16 v[44:47], a[12:15], a[112:115], v[44:47]
    ds_read_b64_tr_b16 a[10:11], v12 offset:3616
    v_mfma_f32_16x16x32_bf16 v[100:103], a[12:15], a[116:119], v[100:103]
    s_mov_b32 m0, s73
    s_nop 0
    buffer_load_dwordx4 v3, s[56:59], s72 offen offset:0 lds
    v_mfma_f32_16x16x32_bf16 v[156:159], a[12:15], a[120:123], v[156:159]
    v_mfma_f32_16x16x32_bf16 v[212:215], a[12:15], a[124:127], v[212:215]
    ds_read_b64_tr_b16 a[12:13], v12 offset:14368
    v_mfma_f32_16x16x32_bf16 v[48:51], a[16:19], a[112:115], v[48:51]
    ds_read_b64_tr_b16 a[14:15], v12 offset:17952
    v_mfma_f32_16x16x32_bf16 v[104:107], a[16:19], a[116:119], v[104:107]
    v_mfma_f32_16x16x32_bf16 v[160:163], a[16:19], a[120:123], v[160:163]
    buffer_load_dwordx4 v4, s[56:59], s72 offen offset:1024 lds
    v_mfma_f32_16x16x32_bf16 v[216:219], a[16:19], a[124:127], v[216:219]
    ds_read_b64_tr_b16 a[16:17], v12 offset:64
    v_mfma_f32_16x16x32_bf16 v[52:55], a[20:23], a[112:115], v[52:55]
    ds_read_b64_tr_b16 a[18:19], v12 offset:3648
    v_mfma_f32_16x16x32_bf16 v[108:111], a[20:23], a[116:119], v[108:111]
    v_mfma_f32_16x16x32_bf16 v[164:167], a[20:23], a[120:123], v[164:167]
    v_mfma_f32_16x16x32_bf16 v[220:223], a[20:23], a[124:127], v[220:223]
    ds_read_b64_tr_b16 a[20:21], v12 offset:14400
    v_mfma_f32_16x16x32_bf16 v[56:59], a[24:27], a[112:115], v[56:59]
    ds_read_b64_tr_b16 a[22:23], v12 offset:17984
    v_mfma_f32_16x16x32_bf16 v[112:115], a[24:27], a[116:119], v[112:115]
    v_mfma_f32_16x16x32_bf16 v[168:171], a[24:27], a[120:123], v[168:171]
    buffer_load_dwordx4 v5, s[56:59], s72 offen offset:2048 lds
    v_mfma_f32_16x16x32_bf16 v[224:227], a[24:27], a[124:127], v[224:227]
    ds_read_b64_tr_b16 a[24:25], v12 offset:96
    v_mfma_f32_16x16x32_bf16 v[60:63], a[28:31], a[112:115], v[60:63]
    ds_read_b64_tr_b16 a[26:27], v12 offset:3680
    v_mfma_f32_16x16x32_bf16 v[116:119], a[28:31], a[116:119], v[116:119]
    v_mfma_f32_16x16x32_bf16 v[172:175], a[28:31], a[120:123], v[172:175]
    v_mfma_f32_16x16x32_bf16 v[228:231], a[28:31], a[124:127], v[228:231]
    ds_read_b64_tr_b16 a[28:29], v12 offset:14432
    s_waitcnt lgkmcnt(8)
    v_mfma_f32_16x16x32_bf16 v[64:67], a[32:35], a[112:115], v[64:67]
    ds_read_b64_tr_b16 a[30:31], v12 offset:18016
    v_mfma_f32_16x16x32_bf16 v[120:123], a[32:35], a[116:119], v[120:123]
    buffer_load_dwordx4 v6, s[56:59], s72 offen offset:3072 lds
    v_mfma_f32_16x16x32_bf16 v[176:179], a[32:35], a[120:123], v[176:179]
    v_mfma_f32_16x16x32_bf16 v[232:235], a[32:35], a[124:127], v[232:235]
    ds_read_b64_tr_b16 a[32:33], v12 offset:128
    v_mfma_f32_16x16x32_bf16 v[68:71], a[36:39], a[112:115], v[68:71]
    ds_read_b64_tr_b16 a[34:35], v12 offset:3712
    v_mfma_f32_16x16x32_bf16 v[124:127], a[36:39], a[116:119], v[124:127]
    v_mfma_f32_16x16x32_bf16 v[180:183], a[36:39], a[120:123], v[180:183]
    v_mfma_f32_16x16x32_bf16 v[236:239], a[36:39], a[124:127], v[236:239]
    ds_read_b64_tr_b16 a[36:37], v12 offset:14464
    v_mfma_f32_16x16x32_bf16 v[72:75], a[40:43], a[112:115], v[72:75]
    ds_read_b64_tr_b16 a[38:39], v12 offset:18048
    v_mfma_f32_16x16x32_bf16 v[76:79], a[44:47], a[112:115], v[76:79]
    v_mfma_f32_16x16x32_bf16 v[80:83], a[48:51], a[112:115], v[80:83]
    v_mfma_f32_16x16x32_bf16 v[84:87], a[52:55], a[112:115], v[84:87]
    buffer_load_dwordx4 a[112:115], v10, s[36:39], s77 offen offset:0 sc1
    v_mfma_f32_16x16x32_bf16 v[128:131], a[40:43], a[116:119], v[128:131]
    v_mfma_f32_16x16x32_bf16 v[132:135], a[44:47], a[116:119], v[132:135]
    v_mfma_f32_16x16x32_bf16 v[136:139], a[48:51], a[116:119], v[136:139]
    v_mfma_f32_16x16x32_bf16 v[140:143], a[52:55], a[116:119], v[140:143]
    buffer_load_dwordx4 a[116:119], v10, s[36:39], s77 offen offset:1024 sc1
    v_mfma_f32_16x16x32_bf16 v[184:187], a[40:43], a[120:123], v[184:187]
    v_mfma_f32_16x16x32_bf16 v[188:191], a[44:47], a[120:123], v[188:191]
    v_mfma_f32_16x16x32_bf16 v[192:195], a[48:51], a[120:123], v[192:195]
    v_mfma_f32_16x16x32_bf16 v[196:199], a[52:55], a[120:123], v[196:199]
    buffer_load_dwordx4 a[120:123], v10, s[36:39], s77 offen offset:2048 sc1
    v_mfma_f32_16x16x32_bf16 v[240:243], a[40:43], a[124:127], v[240:243]
    ds_read_b64_tr_b16 a[40:41], v12 offset:160
    v_mfma_f32_16x16x32_bf16 v[244:247], a[44:47], a[124:127], v[244:247]
    ds_read_b64_tr_b16 a[44:45], v12 offset:14496
    v_mfma_f32_16x16x32_bf16 v[248:251], a[48:51], a[124:127], v[248:251]
    ds_read_b64_tr_b16 a[48:49], v12 offset:192
    v_mfma_f32_16x16x32_bf16 v[252:255], a[52:55], a[124:127], v[252:255]
    ds_read_b64_tr_b16 a[52:53], v12 offset:14528
    s_waitcnt vmcnt(23)
    buffer_store_dwordx4 a[168:171], v30, s[44:47], 0 offen sc1
    s_mov_b32 s78, 1
g1_loop:
    s_waitcnt vmcnt(23) lgkmcnt(4)
    v_mfma_f32_16x16x32_bf16 v[32:35], a[0:3], a[64:67], v[32:35]
    buffer_load_dwordx4 a[124:127], v10, s[36:39], s77 offen offset:3072 sc1
    s_add_u32 s77, s77, 4096
    v_mfma_f32_16x16x32_bf16 v[88:91], a[0:3], a[68:71], v[88:91]
    ds_read_b64_tr_b16 a[42:43], v12 offset:3744
    v_mfma_f32_16x16x32_bf16 v[144:147], a[0:3], a[72:75], v[144:147]
    s_add_u32 m0, s73, 4096
    s_nop 0
    buffer_load_dwordx4 v7, s[56:59], s72 offen offset:0 lds
    v_mfma_f32_16x16x32_bf16 v[200:203], a[0:3], a[76:79], v[200:203]
    ds_read_b64_tr_b16 a[0:1], v12 offset:7168
    v_mfma_f32_16x16x32_bf16 v[36:39], a[4:7], a[64:67], v[36:39]
    ds_read_b64_tr_b16 a[2:3], v12 offset:10752
    v_mfma_f32_16x16x32_bf16 v[92:95], a[4:7], a[68:71], v[92:95]
    ds_read_b64_tr_b16 a[46:47], v12 offset:18080
    v_mfma_f32_16x16x32_bf16 v[148:151], a[4:7], a[72:75], v[148:151]
    ds_read_b64_tr_b16 a[50:51], v12 offset:3776
    v_mfma_f32_16x16x32_bf16 v[204:207], a[4:7], a[76:79], v[204:207]
    ds_read_b64_tr_b16 a[4:5], v12 offset:21504
    v_mfma_f32_16x16x32_bf16 v[40:43], a[8:11], a[64:67], v[40:43]
    ds_read_b64_tr_b16 a[6:7], v12 offset:25088
    v_mfma_f32_16x16x32_bf16 v[96:99], a[8:11], a[68:71], v[96:99]
    ds_read_b64_tr_b16 a[54:55], v12 offset:18112
    v_mfma_f32_16x16x32_bf16 v[152:155], a[8:11], a[72:75], v[152:155]
    v_add_u32 v22, v22, v23
    v_mfma_f32_16x16x32_bf16 v[208:211], a[8:11], a[76:79], v[208:211]
    ds_read_b64_tr_b16 a[8:9], v12 offset:7200
    v_mfma_f32_16x16x32_bf16 v[44:47], a[12:15], a[64:67], v[44:47]
    ds_read_b64_tr_b16 a[10:11], v12 offset:10784
    v_mfma_f32_16x16x32_bf16 v[100:103], a[12:15], a[68:71], v[100:103]
    s_add_u32 s76, s76, 28672
    v_mfma_f32_16x16x32_bf16 v[156:159], a[12:15], a[72:75], v[156:159]
    s_cmp_ge_u32 s76, 143360
    s_cselect_b32 s76, 0, s76
    v_mfma_f32_16x16x32_bf16 v[212:215], a[12:15], a[76:79], v[212:215]
    ds_read_b64_tr_b16 a[12:13], v12 offset:21536
    v_mfma_f32_16x16x32_bf16 v[48:51], a[16:19], a[64:67], v[48:51]
    ds_read_b64_tr_b16 a[14:15], v12 offset:25120
    v_mfma_f32_16x16x32_bf16 v[104:107], a[16:19], a[68:71], v[104:107]
    v_add_u32 v14, s76, v11
    v_mfma_f32_16x16x32_bf16 v[160:163], a[16:19], a[72:75], v[160:163]
    v_min_u32 v25, v22, v24
    v_mfma_f32_16x16x32_bf16 v[216:219], a[16:19], a[76:79], v[216:219]
    ds_read_b64_tr_b16 a[16:17], v12 offset:7232
    v_mfma_f32_16x16x32_bf16 v[52:55], a[20:23], a[64:67], v[52:55]
    ds_read_b64_tr_b16 a[18:19], v12 offset:10816
    v_mfma_f32_16x16x32_bf16 v[108:111], a[20:23], a[68:71], v[108:111]
    v_add_co_u32 v26, vcc, v20, v25
    v_mfma_f32_16x16x32_bf16 v[164:167], a[20:23], a[72:75], v[164:167]
    buffer_load_dwordx4 v8, s[56:59], s72 offen offset:1024 lds
    v_mfma_f32_16x16x32_bf16 v[220:223], a[20:23], a[76:79], v[220:223]
    ds_read_b64_tr_b16 a[20:21], v12 offset:21568
    v_mfma_f32_16x16x32_bf16 v[56:59], a[24:27], a[64:67], v[56:59]
    ds_read_b64_tr_b16 a[22:23], v12 offset:25152
    v_mfma_f32_16x16x32_bf16 v[112:115], a[24:27], a[68:71], v[112:115]
    s_nop 0
    v_mfma_f32_16x16x32_bf16 v[168:171], a[24:27], a[72:75], v[168:171]
    v_addc_co_u32 v27, vcc, 0, v21, vcc
    v_mfma_f32_16x16x32_bf16 v[224:227], a[24:27], a[76:79], v[224:227]
    ds_read_b64_tr_b16 a[24:25], v12 offset:7264
    v_mfma_f32_16x16x32_bf16 v[60:63], a[28:31], a[64:67], v[60:63]
    ds_read_b64_tr_b16 a[26:27], v12 offset:10848
    v_mfma_f32_16x16x32_bf16 v[116:119], a[28:31], a[68:71], v[116:119]
    global_load_dword v31, v[26:27], off
    v_mfma_f32_16x16x32_bf16 v[172:175], a[28:31], a[72:75], v[172:175]
    buffer_load_dwordx4 v9, s[56:59], s72 offen offset:2048 lds
    s_add_u32 s72, s72, 458752
    s_add_u32 s73, s73, 28672
    s_cmp_ge_u32 s73, s75
    s_cselect_b32 s73, s74, s73
    v_mfma_f32_16x16x32_bf16 v[228:231], a[28:31], a[76:79], v[228:231]
    ds_read_b64_tr_b16 a[28:29], v12 offset:21600
    s_waitcnt lgkmcnt(8)
    v_mfma_f32_16x16x32_bf16 v[64:67], a[32:35], a[64:67], v[64:67]
    ds_read_b64_tr_b16 a[30:31], v12 offset:25184
    v_mfma_f32_16x16x32_bf16 v[120:123], a[32:35], a[68:71], v[120:123]
    v_mfma_f32_16x16x32_bf16 v[176:179], a[32:35], a[72:75], v[176:179]
    v_mfma_f32_16x16x32_bf16 v[232:235], a[32:35], a[76:79], v[232:235]
    ds_read_b64_tr_b16 a[32:33], v12 offset:7296
    v_mfma_f32_16x16x32_bf16 v[68:71], a[36:39], a[64:67], v[68:71]
    ds_read_b64_tr_b16 a[34:35], v12 offset:10880
    v_mfma_f32_16x16x32_bf16 v[124:127], a[36:39], a[68:71], v[124:127]
    v_mfma_f32_16x16x32_bf16 v[180:183], a[36:39], a[72:75], v[180:183]
    v_mfma_f32_16x16x32_bf16 v[236:239], a[36:39], a[76:79], v[236:239]
    ds_read_b64_tr_b16 a[36:37], v12 offset:21632
    v_mfma_f32_16x16x32_bf16 v[72:75], a[40:43], a[64:67], v[72:75]
    ds_read_b64_tr_b16 a[38:39], v12 offset:25216
    v_mfma_f32_16x16x32_bf16 v[76:79], a[44:47], a[64:67], v[76:79]
    v_mfma_f32_16x16x32_bf16 v[80:83], a[48:51], a[64:67], v[80:83]
    v_mfma_f32_16x16x32_bf16 v[84:87], a[52:55], a[64:67], v[84:87]
    buffer_load_dwordx4 a[64:67], v10, s[36:39], s77 offen offset:0 sc1
    v_mfma_f32_16x16x32_bf16 v[128:131], a[40:43], a[68:71], v[128:131]
    v_mfma_f32_16x16x32_bf16 v[132:135], a[44:47], a[68:71], v[132:135]
    v_mfma_f32_16x16x32_bf16 v[136:139], a[48:51], a[68:71], v[136:139]
    v_mfma_f32_16x16x32_bf16 v[140:143], a[52:55], a[68:71], v[140:143]
    buffer_load_dwordx4 a[68:71], v10, s[36:39], s77 offen offset:1024 sc1
    v_mfma_f32_16x16x32_bf16 v[184:187], a[40:43], a[72:75], v[184:187]
    v_mfma_f32_16x16x32_bf16 v[188:191], a[44:47], a[72:75], v[188:191]
    v_mfma_f32_16x16x32_bf16 v[192:195], a[48:51], a[72:75], v[192:195]
    v_mfma_f32_16x16x32_bf16 v[196:199], a[52:55], a[72:75], v[196:199]
    buffer_load_dwordx4 a[72:75], v10, s[36:39], s77 offen offset:2048 sc1
    v_mfma_f32_16x16x32_bf16 v[240:243], a[40:43], a[76:79], v[240:243]
    ds_read_b64_tr_b16 a[40:41], v12 offset:7328
    v_mfma_f32_16x16x32_bf16 v[244:247], a[44:47], a[76:79], v[244:247]
    ds_read_b64_tr_b16 a[44:45], v12 offset:21664
    v_mfma_f32_16x16x32_bf16 v[248:251], a[48:51], a[76:79], v[248:251]
    ds_read_b64_tr_b16 a[48:49], v12 offset:7360
    v_mfma_f32_16x16x32_bf16 v[252:255], a[52:55], a[76:79], v[252:255]
    ds_read_b64_tr_b16 a[52:53], v12 offset:21696
    s_waitcnt vmcnt(23) lgkmcnt(4)
    v_mfma_f32_16x16x32_bf16 v[32:35], a[0:3], a[80:83], v[32:35]
    buffer_load_dwordx4 a[76:79], v10, s[36:39], s77 offen offset:3072 sc1
    s_add_u32 s77, s77, 4096
    v_mfma_f32_16x16x32_bf16 v[88:91], a[0:3], a[84:87], v[88:91]
    s_waitcnt vmcnt(36)
    v_mfma_f32_16x16x32_bf16 v[144:147], a[0:3], a[88:91], v[144:147]
    s_barrier
    v_mfma_f32_16x16x32_bf16 v[200:203], a[0:3], a[92:95], v[200:203]
    ds_read_b64_tr_b16 a[0:1], v14 offset:0
    v_mfma_f32_16x16x32_bf16 v[36:39], a[4:7], a[80:83], v[36:39]
    ds_read_b64_tr_b16 a[2:3], v14 offset:3584
    v_mfma_f32_16x16x32_bf16 v[92:95], a[4:7], a[84:87], v[92:95]
    ds_read_b64_tr_b16 a[42:43], v12 offset:10912
    v_mfma_f32_16x16x32_bf16 v[148:151], a[4:7], a[88:91], v[148:151]
    ds_read_b64_tr_b16 a[46:47], v12 offset:25248
    v_mfma_f32_16x16x32_bf16 v[204:207], a[4:7], a[92:95], v[204:207]
    ds_read_b64_tr_b16 a[4:5], v14 offset:14336
    v_mfma_f32_16x16x32_bf16 v[40:43], a[8:11], a[80:83], v[40:43]
    ds_read_b64_tr_b16 a[6:7], v14 offset:17920
    v_mfma_f32_16x16x32_bf16 v[96:99], a[8:11], a[84:87], v[96:99]
    ds_read_b64_tr_b16 a[50:51], v12 offset:10944
    v_mfma_f32_16x16x32_bf16 v[152:155], a[8:11], a[88:91], v[152:155]
    ds_read_b64_tr_b16 a[54:55], v12 offset:25280
    v_mfma_f32_16x16x32_bf16 v[208:211], a[8:11], a[92:95], v[208:211]
    ds_read_b64_tr_b16 a[8:9], v14 offset:32
    v_mfma_f32_16x16x32_bf16 v[44:47], a[12:15], a[80:83], v[44:47]
    ds_read_b64_tr_b16 a[10:11], v14 offset:3616
    v_mfma_f32_16x16x32_bf16 v[100:103], a[12:15], a[84:87], v[100:103]
    s_cmp_lg_u32 s78, 3
    s_cbranch_scc1 nowp_4
    s_lshl_b32 s67, s2, 3
    s_add_u32 s67, s67, 8192
    s_cmp_lg_u32 s3, 0
    s_cbranch_scc1 nosig_5
    s_mov_b64 exec, 1
    v_mov_b32 v16, s64
    v_mov_b32 v17, s65
    v_mov_b32 v18, 0
    buffer_store_dwordx2 v[16:17], v18, s[60:63], s67 offen sc1
    s_mov_b64 exec, -1
nosig_5:
nowp_4:
    v_mfma_f32_16x16x32_bf16 v[156:159], a[12:15], a[88:91], v[156:159]
    s_mov_b32 m0, s73
    s_nop 0
    buffer_load_dwordx4 v3, s[56:59], s72 offen offset:0 lds
    v_mfma_f32_16x16x32_bf16 v[212:215], a[12:15], a[92:95], v[212:215]
    ds_read_b64_tr_b16 a[12:13], v14 offset:14368
    v_mfma_f32_16x16x32_bf16 v[48:51], a[16:19], a[80:83], v[48:51]
    ds_read_b64_tr_b16 a[14:15], v14 offset:17952
    v_mfma_f32_16x16x32_bf16 v[104:107], a[16:19], a[84:87], v[104:107]
    v_mfma_f32_16x16x32_bf16 v[160:163], a[16:19], a[88:91], v[160:163]
    v_mfma_f32_16x16x32_bf16 v[216:219], a[16:19], a[92:95], v[216:219]
    ds_read_b64_tr_b16 a[16:17], v14 offset:64
    v_mfma_f32_16x16x32_bf16 v[52:55], a[20:23], a[80:83], v[52:55]
    ds_read_b64_tr_b16 a[18:19], v14 offset:3648
    v_mfma_f32_16x16x32_bf16 v[108:111], a[20:23], a[84:87], v[108:111]
    buffer_load_dwordx4 v4, s[56:59], s72 offen offset:1024 lds
    v_mfma_f32_16x16x32_bf16 v[164:167], a[20:23], a[88:91], v[164:167]
    v_mfma_f32_16x16x32_bf16 v[220:223], a[20:23], a[92:95], v[220:223]
    ds_read_b64_tr_b16 a[20:21], v14 offset:14400
    v_mfma_f32_16x16x32_bf16 v[56:59], a[24:27], a[80:83], v[56:59]
    ds_read_b64_tr_b16 a[22:23], v14 offset:17984
    v_mfma_f32_16x16x32_bf16 v[112:115], a[24:27], a[84:87], v[112:115]
    v_mfma_f32_16x16x32_bf16 v[168:171], a[24:27], a[88:91], v[168:171]
    buffer_load_dwordx4 v5, s[56:59], s72 offen offset:2048 lds
    v_mfma_f32_16x16x32_bf16 v[224:227], a[24:27], a[92:95], v[224:227]
    ds_read_b64_tr_b16 a[24:25], v14 offset:96
    v_mfma_f32_16x16x32_bf16 v[60:63], a[28:31], a[80:83], v[60:63]
    ds_read_b64_tr_b16 a[26:27], v14 offset:3680
    v_mfma_f32_16x16x32_bf16 v[116:119], a[28:31], a[84:87], v[116:119]
    v_mfma_f32_16x16x32_bf16 v[172:175], a[28:31], a[88:91], v[172:175]
    v_mfma_f32_16x16x32_bf16 v[228:231], a[28:31], a[92:95], v[228:231]
    ds_read_b64_tr_b16 a[28:29], v14 offset:14432
    s_waitcnt lgkmcnt(8)
    v_mfma_f32_16x16x32_bf16 v[64:67], a[32:35], a[80:83], v[64:67]
    ds_read_b64_tr_b16 a[30:31], v14 offset:18016
    v_mfma_f32_16x16x32_bf16 v[120:123], a[32:35], a[84:87], v[120:123]
    buffer_load_dwordx4 v6, s[56:59], s72 offen offset:3072 lds
    v_mfma_f32_16x16x32_bf16 v[176:179], a[32:35], a[88:91], v[176:179]
    v_mfma_f32_16x16x32_bf16 v[232:235], a[32:35], a[92:95], v[232:235]
    ds_read_b64_tr_b16 a[32:33], v14 offset:128
    v_mfma_f32_16x16x32_bf16 v[68:71], a[36:39], a[80:83], v[68:71]
    ds_read_b64_tr_b16 a[34:35], v14 offset:3712
    v_mfma_f32_16x16x32_bf16 v[124:127], a[36:39], a[84:87], v[124:127]
    v_mfma_f32_16x16x32_bf16 v[180:183], a[36:39], a[88:91], v[180:183]
    v_mfma_f32_16x16x32_bf16 v[236:239], a[36:39], a[92:95], v[236:239]
    ds_read_b64_tr_b16 a[36:37], v14 offset:14464
    v_mfma_f32_16x16x32_bf16 v[72:75], a[40:43], a[80:83], v[72:75]
    ds_read_b64_tr_b16 a[38:39], v14 offset:18048
    v_mfma_f32_16x16x32_bf16 v[76:79], a[44:47], a[80:83], v[76:79]
    v_mfma_f32_16x16x32_bf16 v[80:83], a[48:51], a[80:83], v[80:83]
    v_mfma_f32_16x16x32_bf16 v[84:87], a[52:55], a[80:83], v[84:87]
    buffer_load_dwordx4 a[80:83], v10, s[36:39], s77 offen offset:0 sc1
    v_mfma_f32_16x16x32_bf16 v[128:131], a[40:43], a[84:87], v[128:131]
    v_mfma_f32_16x16x32_bf16 v[132:135], a[44:47], a[84:87], v[132:135]
    v_mfma_f32_16x16x32_bf16 v[136:139], a[48:51], a[84:87], v[136:139]
    v_mfma_f32_16x16x32_bf16 v[140:143], a[52:55], a[84:87], v[140:143]
    buffer_load_dwordx4 a[84:87], v10, s[36:39], s77 offen offset:1024 sc1
    v_mfma_f32_16x16x32_bf16 v[184:187], a[40:43], a[88:91], v[184:187]
    v_mfma_f32_16x16x32_bf16 v[188:191], a[44:47], a[88:91], v[188:191]
    v_mfma_f32_16x16x32_bf16 v[192:195], a[48:51], a[88:91], v[192:195]
    v_mfma_f32_16x16x32_bf16 v[196:199], a[52:55], a[88:91], v[196:199]
    buffer_load_dwordx4 a[88:91], v10, s[36:39], s77 offen offset:2048 sc1
    v_mfma_f32_16x16x32_bf16 v[240:243], a[40:43], a[92:95], v[240:243]
    ds_read_b64_tr_b16 a[40:41], v14 offset:160
    v_mfma_f32_16x16x32_bf16 v[244:247], a[44:47], a[92:95], v[244:247]
    ds_read_b64_tr_b16 a[44:45], v14 offset:14496
    v_mfma_f32_16x16x32_bf16 v[248:251], a[48:51], a[92:95], v[248:251]
    ds_read_b64_tr_b16 a[48:49], v14 offset:192
    v_mfma_f32_16x16x32_bf16 v[252:255], a[52:55], a[92:95], v[252:255]
    ds_read_b64_tr_b16 a[52:53], v14 offset:14528
    s_waitcnt vmcnt(23) lgkmcnt(4)
    v_mfma_f32_16x16x32_bf16 v[32:35], a[0:3], a[96:99], v[32:35]
    buffer_load_dwordx4 a[92:95], v10, s[36:39], s77 offen offset:3072 sc1
    s_add_u32 s77, s77, 4096
    v_mfma_f32_16x16x32_bf16 v[88:91], a[0:3], a[100:103], v[88:91]
    ds_read_b64_tr_b16 a[42:43], v14 offset:3744
    v_mfma_f32_16x16x32_bf16 v[144:147], a[0:3], a[104:107], v[144:147]
    s_add_u32 m0, s73, 4096
    s_nop 0
    buffer_load_dwordx4 v7, s[56:59], s72 offen offset:0 lds
    v_mfma_f32_16x16x32_bf16 v[200:203], a[0:3], a[108:111], v[200:203]
    ds_read_b64_tr_b16 a[0:1], v14 offset:7168
    v_mfma_f32_16x16x32_bf16 v[36:39], a[4:7], a[96:99], v[36:39]
    ds_read_b64_tr_b16 a[2:3], v14 offset:10752
    v_mfma_f32_16x16x32_bf16 v[92:95], a[4:7], a[100:103], v[92:95]
    ds_read_b64_tr_b16 a[46:47], v14 offset:18080
    v_mfma_f32_16x16x32_bf16 v[148:151], a[4:7], a[104:107], v[148:151]
    ds_read_b64_tr_b16 a[50:51], v14 offset:3776
    v_mfma_f32_16x16x32_bf16 v[204:207], a[4:7], a[108:111], v[204:207]
    ds_read_b64_tr_b16 a[4:5], v14 offset:21504
    v_mfma_f32_16x16x32_bf16 v[40:43], a[8:11], a[96:99], v[40:43]
    ds_read_b64_tr_b16 a[6:7], v14 offset:25088
    v_mfma_f32_16x16x32_bf16 v[96:99], a[8:11], a[100:103], v[96:99]
    ds_read_b64_tr_b16 a[54:55], v14 offset:18112
    v_mfma_f32_16x16x32_bf16 v[152:155], a[8:11], a[104:107], v[152:155]
    v_add_u32 v22, v22, v23
    v_mfma_f32_16x16x32_bf16 v[208:211], a[8:11], a[108:111], v[208:211]
    ds_read_b64_tr_b16 a[8:9], v14 offset:7200
    v_mfma_f32_16x16x32_bf16 v[44:47], a[12:15], a[96:99], v[44:47]
    ds_read_b64_tr_b16 a[10:11], v14 offset:10784
    v_mfma_f32_16x16x32_bf16 v[100:103], a[12:15], a[100:103], v[100:103]
    s_add_u32 s76, s76, 28672
    v_mfma_f32_16x16x32_bf16 v[156:159], a[12:15], a[104:107], v[156:159]
    s_cmp_ge_u32 s76, 143360
    s_cselect_b32 s76, 0, s76
    v_mfma_f32_16x16x32_bf16 v[212:215], a[12:15], a[108:111], v[212:215]
    ds_read_b64_tr_b16 a[12:13], v14 offset:21536
    v_mfma_f32_16x16x32_bf16 v[48:51], a[16:19], a[96:99], v[48:51]
    ds_read_b64_tr_b16 a[14:15], v14 offset:25120
    v_mfma_f32_16x16x32_bf16 v[104:107], a[16:19], a[100:103], v[104:107]
    v_add_u32 v12, s76, v11
    v_mfma_f32_16x16x32_bf16 v[160:163], a[16:19], a[104:107], v[160:163]
    v_min_u32 v25, v22, v24
    v_mfma_f32_16x16x32_bf16 v[216:219], a[16:19], a[108:111], v[216:219]
    ds_read_b64_tr_b16 a[16:17], v14 offset:7232
    v_mfma_f32_16x16x32_bf16 v[52:55], a[20:23], a[96:99], v[52:55]
    ds_read_b64_tr_b16 a[18:19], v14 offset:10816
    v_mfma_f32_16x16x32_bf16 v[108:111], a[20:23], a[100:103], v[108:111]
    v_add_co_u32 v26, vcc, v20, v25
    v_mfma_f32_16x16x32_bf16 v[164:167], a[20:23], a[104:107], v[164:167]
    buffer_load_dwordx4 v8, s[56:59], s72 offen offset:1024 lds
    v_mfma_f32_16x16x32_bf16 v[220:223], a[20:23], a[108:111], v[220:223]
    ds_read_b64_tr_b16 a[20:21], v14 offset:21568
    v_mfma_f32_16x16x32_bf16 v[56:59], a[24:27], a[96:99], v[56:59]
    ds_read_b64_tr_b16 a[22:23], v14 offset:25152
    v_mfma_f32_16x16x32_bf16 v[112:115], a[24:27], a[100:103], v[112:115]
    s_nop 0
    v_mfma_f32_16x16x32_bf16 v[168:171], a[24:27], a[104:107], v[168:171]
    v_addc_co_u32 v27, vcc, 0, v21, vcc
    v_mfma_f32_16x16x32_bf16 v[224:227], a[24:27], a[108:111], v[224:227]
    ds_read_b64_tr_b16 a[24:25], v14 offset:7264
    v_mfma_f32_16x16x32_bf16 v[60:63], a[28:31], a[96:99], v[60:63]
    ds_read_b64_tr_b16 a[26:27], v14 offset:10848
    v_mfma_f32_16x16x32_bf16 v[116:119], a[28:31], a[100:103], v[116:119]
    global_load_dword v31, v[26:27], off
    v_mfma_f32_16x16x32_bf16 v[172:175], a[28:31], a[104:107], v[172:175]
    buffer_load_dwordx4 v9, s[56:59], s72 offen offset:2048 lds
    s_add_u32 s72, s72, 458752
    s_add_u32 s73, s73, 28672
    s_cmp_ge_u32 s73, s75
    s_cselect_b32 s73, s74, s73
    v_mfma_f32_16x16x32_bf16 v[228:231], a[28:31], a[108:111], v[228:231]
    ds_read_b64_tr_b16 a[28:29], v14 offset:21600
    s_waitcnt lgkmcnt(8)
    v_mfma_f32_16x16x32_bf16 v[64:67], a[32:35], a[96:99], v[64:67]
    ds_read_b64_tr_b16 a[30:31], v14 offset:25184
    v_mfma_f32_16x16x32_bf16 v[120:123], a[32:35], a[100:103], v[120:123]
    v_mfma_f32_16x16x32_bf16 v[176:179], a[32:35], a[104:107], v[176:179]
    v_mfma_f32_16x16x32_bf16 v[232:235], a[32:35], a[108:111], v[232:235]
    ds_read_b64_tr_b16 a[32:33], v14 offset:7296
    v_mfma_f32_16x16x32_bf16 v[68:71], a[36:39], a[96:99], v[68:71]
    ds_read_b64_tr_b16 a[34:35], v14 offset:10880
    v_mfma_f32_16x16x32_bf16 v[124:127], a[36:39], a[100:103], v[124:127]
    v_mfma_f32_16x16x32_bf16 v[180:183], a[36:39], a[104:107], v[180:183]
    v_mfma_f32_16x16x32_bf16 v[236:239], a[36:39], a[108:111], v[236:239]
    ds_read_b64_tr_b16 a[36:37], v14 offset:21632
    v_mfma_f32_16x16x32_bf16 v[72:75], a[40:43], a[96:99], v[72:75]
    ds_read_b64_tr_b16 a[38:39], v14 offset:25216
    v_mfma_f32_16x16x32_bf16 v[76:79], a[44:47], a[96:99], v[76:79]
    v_mfma_f32_16x16x32_bf16 v[80:83], a[48:51], a[96:99], v[80:83]
    v_mfma_f32_16x16x32_bf16 v[84:87], a[52:55], a[96:99], v[84:87]
    buffer_load_dwordx4 a[96:99], v10, s[36:39], s77 offen offset:0 sc1
    v_mfma_f32_16x16x32_bf16 v[128:131], a[40:43], a[100:103], v[128:131]
    v_mfma_f32_16x16x32_bf16 v[132:135], a[44:47], a[100:103], v[132:135]
    v_mfma_f32_16x16x32_bf16 v[136:139], a[48:51], a[100:103], v[136:139]
    v_mfma_f32_16x16x32_bf16 v[140:143], a[52:55], a[100:103], v[140:143]
    buffer_load_dwordx4 a[100:103], v10, s[36:39], s77 offen offset:1024 sc1
    v_mfma_f32_16x16x32_bf16 v[184:187], a[40:43], a[104:107], v[184:187]
    v_mfma_f32_16x16x32_bf16 v[188:191], a[44:47], a[104:107], v[188:191]
    v_mfma_f32_16x16x32_bf16 v[192:195], a[48:51], a[104:107], v[192:195]
    v_mfma_f32_16x16x32_bf16 v[196:199], a[52:55], a[104:107], v[196:199]
    buffer_load_dwordx4 a[104:107], v10, s[36:39], s77 offen offset:2048 sc1
    v_mfma_f32_16x16x32_bf16 v[240:243], a[40:43], a[108:111], v[240:243]
    ds_read_b64_tr_b16 a[40:41], v14 offset:7328
    v_mfma_f32_16x16x32_bf16 v[244:247], a[44:47], a[108:111], v[244:247]
    ds_read_b64_tr_b16 a[44:45], v14 offset:21664
    v_mfma_f32_16x16x32_bf16 v[248:251], a[48:51], a[108:111], v[248:251]
    ds_read_b64_tr_b16 a[48:49], v14 offset:7360
    v_mfma_f32_16x16x32_bf16 v[252:255], a[52:55], a[108:111], v[252:255]
    ds_read_b64_tr_b16 a[52:53], v14 offset:21696
    s_waitcnt vmcnt(23) lgkmcnt(4)
    v_mfma_f32_16x16x32_bf16 v[32:35], a[0:3], a[112:115], v[32:35]
    buffer_load_dwordx4 a[108:111], v10, s[36:39], s77 offen offset:3072 sc1
    s_add_u32 s77, s77, 4096
    v_mfma_f32_16x16x32_bf16 v[88:91], a[0:3], a[116:119], v[88:91]
    s_waitcnt vmcnt(36)
    v_mfma_f32_16x16x32_bf16 v[144:147], a[0:3], a[120:123], v[144:147]
    s_barrier
    v_mfma_f32_16x16x32_bf16 v[200:203], a[0:3], a[124:127], v[200:203]
    ds_read_b64_tr_b16 a[0:1], v12 offset:0
    v_mfma_f32_16x16x32_bf16 v[36:39], a[4:7], a[112:115], v[36:39]
    ds_read_b64_tr_b16 a[2:3], v12 offset:3584
    v_mfma_f32_16x16x32_bf16 v[92:95], a[4:7], a[116:119], v[92:95]
    ds_read_b64_tr_b16 a[42:43], v14 offset:10912
    v_mfma_f32_16x16x32_bf16 v[148:151], a[4:7], a[120:123], v[148:151]
    ds_read_b64_tr_b16 a[46:47], v14 offset:25248
    v_mfma_f32_16x16x32_bf16 v[204:207], a[4:7], a[124:127], v[204:207]
    ds_read_b64_tr_b16 a[4:5], v12 offset:14336
    v_mfma_f32_16x16x32_bf16 v[40:43], a[8:11], a[112:115], v[40:43]
    ds_read_b64_tr_b16 a[6:7], v12 offset:17920
    v_mfma_f32_16x16x32_bf16 v[96:99], a[8:11], a[116:119], v[96:99]
    ds_read_b64_tr_b16 a[50:51], v14 offset:10944
    v_mfma_f32_16x16x32_bf16 v[152:155], a[8:11], a[120:123], v[152:155]
    ds_read_b64_tr_b16 a[54:55], v14 offset:25280
    v_mfma_f32_16x16x32_bf16 v[208:211], a[8:11], a[124:127], v[208:211]
    ds_read_b64_tr_b16 a[8:9], v12 offset:32
    v_mfma_f32_16x16x32_bf16 v[44:47], a[12:15], a[112:115], v[44:47]
    ds_read_b64_tr_b16 a[10:11], v12 offset:3616
    v_mfma_f32_16x16x32_bf16 v[100:103], a[12:15], a[116:119], v[100:103]
    s_mov_b32 m0, s73
    s_nop 0
    buffer_load_dwordx4 v3, s[56:59], s72 offen offset:0 lds
    v_mfma_f32_16x16x32_bf16 v[156:159], a[12:15], a[120:123], v[156:159]
    v_mfma_f32_16x16x32_bf16 v[212:215], a[12:15], a[124:127], v[212:215]
    ds_read_b64_tr_b16 a[12:13], v12 offset:14368
    v_mfma_f32_16x16x32_bf16 v[48:51], a[16:19], a[112:115], v[48:51]
    ds_read_b64_tr_b16 a[14:15], v12 offset:17952
    v_mfma_f32_16x16x32_bf16 v[104:107], a[16:19], a[116:119], v[104:107]
    v_mfma_f32_16x16x32_bf16 v[160:163], a[16:19], a[120:123], v[160:163]
    buffer_load_dwordx4 v4, s[56:59], s72 offen offset:1024 lds
    v_mfma_f32_16x16x32_bf16 v[216:219], a[16:19], a[124:127], v[216:219]
    ds_read_b64_tr_b16 a[16:17], v12 offset:64
    v_mfma_f32_16x16x32_bf16 v[52:55], a[20:23], a[112:115], v[52:55]
    ds_read_b64_tr_b16 a[18:19], v12 offset:3648
    v_mfma_f32_16x16x32_bf16 v[108:111], a[20:23], a[116:119], v[108:111]
    v_mfma_f32_16x16x32_bf16 v[164:167], a[20:23], a[120:123], v[164:167]
    v_mfma_f32_16x16x32_bf16 v[220:223], a[20:23], a[124:127], v[220:223]
    ds_read_b64_tr_b16 a[20:21], v12 offset:14400
    v_mfma_f32_16x16x32_bf16 v[56:59], a[24:27], a[112:115], v[56:59]
    ds_read_b64_tr_b16 a[22:23], v12 offset:17984
    v_mfma_f32_16x16x32_bf16 v[112:115], a[24:27], a[116:119], v[112:115]
    v_mfma_f32_16x16x32_bf16 v[168:171], a[24:27], a[120:123], v[168:171]
    buffer_load_dwordx4 v5, s[56:59], s72 offen offset:2048 lds
    v_mfma_f32_16x16x32_bf16 v[224:227], a[24:27], a[124:127], v[224:227]
    ds_read_b64_tr_b16 a[24:25], v12 offset:96
    v_mfma_f32_16x16x32_bf16 v[60:63], a[28:31], a[112:115], v[60:63]
    ds_read_b64_tr_b16 a[26:27], v12 offset:3680
    v_mfma_f32_16x16x32_bf16 v[116:119], a[28:31], a[116:119], v[116:119]
    v_mfma_f32_16x16x32_bf16 v[172:175], a[28:31], a[120:123], v[172:175]
    v_mfma_f32_16x16x32_bf16 v[228:231], a[28:31], a[124:127], v[228:231]
    ds_read_b64_tr_b16 a[28:29], v12 offset:14432
    s_waitcnt lgkmcnt(8)
    v_mfma_f32_16x16x32_bf16 v[64:67], a[32:35], a[112:115], v[64:67]
    ds_read_b64_tr_b16 a[30:31], v12 offset:18016
    v_mfma_f32_16x16x32_bf16 v[120:123], a[32:35], a[116:119], v[120:123]
    buffer_load_dwordx4 v6, s[56:59], s72 offen offset:3072 lds
    v_mfma_f32_16x16x32_bf16 v[176:179], a[32:35], a[120:123], v[176:179]
    v_mfma_f32_16x16x32_bf16 v[232:235], a[32:35], a[124:127], v[232:235]
    ds_read_b64_tr_b16 a[32:33], v12 offset:128
    v_mfma_f32_16x16x32_bf16 v[68:71], a[36:39], a[112:115], v[68:71]
    ds_read_b64_tr_b16 a[34:35], v12 offset:3712
    v_mfma_f32_16x16x32_bf16 v[124:127], a[36:39], a[116:119], v[124:127]
    v_mfma_f32_16x16x32_bf16 v[180:183], a[36:39], a[120:123], v[180:183]
    v_mfma_f32_16x16x32_bf16 v[236:239], a[36:39], a[124:127], v[236:239]
    ds_read_b64_tr_b16 a[36:37], v12 offset:14464
    v_mfma_f32_16x16x32_bf16 v[72:75], a[40:43], a[112:115], v[72:75]
    ds_read_b64_tr_b16 a[38:39], v12 offset:18048
    v_mfma_f32_16x16x32_bf16 v[76:79], a[44:47], a[112:115], v[76:79]
    v_mfma_f32_16x16x32_bf16 v[80:83], a[48:51], a[112:115], v[80:83]
    v_mfma_f32_16x16x32_bf16 v[84:87], a[52:55], a[112:115], v[84:87]
    buffer_load_dwordx4 a[112:115], v10, s[36:39], s77 offen offset:0 sc1
    v_mfma_f32_16x16x32_bf16 v[128:131], a[40:43], a[116:119], v[128:131]
    v_mfma_f32_16x16x32_bf16 v[132:135], a[44:47], a[116:119], v[132:135]
    v_mfma_f32_16x16x32_bf16 v[136:139], a[48:51], a[116:119], v[136:139]
    v_mfma_f32_16x16x32_bf16 v[140:143], a[52:55], a[116:119], v[140:143]
    buffer_load_dwordx4 a[116:119], v10, s[36:39], s77 offen offset:1024 sc1
    v_mfma_f32_16x16x32_bf16 v[184:187], a[40:43], a[120:123], v[184:187]
    v_mfma_f32_16x16x32_bf16 v[188:191], a[44:47], a[120:123], v[188:191]
    v_mfma_f32_16x16x32_bf16 v[192:195], a[48:51], a[120:123], v[192:195]
    v_mfma_f32_16x16x32_bf16 v[196:199], a[52:55], a[120:123], v[196:199]
    buffer_load_dwordx4 a[120:123], v10, s[36:39], s77 offen offset:2048 sc1
    v_mfma_f32_16x16x32_bf16 v[240:243], a[40:43], a[124:127], v[240:243]
    ds_read_b64_tr_b16 a[40:41], v12 offset:160
    v_mfma_f32_16x16x32_bf16 v[244:247], a[44:47], a[124:127], v[244:247]
    ds_read_b64_tr_b16 a[44:45], v12 offset:14496
    v_mfma_f32_16x16x32_bf16 v[248:251], a[48:51], a[124:127], v[248:251]
    ds_read_b64_tr_b16 a[48:49], v12 offset:192
    v_mfma_f32_16x16x32_bf16 v[252:255], a[52:55], a[124:127], v[252:255]
    ds_read_b64_tr_b16 a[52:53], v12 offset:14528
    s_add_u32 s78, s78, 1
    s_cmp_lt_u32 s78, 6
    s_cbranch_scc1 g1_loop
    s_waitcnt vmcnt(23) lgkmcnt(4)
    v_mfma_f32_16x16x32_bf16 v[32:35], a[0:3], a[64:67], v[32:35]
    buffer_load_dwordx4 a[124:127], v10, s[36:39], s77 offen offset:3072 sc1
    s_add_u32 s77, s77, 4096
    s_mov_b32 s40, s6
    v_mfma_f32_16x16x32_bf16 v[88:91], a[0:3], a[68:71], v[88:91]
    ds_read_b64_tr_b16 a[42:43], v12 offset:3744
    s_mov_b32 s41, s7
    v_mfma_f32_16x16x32_bf16 v[144:147], a[0:3], a[72:75], v[144:147]
    s_add_u32 m0, s73, 4096
    s_nop 0
    buffer_load_dwordx4 v7, s[56:59], s72 offen offset:0 lds
    s_mov_b32 s42, 4194304
    v_mfma_f32_16x16x32_bf16 v[200:203], a[0:3], a[76:79], v[200:203]
    ds_read_b64_tr_b16 a[0:1], v12 offset:7168
    s_mov_b32 s43, 0x20000
    v_mfma_f32_16x16x32_bf16 v[36:39], a[4:7], a[64:67], v[36:39]
    ds_read_b64_tr_b16 a[2:3], v12 offset:10752
    s_mov_b32 s44, s8
    v_mfma_f32_16x16x32_bf16 v[92:95], a[4:7], a[68:71], v[92:95]
    ds_read_b64_tr_b16 a[46:47], v12 offset:18080
    s_mov_b32 s45, s9
    v_mfma_f32_16x16x32_bf16 v[148:151], a[4:7], a[72:75], v[148:151]
    ds_read_b64_tr_b16 a[50:51], v12 offset:3776
    s_mov_b32 s46, 4194304
    v_mfma_f32_16x16x32_bf16 v[204:207], a[4:7], a[76:79], v[204:207]
    ds_read_b64_tr_b16 a[4:5], v12 offset:21504
    s_mov_b32 s47, 0x20000
    v_mfma_f32_16x16x32_bf16 v[40:43], a[8:11], a[64:67], v[40:43]
    ds_read_b64_tr_b16 a[6:7], v12 offset:25088
    s_mov_b32 s48, s10
    v_mfma_f32_16x16x32_bf16 v[96:99], a[8:11], a[68:71], v[96:99]
    ds_read_b64_tr_b16 a[54:55], v12 offset:18112
    s_mov_b32 s49, s11
    v_mfma_f32_16x16x32_bf16 v[152:155], a[8:11], a[72:75], v[152:155]
    s_mov_b32 s50, 8192
    v_mfma_f32_16x16x32_bf16 v[208:211], a[8:11], a[76:79], v[208:211]
    ds_read_b64_tr_b16 a[8:9], v12 offset:7200
    s_mov_b32 s51, 0x20000
    v_mfma_f32_16x16x32_bf16 v[44:47], a[12:15], a[64:67], v[44:47]
    ds_read_b64_tr_b16 a[10:11], v12 offset:10784
    s_lshr_b32 s70, s2, 3
    v_mfma_f32_16x16x32_bf16 v[100:103], a[12:15], a[68:71], v[100:103]
    s_add_u32 s76, s76, 28672
    s_add_u32 s71, s2, s70
    v_mfma_f32_16x16x32_bf16 v[156:159], a[12:15], a[72:75], v[156:159]
    s_cmp_ge_u32 s76, 143360
    s_cselect_b32 s76, 0, s76
    s_and_b32 s71, s71, 7
    v_mfma_f32_16x16x32_bf16 v[212:215], a[12:15], a[76:79], v[212:215]
    ds_read_b64_tr_b16 a[12:13], v12 offset:21536
    s_lshl_b32 s68, s70, 17
    v_mfma_f32_16x16x32_bf16 v[48:51], a[16:19], a[64:67], v[48:51]
    ds_read_b64_tr_b16 a[14:15], v12 offset:25120
    s_lshl_b32 s69, s71, 8
    v_mfma_f32_16x16x32_bf16 v[104:107], a[16:19], a[68:71], v[104:107]
    v_add_u32 v14, s76, v11
    s_add_u32 s68, s68, s69
    v_mfma_f32_16x16x32_bf16 v[160:163], a[16:19], a[72:75], v[160:163]
    s_sub_u32 s68, s68, 6144
    v_mfma_f32_16x16x32_bf16 v[216:219], a[16:19], a[76:79], v[216:219]
    ds_read_b64_tr_b16 a[16:17], v12 offset:7232
    s_lshl_b32 s69, s71, 10
    v_mfma_f32_16x16x32_bf16 v[52:55], a[20:23], a[64:67], v[52:55]
    ds_read_b64_tr_b16 a[18:19], v12 offset:10816
    v_and_b32 v16, 15, v1
    v_mfma_f32_16x16x32_bf16 v[108:111], a[20:23], a[68:71], v[108:111]
    v_lshrrev_b32 v17, 4, v0
    v_mfma_f32_16x16x32_bf16 v[164:167], a[20:23], a[72:75], v[164:167]
    buffer_load_dwordx4 v8, s[56:59], s72 offen offset:1024 lds
    v_lshlrev_b32 v18, 13, v17
    v_mfma_f32_16x16x32_bf16 v[220:223], a[20:23], a[76:79], v[220:223]
    ds_read_b64_tr_b16 a[20:21], v12 offset:21568
    v_lshl_add_u32 v18, v16, 4, v18
    v_mfma_f32_16x16x32_bf16 v[56:59], a[24:27], a[64:67], v[56:59]
    ds_read_b64_tr_b16 a[22:23], v12 offset:25152
    v_add_u32 v18, s68, v18
    v_mfma_f32_16x16x32_bf16 v[112:115], a[24:27], a[68:71], v[112:115]
    v_lshlrev_b32 v19, 6, v16
    v_mfma_f32_16x16x32_bf16 v[168:171], a[24:27], a[72:75], v[168:171]
    s_lshl_b32 s67, s34, 12
    v_mfma_f32_16x16x32_bf16 v[224:227], a[24:27], a[76:79], v[224:227]
    ds_read_b64_tr_b16 a[24:25], v12 offset:7264
    s_add_u32 s52, s12, s67
    s_addc_u32 s53, s13, 0
    v_mfma_f32_16x16x32_bf16 v[60:63], a[28:31], a[64:67], v[60:63]
    ds_read_b64_tr_b16 a[26:27], v12 offset:10848
    s_sub_u32 s54, 4194304, s67
    v_mfma_f32_16x16x32_bf16 v[116:119], a[28:31], a[68:71], v[116:119]
    s_mov_b32 s55, 0x20000
    v_mfma_f32_16x16x32_bf16 v[172:175], a[28:31], a[72:75], v[172:175]
    buffer_load_dwordx4 v9, s[56:59], s72 offen offset:2048 lds
    s_add_u32 s72, s72, 458752
    s_add_u32 s73, s73, 28672
    s_cmp_ge_u32 s73, s75
    s_cselect_b32 s73, s74, s73
    v_add_u32 v22, v22, v23
    v_mfma_f32_16x16x32_bf16 v[228:231], a[28:31], a[76:79], v[228:231]
    ds_read_b64_tr_b16 a[28:29], v12 offset:21600
    v_min_u32 v25, v22, v24
    s_waitcnt lgkmcnt(8)
    v_mfma_f32_16x16x32_bf16 v[64:67], a[32:35], a[64:67], v[64:67]
    ds_read_b64_tr_b16 a[30:31], v12 offset:25184
    v_add_co_u32 v26, vcc, v20, v25
    v_mfma_f32_16x16x32_bf16 v[120:123], a[32:35], a[68:71], v[120:123]
    s_nop 0
    v_mfma_f32_16x16x32_bf16 v[176:179], a[32:35], a[72:75], v[176:179]
    v_addc_co_u32 v27, vcc, 0, v21, vcc
    v_mfma_f32_16x16x32_bf16 v[232:235], a[32:35], a[76:79], v[232:235]
    ds_read_b64_tr_b16 a[32:33], v12 offset:7296
    global_load_dword v31, v[26:27], off
    v_mfma_f32_16x16x32_bf16 v[68:71], a[36:39], a[64:67], v[68:71]
    ds_read_b64_tr_b16 a[34:35], v12 offset:10880
    v_mfma_f32_16x16x32_bf16 v[124:127], a[36:39], a[68:71], v[124:127]
    v_mfma_f32_16x16x32_bf16 v[180:183], a[36:39], a[72:75], v[180:183]
    v_mfma_f32_16x16x32_bf16 v[236:239], a[36:39], a[76:79], v[236:239]
    ds_read_b64_tr_b16 a[36:37], v12 offset:21632
    v_mfma_f32_16x16x32_bf16 v[72:75], a[40:43], a[64:67], v[72:75]
    ds_read_b64_tr_b16 a[38:39], v12 offset:25216
    v_mfma_f32_16x16x32_bf16 v[76:79], a[44:47], a[64:67], v[76:79]
    v_mfma_f32_16x16x32_bf16 v[80:83], a[48:51], a[64:67], v[80:83]
    v_mfma_f32_16x16x32_bf16 v[84:87], a[52:55], a[64:67], v[84:87]
    buffer_load_dwordx4 a[64:67], v10, s[36:39], s77 offen offset:0 sc1
    v_mfma_f32_16x16x32_bf16 v[128:131], a[40:43], a[68:71], v[128:131]
    v_mfma_f32_16x16x32_bf16 v[132:135], a[44:47], a[68:71], v[132:135]
    v_mfma_f32_16x16x32_bf16 v[136:139], a[48:51], a[68:71], v[136:139]
    v_mfma_f32_16x16x32_bf16 v[140:143], a[52:55], a[68:71], v[140:143]
    buffer_load_dwordx4 a[68:71], v10, s[36:39], s77 offen offset:1024 sc1
    v_mfma_f32_16x16x32_bf16 v[184:187], a[40:43], a[72:75], v[184:187]
    v_mfma_f32_16x16x32_bf16 v[188:191], a[44:47], a[72:75], v[188:191]
    v_mfma_f32_16x16x32_bf16 v[192:195], a[48:51], a[72:75], v[192:195]
    v_mfma_f32_16x16x32_bf16 v[196:199], a[52:55], a[72:75], v[196:199]
    buffer_load_dwordx4 a[72:75], v10, s[36:39], s77 offen offset:2048 sc1
    v_mfma_f32_16x16x32_bf16 v[240:243], a[40:43], a[76:79], v[240:243]
    ds_read_b64_tr_b16 a[40:41], v12 offset:7328
    v_mfma_f32_16x16x32_bf16 v[244:247], a[44:47], a[76:79], v[244:247]
    ds_read_b64_tr_b16 a[44:45], v12 offset:21664
    v_mfma_f32_16x16x32_bf16 v[248:251], a[48:51], a[76:79], v[248:251]
    ds_read_b64_tr_b16 a[48:49], v12 offset:7360
    v_mfma_f32_16x16x32_bf16 v[252:255], a[52:55], a[76:79], v[252:255]
    ds_read_b64_tr_b16 a[52:53], v12 offset:21696
    s_waitcnt vmcnt(23) lgkmcnt(4)
    v_mfma_f32_16x16x32_bf16 v[32:35], a[0:3], a[80:83], v[32:35]
    buffer_load_dwordx4 a[76:79], v10, s[36:39], s77 offen offset:3072 sc1
    s_add_u32 s77, s77, 4096
    v_mfma_f32_16x16x32_bf16 v[88:91], a[0:3], a[84:87], v[88:91]
    s_waitcnt vmcnt(36)
    v_mfma_f32_16x16x32_bf16 v[144:147], a[0:3], a[88:91], v[144:147]
    s_barrier
    v_mfma_f32_16x16x32_bf16 v[200:203], a[0:3], a[92:95], v[200:203]
    ds_read_b64_tr_b16 a[0:1], v14 offset:0
    v_mfma_f32_16x16x32_bf16 v[36:39], a[4:7], a[80:83], v[36:39]
    ds_read_b64_tr_b16 a[2:3], v14 offset:3584
    v_mfma_f32_16x16x32_bf16 v[92:95], a[4:7], a[84:87], v[92:95]
    ds_read_b64_tr_b16 a[42:43], v12 offset:10912
    v_mfma_f32_16x16x32_bf16 v[148:151], a[4:7], a[88:91], v[148:151]
    ds_read_b64_tr_b16 a[46:47], v12 offset:25248
    v_mfma_f32_16x16x32_bf16 v[204:207], a[4:7], a[92:95], v[204:207]
    ds_read_b64_tr_b16 a[4:5], v14 offset:14336
    v_mfma_f32_16x16x32_bf16 v[40:43], a[8:11], a[80:83], v[40:43]
    ds_read_b64_tr_b16 a[6:7], v14 offset:17920
    v_mfma_f32_16x16x32_bf16 v[96:99], a[8:11], a[84:87], v[96:99]
    ds_read_b64_tr_b16 a[50:51], v12 offset:10944
    v_mfma_f32_16x16x32_bf16 v[152:155], a[8:11], a[88:91], v[152:155]
    ds_read_b64_tr_b16 a[54:55], v12 offset:25280
    v_mfma_f32_16x16x32_bf16 v[208:211], a[8:11], a[92:95], v[208:211]
    ds_read_b64_tr_b16 a[8:9], v14 offset:32
    v_mfma_f32_16x16x32_bf16 v[44:47], a[12:15], a[80:83], v[44:47]
    ds_read_b64_tr_b16 a[10:11], v14 offset:3616
    v_mfma_f32_16x16x32_bf16 v[100:103], a[12:15], a[84:87], v[100:103]
    s_cmp_lg_u32 s35, 1
    s_cbranch_scc1 no_pwp
    v_lshlrev_b32 v30, 5, v1
    s_mov_b32 s66, 8192
    buffer_load_dwordx4 a[56:59], v30, s[60:63], s66 offen sc1
    buffer_load_dwordx4 a[60:63], v30, s[60:63], s66 offen offset:16 sc1
no_pwp:
    v_mfma_f32_16x16x32_bf16 v[156:159], a[12:15], a[88:91], v[156:159]
    v_mfma_f32_16x16x32_bf16 v[212:215], a[12:15], a[92:95], v[212:215]
    ds_read_b64_tr_b16 a[12:13], v14 offset:14368
    v_mfma_f32_16x16x32_bf16 v[48:51], a[16:19], a[80:83], v[48:51]
    ds_read_b64_tr_b16 a[14:15], v14 offset:17952
    v_mfma_f32_16x16x32_bf16 v[104:107], a[16:19], a[84:87], v[104:107]
    v_add_u32 v15, 0, v18
    buffer_load_dwordx4 a[128:131], v15, s[40:43], 0 offen
    v_mfma_f32_16x16x32_bf16 v[160:163], a[16:19], a[88:91], v[160:163]
    v_mfma_f32_16x16x32_bf16 v[216:219], a[16:19], a[92:95], v[216:219]
    ds_read_b64_tr_b16 a[16:17], v14 offset:64
    v_mfma_f32_16x16x32_bf16 v[52:55], a[20:23], a[80:83], v[52:55]
    ds_read_b64_tr_b16 a[18:19], v14 offset:3648
    v_mfma_f32_16x16x32_bf16 v[108:111], a[20:23], a[84:87], v[108:111]
    v_add_u32 v15, 6144, v18
    buffer_load_dwordx4 a[156:159], v15, s[44:47], 0 offen
    v_mfma_f32_16x16x32_bf16 v[164:167], a[20:23], a[88:91], v[164:167]
    v_mfma_f32_16x16x32_bf16 v[220:223], a[20:23], a[92:95], v[220:223]
    ds_read_b64_tr_b16 a[20:21], v14 offset:14400
    v_mfma_f32_16x16x32_bf16 v[56:59], a[24:27], a[80:83], v[56:59]
    ds_read_b64_tr_b16 a[22:23], v14 offset:17984
    v_mfma_f32_16x16x32_bf16 v[112:115], a[24:27], a[84:87], v[112:115]
    v_add_u32 v15, 8192, v18
    buffer_load_dwordx4 a[144:147], v15, s[40:43], 0 offen
    v_mfma_f32_16x16x32_bf16 v[168:171], a[24:27], a[88:91], v[168:171]
    v_mfma_f32_16x16x32_bf16 v[224:227], a[24:27], a[92:95], v[224:227]
    ds_read_b64_tr_b16 a[24:25], v14 offset:96
    v_mfma_f32_16x16x32_bf16 v[60:63], a[28:31], a[80:83], v[60:63]
    ds_read_b64_tr_b16 a[26:27], v14 offset:3680
    v_mfma_f32_16x16x32_bf16 v[116:119], a[28:31], a[84:87], v[116:119]
    v_add_u32 v15, 8192, v18
    buffer_load_dwordx4 a[160:163], v15, s[44:47], 0 offen
    v_mfma_f32_16x16x32_bf16 v[172:175], a[28:31], a[88:91], v[172:175]
    v_mfma_f32_16x16x32_bf16 v[228:231], a[28:31], a[92:95], v[228:231]
    ds_read_b64_tr_b16 a[28:29], v14 offset:14432
    s_waitcnt lgkmcnt(8)
    v_mfma_f32_16x16x32_bf16 v[64:67], a[32:35], a[80:83], v[64:67]
    ds_read_b64_tr_b16 a[30:31], v14 offset:18016
    v_mfma_f32_16x16x32_bf16 v[120:123], a[32:35], a[84:87], v[120:123]
    v_add_u32 v15, 2048, v18
    buffer_load_dwordx4 a[132:135], v15, s[40:43], 0 offen
    v_mfma_f32_16x16x32_bf16 v[176:179], a[32:35], a[88:91], v[176:179]
    v_mfma_f32_16x16x32_bf16 v[232:235], a[32:35], a[92:95], v[232:235]
    ds_read_b64_tr_b16 a[32:33], v14 offset:128
    v_mfma_f32_16x16x32_bf16 v[68:71], a[36:39], a[80:83], v[68:71]
    ds_read_b64_tr_b16 a[34:35], v14 offset:3712
    v_mfma_f32_16x16x32_bf16 v[124:127], a[36:39], a[84:87], v[124:127]
    v_add_u32 v15, 10240, v18
    buffer_load_dwordx4 a[164:167], v15, s[44:47], 0 offen
    v_mfma_f32_16x16x32_bf16 v[180:183], a[36:39], a[88:91], v[180:183]
    v_mfma_f32_16x16x32_bf16 v[236:239], a[36:39], a[92:95], v[236:239]
    ds_read_b64_tr_b16 a[36:37], v14 offset:14464
    v_mfma_f32_16x16x32_bf16 v[72:75], a[40:43], a[80:83], v[72:75]
    ds_read_b64_tr_b16 a[38:39], v14 offset:18048
    v_mfma_f32_16x16x32_bf16 v[76:79], a[44:47], a[80:83], v[76:79]
    v_mfma_f32_16x16x32_bf16 v[80:83], a[48:51], a[80:83], v[80:83]
    v_mfma_f32_16x16x32_bf16 v[84:87], a[52:55], a[80:83], v[84:87]
    buffer_load_dwordx4 a[80:83], v10, s[36:39], s77 offen offset:0 sc1
    v_mfma_f32_16x16x32_bf16 v[128:131], a[40:43], a[84:87], v[128:131]
    v_mfma_f32_16x16x32_bf16 v[132:135], a[44:47], a[84:87], v[132:135]
    v_mfma_f32_16x16x32_bf16 v[136:139], a[48:51], a[84:87], v[136:139]
    v_mfma_f32_16x16x32_bf16 v[140:143], a[52:55], a[84:87], v[140:143]
    buffer_load_dwordx4 a[84:87], v10, s[36:39], s77 offen offset:1024 sc1
    v_mfma_f32_16x16x32_bf16 v[184:187], a[40:43], a[88:91], v[184:187]
    v_mfma_f32_16x16x32_bf16 v[188:191], a[44:47], a[88:91], v[188:191]
    v_mfma_f32_16x16x32_bf16 v[192:195], a[48:51], a[88:91], v[192:195]
    v_mfma_f32_16x16x32_bf16 v[196:199], a[52:55], a[88:91], v[196:199]
    buffer_load_dwordx4 a[88:91], v10, s[36:39], s77 offen offset:2048 sc1
    v_mfma_f32_16x16x32_bf16 v[240:243], a[40:43], a[92:95], v[240:243]
    ds_read_b64_tr_b16 a[40:41], v14 offset:160
    v_mfma_f32_16x16x32_bf16 v[244:247], a[44:47], a[92:95], v[244:247]
    ds_read_b64_tr_b16 a[44:45], v14 offset:14496
    v_mfma_f32_16x16x32_bf16 v[248:251], a[48:51], a[92:95], v[248:251]
    ds_read_b64_tr_b16 a[48:49], v14 offset:192
    v_mfma_f32_16x16x32_bf16 v[252:255], a[52:55], a[92:95], v[252:255]
    ds_read_b64_tr_b16 a[52:53], v14 offset:14528
    s_waitcnt vmcnt(25) lgkmcnt(4)
    v_mfma_f32_16x16x32_bf16 v[32:35], a[0:3], a[96:99], v[32:35]
    buffer_load_dwordx4 a[92:95], v10, s[36:39], s77 offen offset:3072 sc1
    s_add_u32 s77, s77, 4096
    v_mfma_f32_16x16x32_bf16 v[88:91], a[0:3], a[100:103], v[88:91]
    ds_read_b64_tr_b16 a[42:43], v14 offset:3744
    v_mfma_f32_16x16x32_bf16 v[144:147], a[0:3], a[104:107], v[144:147]
    v_add_u32 v15, 10240, v18
    buffer_load_dwordx4 a[148:151], v15, s[40:43], 0 offen
    v_mfma_f32_16x16x32_bf16 v[200:203], a[0:3], a[108:111], v[200:203]
    ds_read_b64_tr_b16 a[0:1], v14 offset:7168
    v_mfma_f32_16x16x32_bf16 v[36:39], a[4:7], a[96:99], v[36:39]
    ds_read_b64_tr_b16 a[2:3], v14 offset:10752
    v_mfma_f32_16x16x32_bf16 v[92:95], a[4:7], a[100:103], v[92:95]
    ds_read_b64_tr_b16 a[46:47], v14 offset:18080
    v_mfma_f32_16x16x32_bf16 v[148:151], a[4:7], a[104:107], v[148:151]
    ds_read_b64_tr_b16 a[50:51], v14 offset:3776
    v_mfma_f32_16x16x32_bf16 v[204:207], a[4:7], a[108:111], v[204:207]
    ds_read_b64_tr_b16 a[4:5], v14 offset:21504
    v_mfma_f32_16x16x32_bf16 v[40:43], a[8:11], a[96:99], v[40:43]
    ds_read_b64_tr_b16 a[6:7], v14 offset:25088
    v_mfma_f32_16x16x32_bf16 v[96:99], a[8:11], a[100:103], v[96:99]
    ds_read_b64_tr_b16 a[54:55], v14 offset:18112
    v_mfma_f32_16x16x32_bf16 v[152:155], a[8:11], a[104:107], v[152:155]
    v_add_u32 v22, v22, v23
    v_mfma_f32_16x16x32_bf16 v[208:211], a[8:11], a[108:111], v[208:211]
    ds_read_b64_tr_b16 a[8:9], v14 offset:7200
    v_mfma_f32_16x16x32_bf16 v[44:47], a[12:15], a[96:99], v[44:47]
    ds_read_b64_tr_b16 a[10:11], v14 offset:10784
    v_mfma_f32_16x16x32_bf16 v[100:103], a[12:15], a[100:103], v[100:103]
    s_add_u32 s76, s76, 28672
    v_mfma_f32_16x16x32_bf16 v[156:159], a[12:15], a[104:107], v[156:159]
    s_cmp_ge_u32 s76, 143360
    s_cselect_b32 s76, 0, s76
    v_mfma_f32_16x16x32_bf16 v[212:215], a[12:15], a[108:111], v[212:215]
    ds_read_b64_tr_b16 a[12:13], v14 offset:21536
    v_mfma_f32_16x16x32_bf16 v[48:51], a[16:19], a[96:99], v[48:51]
    ds_read_b64_tr_b16 a[14:15], v14 offset:25120
    v_mfma_f32_16x16x32_bf16 v[104:107], a[16:19], a[100:103], v[104:107]
    v_add_u32 v12, s76, v11
    v_mfma_f32_16x16x32_bf16 v[160:163], a[16:19], a[104:107], v[160:163]
    v_add_u32 v15, 12288, v18
    buffer_load_dwordx4 a[168:171], v15, s[44:47], 0 offen
    v_mfma_f32_16x16x32_bf16 v[216:219], a[16:19], a[108:111], v[216:219]
    ds_read_b64_tr_b16 a[16:17], v14 offset:7232
    v_mfma_f32_16x16x32_bf16 v[52:55], a[20:23], a[96:99], v[52:55]
    ds_read_b64_tr_b16 a[18:19], v14 offset:10816
    v_mfma_f32_16x16x32_bf16 v[108:111], a[20:23], a[100:103], v[108:111]
    v_min_u32 v25, v22, v24
    v_mfma_f32_16x16x32_bf16 v[164:167], a[20:23], a[104:107], v[164:167]
    v_add_u32 v15, 4096, v18
    buffer_load_dwordx4 a[136:139], v15, s[40:43], 0 offen
    v_mfma_f32_16x16x32_bf16 v[220:223], a[20:23], a[108:111], v[220:223]
    ds_read_b64_tr_b16 a[20:21], v14 offset:21568
    v_mfma_f32_16x16x32_bf16 v[56:59], a[24:27], a[96:99], v[56:59]
    ds_read_b64_tr_b16 a[22:23], v14 offset:25152
    v_mfma_f32_16x16x32_bf16 v[112:115], a[24:27], a[100:103], v[112:115]
    v_add_co_u32 v26, vcc, v20, v25
    v_mfma_f32_16x16x32_bf16 v[168:171], a[24:27], a[104:107], v[168:171]
    v_add_u32 v15, 12288, v18
    buffer_load_dwordx4 a[152:155], v15, s[40:43], 0 offen
    v_mfma_f32_16x16x32_bf16 v[224:227], a[24:27], a[108:111], v[224:227]
    ds_read_b64_tr_b16 a[24:25], v14 offset:7264
    v_mfma_f32_16x16x32_bf16 v[60:63], a[28:31], a[96:99], v[60:63]
    ds_read_b64_tr_b16 a[26:27], v14 offset:10848
    v_mfma_f32_16x16x32_bf16 v[116:119], a[28:31], a[100:103], v[116:119]
    s_nop 0
    v_mfma_f32_16x16x32_bf16 v[172:175], a[28:31], a[104:107], v[172:175]
    v_add_u32 v15, 6144, v18
    buffer_load_dwordx4 a[140:143], v15, s[40:43], 0 offen
    v_mfma_f32_16x16x32_bf16 v[228:231], a[28:31], a[108:111], v[228:231]
    ds_read_b64_tr_b16 a[28:29], v14 offset:21600
    s_waitcnt lgkmcnt(8)
    v_mfma_f32_16x16x32_bf16 v[64:67], a[32:35], a[96:99], v[64:67]
    ds_read_b64_tr_b16 a[30:31], v14 offset:25184
    v_mfma_f32_16x16x32_bf16 v[120:123], a[32:35], a[100:103], v[120:123]
    v_addc_co_u32 v27, vcc, 0, v21, vcc
    v_mfma_f32_16x16x32_bf16 v[176:179], a[32:35], a[104:107], v[176:179]
    buffer_load_dwordx4 a[172:175], v19, s[48:51], s69 offen offset:0
    v_mfma_f32_16x16x32_bf16 v[232:235], a[32:35], a[108:111], v[232:235]
    ds_read_b64_tr_b16 a[32:33], v14 offset:7296
    v_mfma_f32_16x16x32_bf16 v[68:71], a[36:39], a[96:99], v[68:71]
    ds_read_b64_tr_b16 a[34:35], v14 offset:10880
    v_mfma_f32_16x16x32_bf16 v[124:127], a[36:39], a[100:103], v[124:127]
    global_load_dword v31, v[26:27], off
    v_mfma_f32_16x16x32_bf16 v[180:183], a[36:39], a[104:107], v[180:183]
    v_mfma_f32_16x16x32_bf16 v[236:239], a[36:39], a[108:111], v[236:239]
    ds_read_b64_tr_b16 a[36:37], v14 offset:21632
    v_mfma_f32_16x16x32_bf16 v[72:75], a[40:43], a[96:99], v[72:75]
    ds_read_b64_tr_b16 a[38:39], v14 offset:25216
    v_mfma_f32_16x16x32_bf16 v[76:79], a[44:47], a[96:99], v[76:79]
    v_mfma_f32_16x16x32_bf16 v[80:83], a[48:51], a[96:99], v[80:83]
    v_mfma_f32_16x16x32_bf16 v[84:87], a[52:55], a[96:99], v[84:87]
    buffer_load_dwordx4 a[96:99], v10, s[36:39], s77 offen offset:0 sc1
    v_mfma_f32_16x16x32_bf16 v[128:131], a[40:43], a[100:103], v[128:131]
    v_mfma_f32_16x16x32_bf16 v[132:135], a[44:47], a[100:103], v[132:135]
    v_mfma_f32_16x16x32_bf16 v[136:139], a[48:51], a[100:103], v[136:139]
    v_mfma_f32_16x16x32_bf16 v[140:143], a[52:55], a[100:103], v[140:143]
    buffer_load_dwordx4 a[100:103], v10, s[36:39], s77 offen offset:1024 sc1
    v_mfma_f32_16x16x32_bf16 v[184:187], a[40:43], a[104:107], v[184:187]
    v_mfma_f32_16x16x32_bf16 v[188:191], a[44:47], a[104:107], v[188:191]
    v_mfma_f32_16x16x32_bf16 v[192:195], a[48:51], a[104:107], v[192:195]
    v_mfma_f32_16x16x32_bf16 v[196:199], a[52:55], a[104:107], v[196:199]
    buffer_load_dwordx4 a[104:107], v10, s[36:39], s77 offen offset:2048 sc1
    v_mfma_f32_16x16x32_bf16 v[240:243], a[40:43], a[108:111], v[240:243]
    ds_read_b64_tr_b16 a[40:41], v14 offset:7328
    v_mfma_f32_16x16x32_bf16 v[244:247], a[44:47], a[108:111], v[244:247]
    ds_read_b64_tr_b16 a[44:45], v14 offset:21664
    v_mfma_f32_16x16x32_bf16 v[248:251], a[48:51], a[108:111], v[248:251]
    ds_read_b64_tr_b16 a[48:49], v14 offset:7360
    v_mfma_f32_16x16x32_bf16 v[252:255], a[52:55], a[108:111], v[252:255]
    ds_read_b64_tr_b16 a[52:53], v14 offset:21696
    s_waitcnt vmcnt(28) lgkmcnt(4)
    v_mfma_f32_16x16x32_bf16 v[32:35], a[0:3], a[112:115], v[32:35]
    buffer_load_dwordx4 a[108:111], v10, s[36:39], s77 offen offset:3072 sc1
    s_add_u32 s77, s77, 4096
    v_mfma_f32_16x16x32_bf16 v[88:91], a[0:3], a[116:119], v[88:91]
    s_waitcnt vmcnt(41)
    v_mfma_f32_16x16x32_bf16 v[144:147], a[0:3], a[120:123], v[144:147]
    s_barrier
    v_mfma_f32_16x16x32_bf16 v[200:203], a[0:3], a[124:127], v[200:203]
    ds_read_b64_tr_b16 a[0:1], v12 offset:0
    v_mfma_f32_16x16x32_bf16 v[36:39], a[4:7], a[112:115], v[36:39]
    ds_read_b64_tr_b16 a[2:3], v12 offset:3584
    v_mfma_f32_16x16x32_bf16 v[92:95], a[4:7], a[116:119], v[92:95]
    ds_read_b64_tr_b16 a[42:43], v14 offset:10912
    v_mfma_f32_16x16x32_bf16 v[148:151], a[4:7], a[120:123], v[148:151]
    ds_read_b64_tr_b16 a[46:47], v14 offset:25248
    v_mfma_f32_16x16x32_bf16 v[204:207], a[4:7], a[124:127], v[204:207]
    ds_read_b64_tr_b16 a[4:5], v12 offset:14336
    v_mfma_f32_16x16x32_bf16 v[40:43], a[8:11], a[112:115], v[40:43]
    ds_read_b64_tr_b16 a[6:7], v12 offset:17920
    v_mfma_f32_16x16x32_bf16 v[96:99], a[8:11], a[116:119], v[96:99]
    ds_read_b64_tr_b16 a[50:51], v14 offset:10944
    v_mfma_f32_16x16x32_bf16 v[152:155], a[8:11], a[120:123], v[152:155]
    ds_read_b64_tr_b16 a[54:55], v14 offset:25280
    v_mfma_f32_16x16x32_bf16 v[208:211], a[8:11], a[124:127], v[208:211]
    ds_read_b64_tr_b16 a[8:9], v12 offset:32
    v_mfma_f32_16x16x32_bf16 v[44:47], a[12:15], a[112:115], v[44:47]
    ds_read_b64_tr_b16 a[10:11], v12 offset:3616
    v_mfma_f32_16x16x32_bf16 v[100:103], a[12:15], a[116:119], v[100:103]
    buffer_load_dwordx4 a[176:179], v19, s[48:51], s69 offen offset:16
    v_mfma_f32_16x16x32_bf16 v[156:159], a[12:15], a[120:123], v[156:159]
    v_mfma_f32_16x16x32_bf16 v[212:215], a[12:15], a[124:127], v[212:215]
    ds_read_b64_tr_b16 a[12:13], v12 offset:14368
    v_mfma_f32_16x16x32_bf16 v[48:51], a[16:19], a[112:115], v[48:51]
    ds_read_b64_tr_b16 a[14:15], v12 offset:17952
    v_mfma_f32_16x16x32_bf16 v[104:107], a[16:19], a[116:119], v[104:107]
    buffer_load_dwordx4 a[180:183], v19, s[48:51], s69 offen offset:32
    v_mfma_f32_16x16x32_bf16 v[160:163], a[16:19], a[120:123], v[160:163]
    v_mfma_f32_16x16x32_bf16 v[216:219], a[16:19], a[124:127], v[216:219]
    ds_read_b64_tr_b16 a[16:17], v12 offset:64
    v_mfma_f32_16x16x32_bf16 v[52:55], a[20:23], a[112:115], v[52:55]
    ds_read_b64_tr_b16 a[18:19], v12 offset:3648
    v_mfma_f32_16x16x32_bf16 v[108:111], a[20:23], a[116:119], v[108:111]
    buffer_load_dwordx4 a[184:187], v19, s[48:51], s69 offen offset:48
    v_mfma_f32_16x16x32_bf16 v[164:167], a[20:23], a[120:123], v[164:167]
    v_mfma_f32_16x16x32_bf16 v[220:223], a[20:23], a[124:127], v[220:223]
    ds_read_b64_tr_b16 a[20:21], v12 offset:14400
    v_mfma_f32_16x16x32_bf16 v[56:59], a[24:27], a[112:115], v[56:59]
    ds_read_b64_tr_b16 a[22:23], v12 offset:17984
    v_mfma_f32_16x16x32_bf16 v[112:115], a[24:27], a[116:119], v[112:115]
    v_mfma_f32_16x16x32_bf16 v[168:171], a[24:27], a[120:123], v[168:171]
    s_mov_b32 s17, 0
    buffer_load_dwordx4 a[188:191], v10, s[52:55], s17 offen offset:0
    v_mfma_f32_16x16x32_bf16 v[224:227], a[24:27], a[124:127], v[224:227]
    ds_read_b64_tr_b16 a[24:25], v12 offset:96
    v_mfma_f32_16x16x32_bf16 v[60:63], a[28:31], a[112:115], v[60:63]
    ds_read_b64_tr_b16 a[26:27], v12 offset:3680
    v_mfma_f32_16x16x32_bf16 v[116:119], a[28:31], a[116:119], v[116:119]
    v_mfma_f32_16x16x32_bf16 v[172:175], a[28:31], a[120:123], v[172:175]
    s_mov_b32 s17, 4
    buffer_load_dwordx4 a[204:207], v10, s[52:55], s17 offen offset:0
    v_mfma_f32_16x16x32_bf16 v[228:231], a[28:31], a[124:127], v[228:231]
    ds_read_b64_tr_b16 a[28:29], v12 offset:14432
    s_waitcnt lgkmcnt(8)
    v_mfma_f32_16x16x32_bf16 v[64:67], a[32:35], a[112:115], v[64:67]
    ds_read_b64_tr_b16 a[30:31], v12 offset:18016
    v_mfma_f32_16x16x32_bf16 v[120:123], a[32:35], a[116:119], v[120:123]
    v_mfma_f32_16x16x32_bf16 v[176:179], a[32:35], a[120:123], v[176:179]
    s_mov_b32 s17, 0
    buffer_load_dwordx4 a[192:195], v10, s[52:55], s17 offen offset:1024
    v_mfma_f32_16x16x32_bf16 v[232:235], a[32:35], a[124:127], v[232:235]
    ds_read_b64_tr_b16 a[32:33], v12 offset:128
    v_mfma_f32_16x16x32_bf16 v[68:71], a[36:39], a[112:115], v[68:71]
    ds_read_b64_tr_b16 a[34:35], v12 offset:3712
    v_mfma_f32_16x16x32_bf16 v[124:127], a[36:39], a[116:119], v[124:127]
    v_mfma_f32_16x16x32_bf16 v[180:183], a[36:39], a[120:123], v[180:183]
    v_mfma_f32_16x16x32_bf16 v[236:239], a[36:39], a[124:127], v[236:239]
    ds_read_b64_tr_b16 a[36:37], v12 offset:14464
    v_mfma_f32_16x16x32_bf16 v[72:75], a[40:43], a[112:115], v[72:75]
    ds_read_b64_tr_b16 a[38:39], v12 offset:18048
    v_mfma_f32_16x16x32_bf16 v[76:79], a[44:47], a[112:115], v[76:79]
    v_mfma_f32_16x16x32_bf16 v[80:83], a[48:51], a[112:115], v[80:83]
    v_mfma_f32_16x16x32_bf16 v[84:87], a[52:55], a[112:115], v[84:87]
    buffer_load_dwordx4 a[112:115], v10, s[36:39], s77 offen offset:0 sc1
    v_mfma_f32_16x16x32_bf16 v[128:131], a[40:43], a[116:119], v[128:131]
    v_mfma_f32_16x16x32_bf16 v[132:135], a[44:47], a[116:119], v[132:135]
    v_mfma_f32_16x16x32_bf16 v[136:139], a[48:51], a[116:119], v[136:139]
    v_mfma_f32_16x16x32_bf16 v[140:143], a[52:55], a[116:119], v[140:143]
    buffer_load_dwordx4 a[116:119], v10, s[36:39], s77 offen offset:1024 sc1
    v_mfma_f32_16x16x32_bf16 v[184:187], a[40:43], a[120:123], v[184:187]
    v_mfma_f32_16x16x32_bf16 v[188:191], a[44:47], a[120:123], v[188:191]
    v_mfma_f32_16x16x32_bf16 v[192:195], a[48:51], a[120:123], v[192:195]
    v_mfma_f32_16x16x32_bf16 v[196:199], a[52:55], a[120:123], v[196:199]
    buffer_load_dwordx4 a[120:123], v10, s[36:39], s77 offen offset:2048 sc1
    v_mfma_f32_16x16x32_bf16 v[240:243], a[40:43], a[124:127], v[240:243]
    ds_read_b64_tr_b16 a[40:41], v12 offset:160
    v_mfma_f32_16x16x32_bf16 v[244:247], a[44:47], a[124:127], v[244:247]
    ds_read_b64_tr_b16 a[44:45], v12 offset:14496
    v_mfma_f32_16x16x32_bf16 v[248:251], a[48:51], a[124:127], v[248:251]
    ds_read_b64_tr_b16 a[48:49], v12 offset:192
    v_mfma_f32_16x16x32_bf16 v[252:255], a[52:55], a[124:127], v[252:255]
    ds_read_b64_tr_b16 a[52:53], v12 offset:14528
    s_waitcnt vmcnt(30) lgkmcnt(4)
    v_mfma_f32_16x16x32_bf16 v[32:35], a[0:3], a[64:67], v[32:35]
    buffer_load_dwordx4 a[124:127], v10, s[36:39], s77 offen offset:3072 sc1
    s_add_u32 s77, s77, 4096
    v_mfma_f32_16x16x32_bf16 v[88:91], a[0:3], a[68:71], v[88:91]
    ds_read_b64_tr_b16 a[42:43], v12 offset:3744
    v_mfma_f32_16x16x32_bf16 v[144:147], a[0:3], a[72:75], v[144:147]
    s_cmp_lg_u32 s35, 1
    s_cbranch_scc1 wp_seen
    s_waitcnt vmcnt(30)
    s_mov_b32 s17, 0
wp_chk:
    v_accvgpr_read_b32 v20, a56
    v_accvgpr_read_b32 v21, a57
    v_cmp_ne_u64 vcc, s[64:65], v[20:21]
    s_nop 1
    s_mov_b64 s[78:79], vcc
    v_accvgpr_read_b32 v20, a58
    v_accvgpr_read_b32 v21, a59
    v_cmp_ne_u64 vcc, s[64:65], v[20:21]
    s_nop 1
    s_or_b64 s[78:79], s[78:79], vcc
    v_accvgpr_read_b32 v20, a60
    v_accvgpr_read_b32 v21, a61
    v_cmp_ne_u64 vcc, s[64:65], v[20:21]
    s_nop 1
    s_or_b64 s[78:79], s[78:79], vcc
    v_accvgpr_read_b32 v20, a62
    v_accvgpr_read_b32 v21, a63
    v_cmp_ne_u64 vcc, s[64:65], v[20:21]
    s_nop 1
    s_or_b64 s[78:79], s[78:79], vcc
    s_cbranch_scc0 wp_go
    s_add_u32 s17, s17, 1
    s_cmp_ge_u32 s17, 0x40000
    s_cbranch_scc1 wp_go
    s_mov_b32 s66, 8192
    buffer_load_dwordx4 a[56:59], v30, s[60:63], s66 offen sc1
    buffer_load_dwordx4 a[60:63], v30, s[60:63], s66 offen offset:16 sc1
    s_waitcnt vmcnt(0)
    s_branch wp_chk
wp_go:
    buffer_inv sc1
wp_seen:
    v_mfma_f32_16x16x32_bf16 v[200:203], a[0:3], a[76:79], v[200:203]
    ds_read_b64_tr_b16 a[0:1], v12 offset:7168
    v_mfma_f32_16x16x32_bf16 v[36:39], a[4:7], a[64:67], v[36:39]
    ds_read_b64_tr_b16 a[2:3], v12 offset:10752
    v_mfma_f32_16x16x32_bf16 v[92:95], a[4:7], a[68:71], v[92:95]
    ds_read_b64_tr_b16 a[46:47], v12 offset:18080
    v_mfma_f32_16x16x32_bf16 v[148:151], a[4:7], a[72:75], v[148:151]
    ds_read_b64_tr_b16 a[50:51], v12 offset:3776
    v_mfma_f32_16x16x32_bf16 v[204:207], a[4:7], a[76:79], v[204:207]
    ds_read_b64_tr_b16 a[4:5], v12 offset:21504
    v_mfma_f32_16x16x32_bf16 v[40:43], a[8:11], a[64:67], v[40:43]
    ds_read_b64_tr_b16 a[6:7], v12 offset:25088
    v_mfma_f32_16x16x32_bf16 v[96:99], a[8:11], a[68:71], v[96:99]
    ds_read_b64_tr_b16 a[54:55], v12 offset:18112
    v_mfma_f32_16x16x32_bf16 v[152:155], a[8:11], a[72:75], v[152:155]
    v_mfma_f32_16x16x32_bf16 v[208:211], a[8:11], a[76:79], v[208:211]
    ds_read_b64_tr_b16 a[8:9], v12 offset:7200
    v_mfma_f32_16x16x32_bf16 v[44:47], a[12:15], a[64:67], v[44:47]
    ds_read_b64_tr_b16 a[10:11], v12 offset:10784
    v_mfma_f32_16x16x32_bf16 v[100:103], a[12:15], a[68:71], v[100:103]
    s_add_u32 s76, s76, 28672
    v_mfma_f32_16x16x32_bf16 v[156:159], a[12:15], a[72:75], v[156:159]
    s_cmp_ge_u32 s76, 143360
    s_cselect_b32 s76, 0, s76
    v_mfma_f32_16x16x32_bf16 v[212:215], a[12:15], a[76:79], v[212:215]
    ds_read_b64_tr_b16 a[12:13], v12 offset:21536
    v_mfma_f32_16x16x32_bf16 v[48:51], a[16:19], a[64:67], v[48:51]
    ds_read_b64_tr_b16 a[14:15], v12 offset:25120
    v_mfma_f32_16x16x32_bf16 v[104:107], a[16:19], a[68:71], v[104:107]
    v_add_u32 v14, s76, v11
    v_mfma_f32_16x16x32_bf16 v[160:163], a[16:19], a[72:75], v[160:163]
    v_mfma_f32_16x16x32_bf16 v[216:219], a[16:19], a[76:79], v[216:219]
    ds_read_b64_tr_b16 a[16:17], v12 offset:7232
    v_mfma_f32_16x16x32_bf16 v[52:55], a[20:23], a[64:67], v[52:55]
    ds_read_b64_tr_b16 a[18:19], v12 offset:10816
    v_mfma_f32_16x16x32_bf16 v[108:111], a[20:23], a[68:71], v[108:111]
    v_mfma_f32_16x16x32_bf16 v[164:167], a[20:23], a[72:75], v[164:167]
    s_mov_b32 s17, 4
    buffer_load_dwordx4 a[208:211], v10, s[52:55], s17 offen offset:1024
    v_mfma_f32_16x16x32_bf16 v[220:223], a[20:23], a[76:79], v[220:223]
    ds_read_b64_tr_b16 a[20:21], v12 offset:21568
    v_mfma_f32_16x16x32_bf16 v[56:59], a[24:27], a[64:67], v[56:59]
    ds_read_b64_tr_b16 a[22:23], v12 offset:25152
    v_mfma_f32_16x16x32_bf16 v[112:115], a[24:27], a[68:71], v[112:115]
    v_mfma_f32_16x16x32_bf16 v[168:171], a[24:27], a[72:75], v[168:171]
    v_mfma_f32_16x16x32_bf16 v[224:227], a[24:27], a[76:79], v[224:227]
    ds_read_b64_tr_b16 a[24:25], v12 offset:7264
    v_mfma_f32_16x16x32_bf16 v[60:63], a[28:31], a[64:67], v[60:63]
    ds_read_b64_tr_b16 a[26:27], v12 offset:10848
    v_mfma_f32_16x16x32_bf16 v[116:119], a[28:31], a[68:71], v[116:119]
    v_mfma_f32_16x16x32_bf16 v[172:175], a[28:31], a[72:75], v[172:175]
    s_mov_b32 s17, 0
    buffer_load_dwordx4 a[196:199], v10, s[52:55], s17 offen offset:2048
    v_mfma_f32_16x16x32_bf16 v[228:231], a[28:31], a[76:79], v[228:231]
    ds_read_b64_tr_b16 a[28:29], v12 offset:21600
    s_waitcnt lgkmcnt(8)
    v_mfma_f32_16x16x32_bf16 v[64:67], a[32:35], a[64:67], v[64:67]
    ds_read_b64_tr_b16 a[30:31], v12 offset:25184
    v_mfma_f32_16x16x32_bf16 v[120:123], a[32:35], a[68:71], v[120:123]
    v_mfma_f32_16x16x32_bf16 v[176:179], a[32:35], a[72:75], v[176:179]
    v_mfma_f32_16x16x32_bf16 v[232:235], a[32:35], a[76:79], v[232:235]
    ds_read_b64_tr_b16 a[32:33], v12 offset:7296
    v_mfma_f32_16x16x32_bf16 v[68:71], a[36:39], a[64:67], v[68:71]
    ds_read_b64_tr_b16 a[34:35], v12 offset:10880
    v_mfma_f32_16x16x32_bf16 v[124:127], a[36:39], a[68:71], v[124:127]
    v_mfma_f32_16x16x32_bf16 v[180:183], a[36:39], a[72:75], v[180:183]
    v_mfma_f32_16x16x32_bf16 v[236:239], a[36:39], a[76:79], v[236:239]
    ds_read_b64_tr_b16 a[36:37], v12 offset:21632
    v_mfma_f32_16x16x32_bf16 v[72:75], a[40:43], a[64:67], v[72:75]
    ds_read_b64_tr_b16 a[38:39], v12 offset:25216
    v_mfma_f32_16x16x32_bf16 v[76:79], a[44:47], a[64:67], v[76:79]
    v_mfma_f32_16x16x32_bf16 v[80:83], a[48:51], a[64:67], v[80:83]
    v_mfma_f32_16x16x32_bf16 v[84:87], a[52:55], a[64:67], v[84:87]
    s_mov_b32 s17, 4
    buffer_load_dwordx4 a[212:215], v10, s[52:55], s17 offen offset:2048
    v_mfma_f32_16x16x32_bf16 v[128:131], a[40:43], a[68:71], v[128:131]
    v_mfma_f32_16x16x32_bf16 v[132:135], a[44:47], a[68:71], v[132:135]
    v_mfma_f32_16x16x32_bf16 v[136:139], a[48:51], a[68:71], v[136:139]
    v_mfma_f32_16x16x32_bf16 v[140:143], a[52:55], a[68:71], v[140:143]
    s_mov_b32 s17, 0
    buffer_load_dwordx4 a[200:203], v10, s[52:55], s17 offen offset:3072
    v_mfma_f32_16x16x32_bf16 v[184:187], a[40:43], a[72:75], v[184:187]
    v_mfma_f32_16x16x32_bf16 v[188:191], a[44:47], a[72:75], v[188:191]
    v_mfma_f32_16x16x32_bf16 v[192:195], a[48:51], a[72:75], v[192:195]
    v_mfma_f32_16x16x32_bf16 v[196:199], a[52:55], a[72:75], v[196:199]
    s_mov_b32 s17, 4
    buffer_load_dwordx4 a[216:219], v10, s[52:55], s17 offen offset:3072
    v_mfma_f32_16x16x32_bf16 v[240:243], a[40:43], a[76:79], v[240:243]
    ds_read_b64_tr_b16 a[40:41], v12 offset:7328
    v_mfma_f32_16x16x32_bf16 v[244:247], a[44:47], a[76:79], v[244:247]
    ds_read_b64_tr_b16 a[44:45], v12 offset:21664
    v_mfma_f32_16x16x32_bf16 v[248:251], a[48:51], a[76:79], v[248:251]
    ds_read_b64_tr_b16 a[48:49], v12 offset:7360
    v_mfma_f32_16x16x32_bf16 v[252:255], a[52:55], a[76:79], v[252:255]
    ds_read_b64_tr_b16 a[52:53], v12 offset:21696
    s_waitcnt vmcnt(26) lgkmcnt(4)
    v_mfma_f32_16x16x32_bf16 v[32:35], a[0:3], a[80:83], v[32:35]
    ds_read_b64_tr_b16 a[42:43], v12 offset:10912
    v_mfma_f32_16x16x32_bf16 v[88:91], a[0:3], a[84:87], v[88:91]
    s_waitcnt vmcnt(41)
    v_mfma_f32_16x16x32_bf16 v[144:147], a[0:3], a[88:91], v[144:147]
    s_barrier
    v_mfma_f32_16x16x32_bf16 v[200:203], a[0:3], a[92:95], v[200:203]
    ds_read_b64_tr_b16 a[0:1], v14 offset:0
    v_mfma_f32_16x16x32_bf16 v[36:39], a[4:7], a[80:83], v[36:39]
    ds_read_b64_tr_b16 a[2:3], v14 offset:3584
    v_mfma_f32_16x16x32_bf16 v[92:95], a[4:7], a[84:87], v[92:95]
    ds_read_b64_tr_b16 a[46:47], v12 offset:25248
    v_mfma_f32_16x16x32_bf16 v[148:151], a[4:7], a[88:91], v[148:151]
    ds_read_b64_tr_b16 a[50:51], v12 offset:10944
    v_mfma_f32_16x16x32_bf16 v[204:207], a[4:7], a[92:95], v[204:207]
    ds_read_b64_tr_b16 a[4:5], v14 offset:14336
    v_mfma_f32_16x16x32_bf16 v[40:43], a[8:11], a[80:83], v[40:43]
    ds_read_b64_tr_b16 a[6:7], v14 offset:17920
    v_mfma_f32_16x16x32_bf16 v[96:99], a[8:11], a[84:87], v[96:99]
    ds_read_b64_tr_b16 a[54:55], v12 offset:25280
    v_mfma_f32_16x16x32_bf16 v[152:155], a[8:11], a[88:91], v[152:155]
    buffer_load_dword a236, v29, s[52:55], 0 offen
    v_mfma_f32_16x16x32_bf16 v[208:211], a[8:11], a[92:95], v[208:211]
    ds_read_b64_tr_b16 a[8:9], v14 offset:32
    v_mfma_f32_16x16x32_bf16 v[44:47], a[12:15], a[80:83], v[44:47]
    ds_read_b64_tr_b16 a[10:11], v14 offset:3616
    v_mfma_f32_16x16x32_bf16 v[100:103], a[12:15], a[84:87], v[100:103]
    v_mfma_f32_16x16x32_bf16 v[156:159], a[12:15], a[88:91], v[156:159]
    v_mfma_f32_16x16x32_bf16 v[212:215], a[12:15], a[92:95], v[212:215]
    ds_read_b64_tr_b16 a[12:13], v14 offset:14368
    v_mfma_f32_16x16x32_bf16 v[48:51], a[16:19], a[80:83], v[48:51]
    ds_read_b64_tr_b16 a[14:15], v14 offset:17952
    v_mfma_f32_16x16x32_bf16 v[104:107], a[16:19], a[84:87], v[104:107]
    v_mfma_f32_16x16x32_bf16 v[160:163], a[16:19], a[88:91], v[160:163]
    v_mfma_f32_16x16x32_bf16 v[216:219], a[16:19], a[92:95], v[216:219]
    ds_read_b64_tr_b16 a[16:17], v14 offset:64
    v_mfma_f32_16x16x32_bf16 v[52:55], a[20:23], a[80:83], v[52:55]
    ds_read_b64_tr_b16 a[18:19], v14 offset:3648
    v_mfma_f32_16x16x32_bf16 v[108:111], a[20:23], a[84:87], v[108:111]
    v_mfma_f32_16x16x32_bf16 v[164:167], a[20:23], a[88:91], v[164:167]
    v_mfma_f32_16x16x32_bf16 v[220:223], a[20:23], a[92:95], v[220:223]
    ds_read_b64_tr_b16 a[20:21], v14 offset:14400
    v_mfma_f32_16x16x32_bf16 v[56:59], a[24:27], a[80:83], v[56:59]
    ds_read_b64_tr_b16 a[22:23], v14 offset:17984
    v_mfma_f32_16x16x32_bf16 v[112:115], a[24:27], a[84:87], v[112:115]
    s_mov_b32 s48, s14
    s_mov_b32 s49, s15
    s_mov_b32 s50, 2048
    s_mov_b32 s51, 0x20000
    s_lshl_b32 s66, s34, 1
    v_mov_b32 v15, 0
    buffer_load_ushort a237, v15, s[48:51], s66 offen
    s_mov_b32 s52, s4
    s_mov_b32 s53, s5
    s_mov_b32 s54, 4194304
    s_mov_b32 s55, 0x20000
    v_mfma_f32_16x16x32_bf16 v[168:171], a[24:27], a[88:91], v[168:171]
    v_mfma_f32_16x16x32_bf16 v[224:227], a[24:27], a[92:95], v[224:227]
    ds_read_b64_tr_b16 a[24:25], v14 offset:96
    v_mfma_f32_16x16x32_bf16 v[60:63], a[28:31], a[80:83], v[60:63]
    ds_read_b64_tr_b16 a[26:27], v14 offset:3680
    v_mfma_f32_16x16x32_bf16 v[116:119], a[28:31], a[84:87], v[116:119]
    v_mfma_f32_16x16x32_bf16 v[172:175], a[28:31], a[88:91], v[172:175]
    v_mfma_f32_16x16x32_bf16 v[228:231], a[28:31], a[92:95], v[228:231]
    ds_read_b64_tr_b16 a[28:29], v14 offset:14432
    s_waitcnt lgkmcnt(8)
    v_mfma_f32_16x16x32_bf16 v[64:67], a[32:35], a[80:83], v[64:67]
    ds_read_b64_tr_b16 a[30:31], v14 offset:18016
    v_mfma_f32_16x16x32_bf16 v[120:123], a[32:35], a[84:87], v[120:123]
    v_mfma_f32_16x16x32_bf16 v[176:179], a[32:35], a[88:91], v[176:179]
    v_mfma_f32_16x16x32_bf16 v[232:235], a[32:35], a[92:95], v[232:235]
    ds_read_b64_tr_b16 a[32:33], v14 offset:128
    v_mfma_f32_16x16x32_bf16 v[68:71], a[36:39], a[80:83], v[68:71]
    ds_read_b64_tr_b16 a[34:35], v14 offset:3712
    v_mfma_f32_16x16x32_bf16 v[124:127], a[36:39], a[84:87], v[124:127]
    v_mfma_f32_16x16x32_bf16 v[180:183], a[36:39], a[88:91], v[180:183]
    v_mfma_f32_16x16x32_bf16 v[236:239], a[36:39], a[92:95], v[236:239]
    ds_read_b64_tr_b16 a[36:37], v14 offset:14464
    v_mfma_f32_16x16x32_bf16 v[72:75], a[40:43], a[80:83], v[72:75]
    ds_read_b64_tr_b16 a[38:39], v14 offset:18048
    v_mfma_f32_16x16x32_bf16 v[76:79], a[44:47], a[80:83], v[76:79]
    v_mfma_f32_16x16x32_bf16 v[80:83], a[48:51], a[80:83], v[80:83]
    v_mfma_f32_16x16x32_bf16 v[84:87], a[52:55], a[80:83], v[84:87]
    buffer_load_dwordx2 a[220:221], v28, s[52:55], s16 offen offset:0
    v_mfma_f32_16x16x32_bf16 v[128:131], a[40:43], a[84:87], v[128:131]
    v_mfma_f32_16x16x32_bf16 v[132:135], a[44:47], a[84:87], v[132:135]
    v_mfma_f32_16x16x32_bf16 v[136:139], a[48:51], a[84:87], v[136:139]
    v_mfma_f32_16x16x32_bf16 v[140:143], a[52:55], a[84:87], v[140:143]
    buffer_load_dwordx2 a[222:223], v28, s[52:55], s16 offen offset:16
    v_mfma_f32_16x16x32_bf16 v[184:187], a[40:43], a[88:91], v[184:187]
    v_mfma_f32_16x16x32_bf16 v[188:191], a[44:47], a[88:91], v[188:191]
    v_mfma_f32_16x16x32_bf16 v[192:195], a[48:51], a[88:91], v[192:195]
    v_mfma_f32_16x16x32_bf16 v[196:199], a[52:55], a[88:91], v[196:199]
    buffer_load_dwordx2 a[224:225], v28, s[52:55], s16 offen offset:32
    v_mfma_f32_16x16x32_bf16 v[240:243], a[40:43], a[92:95], v[240:243]
    ds_read_b64_tr_b16 a[40:41], v14 offset:160
    v_mfma_f32_16x16x32_bf16 v[244:247], a[44:47], a[92:95], v[244:247]
    ds_read_b64_tr_b16 a[44:45], v14 offset:14496
    v_mfma_f32_16x16x32_bf16 v[248:251], a[48:51], a[92:95], v[248:251]
    ds_read_b64_tr_b16 a[48:49], v14 offset:192
    v_mfma_f32_16x16x32_bf16 v[252:255], a[52:55], a[92:95], v[252:255]
    ds_read_b64_tr_b16 a[52:53], v14 offset:14528
    s_waitcnt vmcnt(20) lgkmcnt(4)
    v_mfma_f32_16x16x32_bf16 v[32:35], a[0:3], a[96:99], v[32:35]
    ds_read_b64_tr_b16 a[42:43], v14 offset:3744
    v_mfma_f32_16x16x32_bf16 v[88:91], a[0:3], a[100:103], v[88:91]
    ds_read_b64_tr_b16 a[46:47], v14 offset:18080
    v_mfma_f32_16x16x32_bf16 v[144:147], a[0:3], a[104:107], v[144:147]
    buffer_load_dwordx2 a[226:227], v28, s[52:55], s16 offen offset:48
    v_mfma_f32_16x16x32_bf16 v[200:203], a[0:3], a[108:111], v[200:203]
    ds_read_b64_tr_b16 a[0:1], v14 offset:7168
    v_mfma_f32_16x16x32_bf16 v[36:39], a[4:7], a[96:99], v[36:39]
    ds_read_b64_tr_b16 a[2:3], v14 offset:10752
    v_mfma_f32_16x16x32_bf16 v[92:95], a[4:7], a[100:103], v[92:95]
    ds_read_b64_tr_b16 a[50:51], v14 offset:3776
    v_mfma_f32_16x16x32_bf16 v[148:151], a[4:7], a[104:107], v[148:151]
    ds_read_b64_tr_b16 a[54:55], v14 offset:18112
    v_mfma_f32_16x16x32_bf16 v[204:207], a[4:7], a[108:111], v[204:207]
    ds_read_b64_tr_b16 a[4:5], v14 offset:21504
    v_mfma_f32_16x16x32_bf16 v[40:43], a[8:11], a[96:99], v[40:43]
    ds_read_b64_tr_b16 a[6:7], v14 offset:25088
    v_mfma_f32_16x16x32_bf16 v[96:99], a[8:11], a[100:103], v[96:99]
    v_mfma_f32_16x16x32_bf16 v[152:155], a[8:11], a[104:107], v[152:155]
    v_mfma_f32_16x16x32_bf16 v[208:211], a[8:11], a[108:111], v[208:211]
    ds_read_b64_tr_b16 a[8:9], v14 offset:7200
    v_mfma_f32_16x16x32_bf16 v[44:47], a[12:15], a[96:99], v[44:47]
    ds_read_b64_tr_b16 a[10:11], v14 offset:10784
    v_mfma_f32_16x16x32_bf16 v[100:103], a[12:15], a[100:103], v[100:103]
    v_mfma_f32_16x16x32_bf16 v[156:159], a[12:15], a[104:107], v[156:159]
    v_mfma_f32_16x16x32_bf16 v[212:215], a[12:15], a[108:111], v[212:215]
    ds_read_b64_tr_b16 a[12:13], v14 offset:21536
    v_mfma_f32_16x16x32_bf16 v[48:51], a[16:19], a[96:99], v[48:51]
    ds_read_b64_tr_b16 a[14:15], v14 offset:25120
    v_mfma_f32_16x16x32_bf16 v[104:107], a[16:19], a[100:103], v[104:107]
    v_mfma_f32_16x16x32_bf16 v[160:163], a[16:19], a[104:107], v[160:163]
    v_mfma_f32_16x16x32_bf16 v[216:219], a[16:19], a[108:111], v[216:219]
    ds_read_b64_tr_b16 a[16:17], v14 offset:7232
    v_mfma_f32_16x16x32_bf16 v[52:55], a[20:23], a[96:99], v[52:55]
    ds_read_b64_tr_b16 a[18:19], v14 offset:10816
    v_mfma_f32_16x16x32_bf16 v[108:111], a[20:23], a[100:103], v[108:111]
    v_mfma_f32_16x16x32_bf16 v[164:167], a[20:23], a[104:107], v[164:167]
    buffer_load_dwordx2 a[228:229], v28, s[52:55], s16 offen offset:64
    v_mfma_f32_16x16x32_bf16 v[220:223], a[20:23], a[108:111], v[220:223]
    ds_read_b64_tr_b16 a[20:21], v14 offset:21568
    v_mfma_f32_16x16x32_bf16 v[56:59], a[24:27], a[96:99], v[56:59]
    ds_read_b64_tr_b16 a[22:23], v14 offset:25152
    v_mfma_f32_16x16x32_bf16 v[112:115], a[24:27], a[100:103], v[112:115]
    v_mfma_f32_16x16x32_bf16 v[168:171], a[24:27], a[104:107], v[168:171]
    v_mfma_f32_16x16x32_bf16 v[224:227], a[24:27], a[108:111], v[224:227]
    ds_read_b64_tr_b16 a[24:25], v14 offset:7264
    v_mfma_f32_16x16x32_bf16 v[60:63], a[28:31], a[96:99], v[60:63]
    ds_read_b64_tr_b16 a[26:27], v14 offset:10848
    v_mfma_f32_16x16x32_bf16 v[116:119], a[28:31], a[100:103], v[116:119]
    v_mfma_f32_16x16x32_bf16 v[172:175], a[28:31], a[104:107], v[172:175]
    v_mfma_f32_16x16x32_bf16 v[228:231], a[28:31], a[108:111], v[228:231]
    ds_read_b64_tr_b16 a[28:29], v14 offset:21600
    s_waitcnt lgkmcnt(8)
    v_mfma_f32_16x16x32_bf16 v[64:67], a[32:35], a[96:99], v[64:67]
    ds_read_b64_tr_b16 a[30:31], v14 offset:25184
    v_mfma_f32_16x16x32_bf16 v[120:123], a[32:35], a[100:103], v[120:123]
    v_mfma_f32_16x16x32_bf16 v[176:179], a[32:35], a[104:107], v[176:179]
    v_mfma_f32_16x16x32_bf16 v[232:235], a[32:35], a[108:111], v[232:235]
    ds_read_b64_tr_b16 a[32:33], v14 offset:7296
    v_mfma_f32_16x16x32_bf16 v[68:71], a[36:39], a[96:99], v[68:71]
    ds_read_b64_tr_b16 a[34:35], v14 offset:10880
    v_mfma_f32_16x16x32_bf16 v[124:127], a[36:39], a[100:103], v[124:127]
    v_mfma_f32_16x16x32_bf16 v[180:183], a[36:39], a[104:107], v[180:183]
    v_mfma_f32_16x16x32_bf16 v[236:239], a[36:39], a[108:111], v[236:239]
    ds_read_b64_tr_b16 a[36:37], v14 offset:21632
    v_mfma_f32_16x16x32_bf16 v[72:75], a[40:43], a[96:99], v[72:75]
    ds_read_b64_tr_b16 a[38:39], v14 offset:25216
    v_mfma_f32_16x16x32_bf16 v[76:79], a[44:47], a[96:99], v[76:79]
    v_mfma_f32_16x16x32_bf16 v[80:83], a[48:51], a[96:99], v[80:83]
    v_mfma_f32_16x16x32_bf16 v[84:87], a[52:55], a[96:99], v[84:87]
    buffer_load_dwordx2 a[230:231], v28, s[52:55], s16 offen offset:80
    v_mfma_f32_16x16x32_bf16 v[128:131], a[40:43], a[100:103], v[128:131]
    v_mfma_f32_16x16x32_bf16 v[132:135], a[44:47], a[100:103], v[132:135]
    v_mfma_f32_16x16x32_bf16 v[136:139], a[48:51], a[100:103], v[136:139]
    v_mfma_f32_16x16x32_bf16 v[140:143], a[52:55], a[100:103], v[140:143]
    buffer_load_dwordx2 a[232:233], v28, s[52:55], s16 offen offset:96
    v_mfma_f32_16x16x32_bf16 v[184:187], a[40:43], a[104:107], v[184:187]
    v_mfma_f32_16x16x32_bf16 v[188:191], a[44:47], a[104:107], v[188:191]
    v_mfma_f32_16x16x32_bf16 v[192:195], a[48:51], a[104:107], v[192:195]
    v_mfma_f32_16x16x32_bf16 v[196:199], a[52:55], a[104:107], v[196:199]
    buffer_load_dwordx2 a[234:235], v28, s[52:55], s16 offen offset:112
    v_mfma_f32_16x16x32_bf16 v[240:243], a[40:43], a[108:111], v[240:243]
    ds_read_b64_tr_b16 a[40:41], v14 offset:7328
    v_mfma_f32_16x16x32_bf16 v[244:247], a[44:47], a[108:111], v[244:247]
    ds_read_b64_tr_b16 a[44:45], v14 offset:21664
    v_mfma_f32_16x16x32_bf16 v[248:251], a[48:51], a[108:111], v[248:251]
    ds_read_b64_tr_b16 a[48:49], v14 offset:7360
    v_mfma_f32_16x16x32_bf16 v[252:255], a[52:55], a[108:111], v[252:255]
    ds_read_b64_tr_b16 a[52:53], v14 offset:21696
    s_waitcnt vmcnt(15) lgkmcnt(4)
    v_mfma_f32_16x16x32_bf16 v[32:35], a[0:3], a[112:115], v[32:35]
    ds_read_b64_tr_b16 a[42:43], v14 offset:10912
    v_mfma_f32_16x16x32_bf16 v[88:91], a[0:3], a[116:119], v[88:91]
    ds_read_b64_tr_b16 a[46:47], v14 offset:25248
    v_mfma_f32_16x16x32_bf16 v[144:147], a[0:3], a[120:123], v[144:147]
    v_lshrrev_b32 v3, 3, v1
    v_mfma_f32_16x16x32_bf16 v[200:203], a[0:3], a[124:127], v[200:203]
    v_bfe_u32 v4, v1, 4, 1
    v_mfma_f32_16x16x32_bf16 v[36:39], a[4:7], a[112:115], v[36:39]
    v_lshlrev_b32 v4, 2, v4
    v_mfma_f32_16x16x32_bf16 v[92:95], a[4:7], a[116:119], v[92:95]
    ds_read_b64_tr_b16 a[50:51], v14 offset:10944
    v_mfma_f32_16x16x32_bf16 v[148:151], a[4:7], a[120:123], v[148:151]
    ds_read_b64_tr_b16 a[54:55], v14 offset:25280
    v_mfma_f32_16x16x32_bf16 v[204:207], a[4:7], a[124:127], v[204:207]
    v_and_b32 v6, 7, v1
    v_mfma_f32_16x16x32_bf16 v[40:43], a[8:11], a[112:115], v[40:43]
    v_xor_b32 v4, v4, v6
    v_mfma_f32_16x16x32_bf16 v[96:99], a[8:11], a[116:119], v[96:99]
    v_lshlrev_b32 v3, 11, v3
    v_mfma_f32_16x16x32_bf16 v[152:155], a[8:11], a[120:123], v[152:155]
    v_lshl_add_u32 v12, v4, 4, v3
    v_mfma_f32_16x16x32_bf16 v[208:211], a[8:11], a[124:127], v[208:211]
    v_add_u32 v18, 15360, v12
    v_mfma_f32_16x16x32_bf16 v[44:47], a[12:15], a[112:115], v[44:47]
    v_add_u32 v19, 30720, v12
    v_mfma_f32_16x16x32_bf16 v[100:103], a[12:15], a[116:119], v[100:103]
    v_add_u32 v5, 46080, v12
    v_mfma_f32_16x16x32_bf16 v[156:159], a[12:15], a[120:123], v[156:159]
    s_mov_b32 s56, s22
    v_mfma_f32_16x16x32_bf16 v[212:215], a[12:15], a[124:127], v[212:215]
    s_mov_b32 s57, s23
    v_mfma_f32_16x16x32_bf16 v[48:51], a[16:19], a[112:115], v[48:51]
    s_mov_b32 s58, 7340032
    v_mfma_f32_16x16x32_bf16 v[104:107], a[16:19], a[116:119], v[104:107]
    s_mov_b32 s59, 0x20000
    v_mfma_f32_16x16x32_bf16 v[160:163], a[16:19], a[120:123], v[160:163]
    s_lshl_b32 s74, s3, 12
    v_mfma_f32_16x16x32_bf16 v[216:219], a[16:19], a[124:127], v[216:219]
    s_lshl_b32 s72, s3, 16
    v_mfma_f32_16x16x32_bf16 v[52:55], a[20:23], a[112:115], v[52:55]
    s_lshl_b32 s66, s33, 7
    v_mfma_f32_16x16x32_bf16 v[108:111], a[20:23], a[116:119], v[108:111]
    s_add_u32 s72, s72, s66
    v_mfma_f32_16x16x32_bf16 v[164:167], a[20:23], a[120:123], v[164:167]
    s_mov_b32 s76, 262144
    v_mfma_f32_16x16x32_bf16 v[220:223], a[20:23], a[124:127], v[220:223]
    s_mov_b32 s77, 0
    v_mfma_f32_16x16x32_bf16 v[56:59], a[24:27], a[112:115], v[56:59]
    s_add_u32 s40, s28, 4194304
    s_addc_u32 s41, s29, 0
    v_mfma_f32_16x16x32_bf16 v[112:115], a[24:27], a[116:119], v[112:115]
    s_mov_b32 s42, 14680064
    v_mfma_f32_16x16x32_bf16 v[168:171], a[24:27], a[120:123], v[168:171]
    s_mov_b32 s43, 0x20000
    v_mfma_f32_16x16x32_bf16 v[224:227], a[24:27], a[124:127], v[224:227]
    s_lshl_b32 s68, s30, 3
    v_mfma_f32_16x16x32_bf16 v[60:63], a[28:31], a[112:115], v[60:63]
    s_lshl_b32 s69, s3, 1
    v_mfma_f32_16x16x32_bf16 v[116:119], a[28:31], a[116:119], v[116:119]
    s_add_u32 s68, s68, s69
    v_mfma_f32_16x16x32_bf16 v[172:175], a[28:31], a[120:123], v[172:175]
    s_mul_i32 s68, s68, 229376
    v_mfma_f32_16x16x32_bf16 v[228:231], a[28:31], a[124:127], v[228:231]
    s_mul_i32 s69, s31, 7168
    s_waitcnt lgkmcnt(0)
    v_mfma_f32_16x16x32_bf16 v[64:67], a[32:35], a[112:115], v[64:67]
    s_add_u32 s68, s68, s69
    v_mfma_f32_16x16x32_bf16 v[120:123], a[32:35], a[116:119], v[120:123]
    s_mov_b32 s66, 0xbfb8aa3b
    v_mfma_f32_16x16x32_bf16 v[176:179], a[32:35], a[120:123], v[176:179]
    s_mov_b32 s67, 0xbfb8aa3b
    v_mfma_f32_16x16x32_bf16 v[232:235], a[32:35], a[124:127], v[232:235]
    s_mov_b32 s78, 1.0
    v_mfma_f32_16x16x32_bf16 v[68:71], a[36:39], a[112:115], v[68:71]
    s_mov_b32 s79, 1.0
    v_mfma_f32_16x16x32_bf16 v[124:127], a[36:39], a[116:119], v[124:127]
    v_mfma_f32_16x16x32_bf16 v[180:183], a[36:39], a[120:123], v[180:183]
    v_mfma_f32_16x16x32_bf16 v[236:239], a[36:39], a[124:127], v[236:239]
    v_mfma_f32_16x16x32_bf16 v[72:75], a[40:43], a[112:115], v[72:75]
    v_mfma_f32_16x16x32_bf16 v[76:79], a[44:47], a[112:115], v[76:79]
    v_mfma_f32_16x16x32_bf16 v[80:83], a[48:51], a[112:115], v[80:83]
    v_mfma_f32_16x16x32_bf16 v[84:87], a[52:55], a[112:115], v[84:87]
    v_mfma_f32_16x16x32_bf16 v[128:131], a[40:43], a[116:119], v[128:131]
    v_mfma_f32_16x16x32_bf16 v[132:135], a[44:47], a[116:119], v[132:135]
    v_mfma_f32_16x16x32_bf16 v[136:139], a[48:51], a[116:119], v[136:139]
    v_mfma_f32_16x16x32_bf16 v[140:143], a[52:55], a[116:119], v[140:143]
    v_mfma_f32_16x16x32_bf16 v[184:187], a[40:43], a[120:123], v[184:187]
    v_mfma_f32_16x16x32_bf16 v[188:191], a[44:47], a[120:123], v[188:191]
    v_mfma_f32_16x16x32_bf16 v[192:195], a[48:51], a[120:123], v[192:195]
    v_mfma_f32_16x16x32_bf16 v[196:199], a[52:55], a[120:123], v[196:199]
    v_mfma_f32_16x16x32_bf16 v[240:243], a[40:43], a[124:127], v[240:243]
    v_mfma_f32_16x16x32_bf16 v[244:247], a[44:47], a[124:127], v[244:247]
    v_mfma_f32_16x16x32_bf16 v[248:251], a[48:51], a[124:127], v[248:251]
    v_mfma_f32_16x16x32_bf16 v[252:255], a[52:55], a[124:127], v[252:255]
e1_start:
    s_cmp_eq_u32 s35, 0
    s_cbranch_scc1 wp_ok
    s_cmp_lg_u32 s35, 1
    s_cbranch_scc1 wp_sw
    s_waitcnt vmcnt(0)
wp_sw:
    s_lshr_b32 s72, s33, 3
    s_mul_i32 s72, s72, 458752
    s_add_u32 s72, s72, 30408704
    s_add_u32 s56, s28, s72
    s_addc_u32 s57, s29, 0
    s_mov_b32 s58, 458752
    s_mov_b32 s72, s74
    s_mov_b32 s76, 16384
    v_mov_b32 v12, v10
    v_mov_b32 v18, v10
    v_mov_b32 v19, v10
    v_mov_b32 v5, v10
wp_ok:
    s_barrier
    s_nop 4
    v_pk_mul_f32 v[32:33], v[32:33], s[66:67]
    v_pk_mul_f32 v[34:35], v[34:35], s[66:67]
    v_pk_mul_f32 v[88:89], v[88:89], s[66:67]
    v_pk_mul_f32 v[90:91], v[90:91], s[66:67]
    v_exp_f32 v32, v32
    v_exp_f32 v33, v33
    v_exp_f32 v34, v34
    v_exp_f32 v35, v35
    v_exp_f32 v88, v88
    v_exp_f32 v89, v89
    v_exp_f32 v90, v90
    v_exp_f32 v91, v91
    v_pk_add_f32 v[32:33], v[32:33], s[78:79]
    v_pk_add_f32 v[34:35], v[34:35], s[78:79]
    v_pk_add_f32 v[88:89], v[88:89], s[78:79]
    v_pk_add_f32 v[90:91], v[90:91], s[78:79]
    v_rcp_f32 v32, v32
    v_rcp_f32 v33, v33
    v_rcp_f32 v34, v34
    v_rcp_f32 v35, v35
    v_rcp_f32 v88, v88
    v_rcp_f32 v89, v89
    v_rcp_f32 v90, v90
    v_rcp_f32 v91, v91
    v_pk_mul_f32 v[32:33], v[32:33], v[36:37]
    v_pk_mul_f32 v[34:35], v[34:35], v[38:39]
    v_pk_mul_f32 v[88:89], v[88:89], v[92:93]
    v_pk_mul_f32 v[90:91], v[90:91], v[94:95]
    v_cvt_pk_bf16_f32 v32, v32, v33
    v_cvt_pk_bf16_f32 v33, v34, v35
    v_cvt_pk_bf16_f32 v34, v88, v89
    v_cvt_pk_bf16_f32 v35, v90, v91
    s_nop 0
    s_nop 0
    v_permlane16_swap_b32 v32, v34
    v_permlane16_swap_b32 v33, v35
    buffer_store_dwordx4 v[32:35], v10, s[40:43], s68 offen offset:0 sc1
    v_pk_mul_f32 v[40:41], v[40:41], s[66:67]
    v_pk_mul_f32 v[42:43], v[42:43], s[66:67]
    v_pk_mul_f32 v[96:97], v[96:97], s[66:67]
    v_pk_mul_f32 v[98:99], v[98:99], s[66:67]
    v_exp_f32 v40, v40
    v_exp_f32 v41, v41
    v_exp_f32 v42, v42
    v_exp_f32 v43, v43
    v_exp_f32 v96, v96
    v_exp_f32 v97, v97
    v_exp_f32 v98, v98
    v_exp_f32 v99, v99
    v_pk_add_f32 v[40:41], v[40:41], s[78:79]
    v_pk_add_f32 v[42:43], v[42:43], s[78:79]
    v_pk_add_f32 v[96:97], v[96:97], s[78:79]
    v_pk_add_f32 v[98:99], v[98:99], s[78:79]
    v_rcp_f32 v40, v40
    v_rcp_f32 v41, v41
    v_rcp_f32 v42, v42
    v_rcp_f32 v43, v43
    v_rcp_f32 v96, v96
    v_rcp_f32 v97, v97
    v_rcp_f32 v98, v98
    v_rcp_f32 v99, v99
    v_pk_mul_f32 v[40:41], v[40:41], v[44:45]
    v_pk_mul_f32 v[42:43], v[42:43], v[46:47]
    v_pk_mul_f32 v[96:97], v[96:97], v[100:101]
    v_pk_mul_f32 v[98:99], v[98:99], v[102:103]
    v_cvt_pk_bf16_f32 v40, v40, v41
    v_cvt_pk_bf16_f32 v41, v42, v43
    v_cvt_pk_bf16_f32 v42, v96, v97
    v_cvt_pk_bf16_f32 v43, v98, v99
    s_nop 0
    s_nop 0
    v_permlane16_swap_b32 v40, v42
    v_permlane16_swap_b32 v41, v43
    buffer_store_dwordx4 v[40:43], v10, s[40:43], s68 offen offset:1024 sc1
    v_pk_mul_f32 v[48:49], v[48:49], s[66:67]
    v_pk_mul_f32 v[50:51], v[50:51], s[66:67]
    v_pk_mul_f32 v[104:105], v[104:105], s[66:67]
    v_pk_mul_f32 v[106:107], v[106:107], s[66:67]
    v_exp_f32 v48, v48
    v_exp_f32 v49, v49
    v_exp_f32 v50, v50
    v_exp_f32 v51, v51
    v_exp_f32 v104, v104
    v_exp_f32 v105, v105
    v_exp_f32 v106, v106
    v_exp_f32 v107, v107
    v_pk_add_f32 v[48:49], v[48:49], s[78:79]
    v_pk_add_f32 v[50:51], v[50:51], s[78:79]
    v_pk_add_f32 v[104:105], v[104:105], s[78:79]
    v_pk_add_f32 v[106:107], v[106:107], s[78:79]
    v_rcp_f32 v48, v48
    v_rcp_f32 v49, v49
    v_rcp_f32 v50, v50
    v_rcp_f32 v51, v51
    v_rcp_f32 v104, v104
    v_rcp_f32 v105, v105
    v_rcp_f32 v106, v106
    v_rcp_f32 v107, v107
    v_pk_mul_f32 v[48:49], v[48:49], v[52:53]
    v_pk_mul_f32 v[50:51], v[50:51], v[54:55]
    v_pk_mul_f32 v[104:105], v[104:105], v[108:109]
    v_pk_mul_f32 v[106:107], v[106:107], v[110:111]
    v_cvt_pk_bf16_f32 v48, v48, v49
    v_cvt_pk_bf16_f32 v49, v50, v51
    v_cvt_pk_bf16_f32 v50, v104, v105
    v_cvt_pk_bf16_f32 v51, v106, v107
    s_nop 0
    s_nop 0
    v_permlane16_swap_b32 v48, v50
    v_permlane16_swap_b32 v49, v51
    buffer_store_dwordx4 v[48:51], v10, s[40:43], s68 offen offset:2048 sc1
    v_pk_mul_f32 v[56:57], v[56:57], s[66:67]
    v_pk_mul_f32 v[58:59], v[58:59], s[66:67]
    v_pk_mul_f32 v[112:113], v[112:113], s[66:67]
    v_pk_mul_f32 v[114:115], v[114:115], s[66:67]
    v_exp_f32 v56, v56
    v_exp_f32 v57, v57
    v_exp_f32 v58, v58
    v_exp_f32 v59, v59
    v_exp_f32 v112, v112
    v_exp_f32 v113, v113
    v_exp_f32 v114, v114
    v_exp_f32 v115, v115
    v_pk_add_f32 v[56:57], v[56:57], s[78:79]
    v_pk_add_f32 v[58:59], v[58:59], s[78:79]
    v_pk_add_f32 v[112:113], v[112:113], s[78:79]
    v_pk_add_f32 v[114:115], v[114:115], s[78:79]
    v_rcp_f32 v56, v56
    v_rcp_f32 v57, v57
    v_rcp_f32 v58, v58
    v_rcp_f32 v59, v59
    v_rcp_f32 v112, v112
    v_rcp_f32 v113, v113
    v_rcp_f32 v114, v114
    v_rcp_f32 v115, v115
    v_pk_mul_f32 v[56:57], v[56:57], v[60:61]
    v_pk_mul_f32 v[58:59], v[58:59], v[62:63]
    v_pk_mul_f32 v[112:113], v[112:113], v[116:117]
    v_pk_mul_f32 v[114:115], v[114:115], v[118:119]
    v_cvt_pk_bf16_f32 v56, v56, v57
    v_cvt_pk_bf16_f32 v57, v58, v59
    v_cvt_pk_bf16_f32 v58, v112, v113
    v_cvt_pk_bf16_f32 v59, v114, v115
    s_nop 0
    s_nop 0
    v_permlane16_swap_b32 v56, v58
    v_permlane16_swap_b32 v57, v59
    buffer_store_dwordx4 v[56:59], v10, s[40:43], s68 offen offset:3072 sc1
    v_pk_mul_f32 v[64:65], v[64:65], s[66:67]
    v_pk_mul_f32 v[66:67], v[66:67], s[66:67]
    v_pk_mul_f32 v[120:121], v[120:121], s[66:67]
    v_pk_mul_f32 v[122:123], v[122:123], s[66:67]
    v_exp_f32 v64, v64
    v_exp_f32 v65, v65
    v_exp_f32 v66, v66
    v_exp_f32 v67, v67
    v_exp_f32 v120, v120
    v_exp_f32 v121, v121
    v_exp_f32 v122, v122
    v_exp_f32 v123, v123
    v_pk_add_f32 v[64:65], v[64:65], s[78:79]
    v_pk_add_f32 v[66:67], v[66:67], s[78:79]
    v_pk_add_f32 v[120:121], v[120:121], s[78:79]
    v_pk_add_f32 v[122:123], v[122:123], s[78:79]
    v_rcp_f32 v64, v64
    v_rcp_f32 v65, v65
    v_rcp_f32 v66, v66
    v_rcp_f32 v67, v67
    v_rcp_f32 v120, v120
    v_rcp_f32 v121, v121
    v_rcp_f32 v122, v122
    v_rcp_f32 v123, v123
    v_pk_mul_f32 v[64:65], v[64:65], v[68:69]
    v_pk_mul_f32 v[66:67], v[66:67], v[70:71]
    v_pk_mul_f32 v[120:121], v[120:121], v[124:125]
    v_pk_mul_f32 v[122:123], v[122:123], v[126:127]
    v_cvt_pk_bf16_f32 v64, v64, v65
    v_cvt_pk_bf16_f32 v65, v66, v67
    v_cvt_pk_bf16_f32 v66, v120, v121
    v_cvt_pk_bf16_f32 v67, v122, v123
    s_add_u32 s69, s68, 4096
    s_nop 0
    v_permlane16_swap_b32 v64, v66
    v_permlane16_swap_b32 v65, v67
    buffer_store_dwordx4 v[64:67], v10, s[40:43], s69 offen offset:0 sc1
    v_pk_mul_f32 v[72:73], v[72:73], s[66:67]
    v_pk_mul_f32 v[74:75], v[74:75], s[66:67]
    v_pk_mul_f32 v[128:129], v[128:129], s[66:67]
    v_pk_mul_f32 v[130:131], v[130:131], s[66:67]
    v_exp_f32 v72, v72
    v_exp_f32 v73, v73
    v_exp_f32 v74, v74
    v_exp_f32 v75, v75
    v_exp_f32 v128, v128
    v_exp_f32 v129, v129
    v_exp_f32 v130, v130
    v_exp_f32 v131, v131
    v_pk_add_f32 v[72:73], v[72:73], s[78:79]
    v_pk_add_f32 v[74:75], v[74:75], s[78:79]
    v_pk_add_f32 v[128:129], v[128:129], s[78:79]
    v_pk_add_f32 v[130:131], v[130:131], s[78:79]
    v_rcp_f32 v72, v72
    v_rcp_f32 v73, v73
    v_rcp_f32 v74, v74
    v_rcp_f32 v75, v75
    v_rcp_f32 v128, v128
    v_rcp_f32 v129, v129
    v_rcp_f32 v130, v130
    v_rcp_f32 v131, v131
    v_pk_mul_f32 v[72:73], v[72:73], v[76:77]
    v_pk_mul_f32 v[74:75], v[74:75], v[78:79]
    v_pk_mul_f32 v[128:129], v[128:129], v[132:133]
    v_pk_mul_f32 v[130:131], v[130:131], v[134:135]
    v_cvt_pk_bf16_f32 v72, v72, v73
    v_cvt_pk_bf16_f32 v73, v74, v75
    v_cvt_pk_bf16_f32 v74, v128, v129
    v_cvt_pk_bf16_f32 v75, v130, v131
    s_nop 0
    s_nop 0
    v_permlane16_swap_b32 v72, v74
    v_permlane16_swap_b32 v73, v75
    buffer_store_dwordx4 v[72:75], v10, s[40:43], s69 offen offset:1024 sc1
    v_pk_mul_f32 v[80:81], v[80:81], s[66:67]
    v_pk_mul_f32 v[82:83], v[82:83], s[66:67]
    v_pk_mul_f32 v[136:137], v[136:137], s[66:67]
    v_pk_mul_f32 v[138:139], v[138:139], s[66:67]
    v_exp_f32 v80, v80
    v_exp_f32 v81, v81
    v_exp_f32 v82, v82
    v_exp_f32 v83, v83
    v_exp_f32 v136, v136
    v_exp_f32 v137, v137
    v_exp_f32 v138, v138
    v_exp_f32 v139, v139
    v_pk_add_f32 v[80:81], v[80:81], s[78:79]
    v_pk_add_f32 v[82:83], v[82:83], s[78:79]
    v_pk_add_f32 v[136:137], v[136:137], s[78:79]
    v_pk_add_f32 v[138:139], v[138:139], s[78:79]
    v_rcp_f32 v80, v80
    v_rcp_f32 v81, v81
    v_rcp_f32 v82, v82
    v_rcp_f32 v83, v83
    v_rcp_f32 v136, v136
    v_rcp_f32 v137, v137
    v_rcp_f32 v138, v138
    v_rcp_f32 v139, v139
    v_pk_mul_f32 v[80:81], v[80:81], v[84:85]
    v_pk_mul_f32 v[82:83], v[82:83], v[86:87]
    v_pk_mul_f32 v[136:137], v[136:137], v[140:141]
    v_pk_mul_f32 v[138:139], v[138:139], v[142:143]
    v_cvt_pk_bf16_f32 v80, v80, v81
    v_cvt_pk_bf16_f32 v81, v82, v83
    v_cvt_pk_bf16_f32 v82, v136, v137
    v_cvt_pk_bf16_f32 v83, v138, v139
    s_nop 0
    s_nop 0
    v_permlane16_swap_b32 v80, v82
    v_permlane16_swap_b32 v81, v83
    buffer_store_dwordx4 v[80:83], v10, s[40:43], s69 offen offset:2048 sc1
    s_add_u32 s68, s68, 229376
    v_pk_mul_f32 v[144:145], v[144:145], s[66:67]
    v_pk_mul_f32 v[146:147], v[146:147], s[66:67]
    v_pk_mul_f32 v[200:201], v[200:201], s[66:67]
    v_pk_mul_f32 v[202:203], v[202:203], s[66:67]
    v_exp_f32 v144, v144
    v_exp_f32 v145, v145
    v_exp_f32 v146, v146
    v_exp_f32 v147, v147
    v_exp_f32 v200, v200
    v_exp_f32 v201, v201
    v_exp_f32 v202, v202
    v_exp_f32 v203, v203
    v_pk_add_f32 v[144:145], v[144:145], s[78:79]
    v_pk_add_f32 v[146:147], v[146:147], s[78:79]
    v_pk_add_f32 v[200:201], v[200:201], s[78:79]
    v_pk_add_f32 v[202:203], v[202:203], s[78:79]
    v_rcp_f32 v144, v144
    v_rcp_f32 v145, v145
    v_rcp_f32 v146, v146
    v_rcp_f32 v147, v147
    v_rcp_f32 v200, v200
    v_rcp_f32 v201, v201
    v_rcp_f32 v202, v202
    v_rcp_f32 v203, v203
    v_pk_mul_f32 v[144:145], v[144:145], v[148:149]
    v_pk_mul_f32 v[146:147], v[146:147], v[150:151]
    v_pk_mul_f32 v[200:201], v[200:201], v[204:205]
    v_pk_mul_f32 v[202:203], v[202:203], v[206:207]
    v_cvt_pk_bf16_f32 v144, v144, v145
    v_cvt_pk_bf16_f32 v145, v146, v147
    v_cvt_pk_bf16_f32 v146, v200, v201
    v_cvt_pk_bf16_f32 v147, v202, v203
    s_nop 0
    s_nop 0
    v_permlane16_swap_b32 v144, v146
    v_permlane16_swap_b32 v145, v147
    buffer_store_dwordx4 v[144:147], v10, s[40:43], s68 offen offset:0 sc1
    v_pk_mul_f32 v[152:153], v[152:153], s[66:67]
    v_pk_mul_f32 v[154:155], v[154:155], s[66:67]
    v_pk_mul_f32 v[208:209], v[208:209], s[66:67]
    v_pk_mul_f32 v[210:211], v[210:211], s[66:67]
    v_exp_f32 v152, v152
    v_exp_f32 v153, v153
    v_exp_f32 v154, v154
    v_exp_f32 v155, v155
    v_exp_f32 v208, v208
    v_exp_f32 v209, v209
    v_exp_f32 v210, v210
    v_exp_f32 v211, v211
    v_pk_add_f32 v[152:153], v[152:153], s[78:79]
    v_pk_add_f32 v[154:155], v[154:155], s[78:79]
    v_pk_add_f32 v[208:209], v[208:209], s[78:79]
    v_pk_add_f32 v[210:211], v[210:211], s[78:79]
    v_rcp_f32 v152, v152
    v_rcp_f32 v153, v153
    v_rcp_f32 v154, v154
    v_rcp_f32 v155, v155
    v_rcp_f32 v208, v208
    v_rcp_f32 v209, v209
    v_rcp_f32 v210, v210
    v_rcp_f32 v211, v211
    v_pk_mul_f32 v[152:153], v[152:153], v[156:157]
    v_pk_mul_f32 v[154:155], v[154:155], v[158:159]
    v_pk_mul_f32 v[208:209], v[208:209], v[212:213]
    v_pk_mul_f32 v[210:211], v[210:211], v[214:215]
    v_cvt_pk_bf16_f32 v152, v152, v153
    v_cvt_pk_bf16_f32 v153, v154, v155
    v_cvt_pk_bf16_f32 v154, v208, v209
    v_cvt_pk_bf16_f32 v155, v210, v211
    s_nop 0
    s_nop 0
    v_permlane16_swap_b32 v152, v154
    v_permlane16_swap_b32 v153, v155
    buffer_store_dwordx4 v[152:155], v10, s[40:43], s68 offen offset:1024 sc1
    v_pk_mul_f32 v[160:161], v[160:161], s[66:67]
    v_pk_mul_f32 v[162:163], v[162:163], s[66:67]
    v_pk_mul_f32 v[216:217], v[216:217], s[66:67]
    v_pk_mul_f32 v[218:219], v[218:219], s[66:67]
    v_exp_f32 v160, v160
    v_exp_f32 v161, v161
    v_exp_f32 v162, v162
    v_exp_f32 v163, v163
    v_exp_f32 v216, v216
    v_exp_f32 v217, v217
    v_exp_f32 v218, v218
    v_exp_f32 v219, v219
    v_pk_add_f32 v[160:161], v[160:161], s[78:79]
    v_pk_add_f32 v[162:163], v[162:163], s[78:79]
    v_pk_add_f32 v[216:217], v[216:217], s[78:79]
    v_pk_add_f32 v[218:219], v[218:219], s[78:79]
    v_rcp_f32 v160, v160
    v_rcp_f32 v161, v161
    v_rcp_f32 v162, v162
    v_rcp_f32 v163, v163
    v_rcp_f32 v216, v216
    v_rcp_f32 v217, v217
    v_rcp_f32 v218, v218
    v_rcp_f32 v219, v219
    v_pk_mul_f32 v[160:161], v[160:161], v[164:165]
    v_pk_mul_f32 v[162:163], v[162:163], v[166:167]
    v_pk_mul_f32 v[216:217], v[216:217], v[220:221]
    v_pk_mul_f32 v[218:219], v[218:219], v[222:223]
    v_cvt_pk_bf16_f32 v160, v160, v161
    v_cvt_pk_bf16_f32 v161, v162, v163
    v_cvt_pk_bf16_f32 v162, v216, v217
    v_cvt_pk_bf16_f32 v163, v218, v219
    s_nop 0
    s_nop 0
    v_permlane16_swap_b32 v160, v162
    v_permlane16_swap_b32 v161, v163
    buffer_store_dwordx4 v[160:163], v10, s[40:43], s68 offen offset:2048 sc1
    v_pk_mul_f32 v[168:169], v[168:169], s[66:67]
    v_pk_mul_f32 v[170:171], v[170:171], s[66:67]
    v_pk_mul_f32 v[224:225], v[224:225], s[66:67]
    v_pk_mul_f32 v[226:227], v[226:227], s[66:67]
    v_exp_f32 v168, v168
    v_exp_f32 v169, v169
    v_exp_f32 v170, v170
    v_exp_f32 v171, v171
    v_exp_f32 v224, v224
    v_exp_f32 v225, v225
    v_exp_f32 v226, v226
    v_exp_f32 v227, v227
    v_pk_add_f32 v[168:169], v[168:169], s[78:79]
    v_pk_add_f32 v[170:171], v[170:171], s[78:79]
    v_pk_add_f32 v[224:225], v[224:225], s[78:79]
    v_pk_add_f32 v[226:227], v[226:227], s[78:79]
    v_rcp_f32 v168, v168
    v_rcp_f32 v169, v169
    v_rcp_f32 v170, v170
    v_rcp_f32 v171, v171
    v_rcp_f32 v224, v224
    v_rcp_f32 v225, v225
    v_rcp_f32 v226, v226
    v_rcp_f32 v227, v227
    v_pk_mul_f32 v[168:169], v[168:169], v[172:173]
    v_pk_mul_f32 v[170:171], v[170:171], v[174:175]
    v_pk_mul_f32 v[224:225], v[224:225], v[228:229]
    v_pk_mul_f32 v[226:227], v[226:227], v[230:231]
    v_cvt_pk_bf16_f32 v168, v168, v169
    v_cvt_pk_bf16_f32 v169, v170, v171
    v_cvt_pk_bf16_f32 v170, v224, v225
    v_cvt_pk_bf16_f32 v171, v226, v227
    s_nop 0
    s_nop 0
    v_permlane16_swap_b32 v168, v170
    v_permlane16_swap_b32 v169, v171
    buffer_store_dwordx4 v[168:171], v10, s[40:43], s68 offen offset:3072 sc1
    v_pk_mul_f32 v[176:177], v[176:177], s[66:67]
    v_pk_mul_f32 v[178:179], v[178:179], s[66:67]
    v_pk_mul_f32 v[232:233], v[232:233], s[66:67]
    v_pk_mul_f32 v[234:235], v[234:235], s[66:67]
    v_exp_f32 v176, v176
    v_exp_f32 v177, v177
    v_exp_f32 v178, v178
    v_exp_f32 v179, v179
    v_exp_f32 v232, v232
    v_exp_f32 v233, v233
    v_exp_f32 v234, v234
    v_exp_f32 v235, v235
    v_pk_add_f32 v[176:177], v[176:177], s[78:79]
    v_pk_add_f32 v[178:179], v[178:179], s[78:79]
    v_pk_add_f32 v[232:233], v[232:233], s[78:79]
    v_pk_add_f32 v[234:235], v[234:235], s[78:79]
    v_rcp_f32 v176, v176
    v_rcp_f32 v177, v177
    v_rcp_f32 v178, v178
    v_rcp_f32 v179, v179
    v_rcp_f32 v232, v232
    v_rcp_f32 v233, v233
    v_rcp_f32 v234, v234
    v_rcp_f32 v235, v235
    v_pk_mul_f32 v[176:177], v[176:177], v[180:181]
    v_pk_mul_f32 v[178:179], v[178:179], v[182:183]
    v_pk_mul_f32 v[232:233], v[232:233], v[236:237]
    v_pk_mul_f32 v[234:235], v[234:235], v[238:239]
    v_cvt_pk_bf16_f32 v176, v176, v177
    v_cvt_pk_bf16_f32 v177, v178, v179
    v_cvt_pk_bf16_f32 v178, v232, v233
    v_cvt_pk_bf16_f32 v179, v234, v235
    s_add_u32 s69, s68, 4096
    s_nop 0
    v_permlane16_swap_b32 v176, v178
    v_permlane16_swap_b32 v177, v179
    buffer_store_dwordx4 v[176:179], v10, s[40:43], s69 offen offset:0 sc1
    v_pk_mul_f32 v[184:185], v[184:185], s[66:67]
    v_pk_mul_f32 v[186:187], v[186:187], s[66:67]
    v_pk_mul_f32 v[240:241], v[240:241], s[66:67]
    v_pk_mul_f32 v[242:243], v[242:243], s[66:67]
    v_exp_f32 v184, v184
    v_exp_f32 v185, v185
    v_exp_f32 v186, v186
    v_exp_f32 v187, v187
    v_exp_f32 v240, v240
    v_exp_f32 v241, v241
    v_exp_f32 v242, v242
    v_exp_f32 v243, v243
    v_pk_add_f32 v[184:185], v[184:185], s[78:79]
    v_pk_add_f32 v[186:187], v[186:187], s[78:79]
    v_pk_add_f32 v[240:241], v[240:241], s[78:79]
    v_pk_add_f32 v[242:243], v[242:243], s[78:79]
    v_rcp_f32 v184, v184
    v_rcp_f32 v185, v185
    v_rcp_f32 v186, v186
    v_rcp_f32 v187, v187
    v_rcp_f32 v240, v240
    v_rcp_f32 v241, v241
    v_rcp_f32 v242, v242
    v_rcp_f32 v243, v243
    v_pk_mul_f32 v[184:185], v[184:185], v[188:189]
    v_pk_mul_f32 v[186:187], v[186:187], v[190:191]
    v_pk_mul_f32 v[240:241], v[240:241], v[244:245]
    v_pk_mul_f32 v[242:243], v[242:243], v[246:247]
    v_cvt_pk_bf16_f32 v184, v184, v185
    v_cvt_pk_bf16_f32 v185, v186, v187
    v_cvt_pk_bf16_f32 v186, v240, v241
    v_cvt_pk_bf16_f32 v187, v242, v243
    s_nop 0
    s_nop 0
    v_permlane16_swap_b32 v184, v186
    v_permlane16_swap_b32 v185, v187
    buffer_store_dwordx4 v[184:187], v10, s[40:43], s69 offen offset:1024 sc1
    v_pk_mul_f32 v[192:193], v[192:193], s[66:67]
    v_pk_mul_f32 v[194:195], v[194:195], s[66:67]
    v_pk_mul_f32 v[248:249], v[248:249], s[66:67]
    v_pk_mul_f32 v[250:251], v[250:251], s[66:67]
    v_exp_f32 v192, v192
    v_exp_f32 v193, v193
    v_exp_f32 v194, v194
    v_exp_f32 v195, v195
    v_exp_f32 v248, v248
    v_exp_f32 v249, v249
    v_exp_f32 v250, v250
    v_exp_f32 v251, v251
    v_pk_add_f32 v[192:193], v[192:193], s[78:79]
    v_pk_add_f32 v[194:195], v[194:195], s[78:79]
    v_pk_add_f32 v[248:249], v[248:249], s[78:79]
    v_pk_add_f32 v[250:251], v[250:251], s[78:79]
    v_rcp_f32 v192, v192
    v_rcp_f32 v193, v193
    v_rcp_f32 v194, v194
    v_rcp_f32 v195, v195
    v_rcp_f32 v248, v248
    v_rcp_f32 v249, v249
    v_rcp_f32 v250, v250
    v_rcp_f32 v251, v251
    v_pk_mul_f32 v[192:193], v[192:193], v[196:197]
    v_pk_mul_f32 v[194:195], v[194:195], v[198:199]
    v_pk_mul_f32 v[248:249], v[248:249], v[252:253]
    v_pk_mul_f32 v[250:251], v[250:251], v[254:255]
    v_cvt_pk_bf16_f32 v192, v192, v193
    v_cvt_pk_bf16_f32 v193, v194, v195
    v_cvt_pk_bf16_f32 v194, v248, v249
    v_cvt_pk_bf16_f32 v195, v250, v251
    s_nop 0
    s_nop 0
    v_permlane16_swap_b32 v192, v194
    v_permlane16_swap_b32 v193, v195
    buffer_store_dwordx4 v[192:195], v10, s[40:43], s69 offen offset:2048 sc1
    v_lshlrev_b32 v22, 3, v17
    v_sub_u32 v22, 120, v22
    v_lshlrev_b32 v23, 4, v16
    v_and_b32 v23, 127, v23
    v_xor_b32 v22, v22, v23
    v_lshl_add_u32 v22, v16, 10, v22
    v_add_u32 v22, 131072, v22
    s_waitcnt vmcnt(36)
    v_accvgpr_read_b32 v100, a128
    v_accvgpr_read_b32 v101, a132
    v_accvgpr_read_b32 v102, a136
    v_accvgpr_read_b32 v103, a140
    v_accvgpr_read_b32 v104, a144
    v_accvgpr_read_b32 v105, a148
    v_accvgpr_read_b32 v106, a152
    v_accvgpr_read_b32 v107, a156
    v_accvgpr_read_b32 v108, a160
    v_accvgpr_read_b32 v109, a164
    v_accvgpr_read_b32 v110, a168
    v_accvgpr_read_b32 v111, a172
    v_accvgpr_read_b32 v112, a173
    v_accvgpr_read_b32 v113, a174
    v_accvgpr_read_b32 v114, a175
    v_lshlrev_b32 v132, 16, v100
    v_and_b32 v133, s18, v100
    v_lshlrev_b32 v134, 16, v101
    v_and_b32 v135, s18, v101
    v_lshlrev_b32 v136, 16, v102
    v_and_b32 v137, s18, v102
    v_lshlrev_b32 v138, 16, v103
    v_and_b32 v139, s18, v103
    v_lshlrev_b32 v140, 16, v104
    v_and_b32 v141, s18, v104
    v_lshlrev_b32 v142, 16, v105
    v_and_b32 v143, s18, v105
    v_lshlrev_b32 v144, 16, v106
    v_and_b32 v145, s18, v106
    v_lshlrev_b32 v146, 16, v107
    v_and_b32 v147, s18, v107
    v_lshlrev_b32 v148, 16, v108
    v_and_b32 v149, s18, v108
    v_lshlrev_b32 v150, 16, v109
    v_and_b32 v151, s18, v109
    v_lshlrev_b32 v152, 16, v110
    v_and_b32 v153, s18, v110
    v_lshlrev_b32 v154, 16, v111
    v_lshlrev_b32 v155, 16, v113
    v_and_b32 v156, s18, v111
    v_and_b32 v157, s18, v113
    v_lshlrev_b32 v158, 16, v112
    v_lshlrev_b32 v159, 16, v114
    v_and_b32 v160, s18, v112
    v_and_b32 v161, s18, v114
    s_add_u32 m0, s74, 81920
    s_nop 0
    buffer_load_dwordx4 v12, s[56:59], s72 offen offset:0 sc1 lds
    buffer_load_dwordx4 v18, s[56:59], s72 offen offset:1024 sc1 lds
    v_pk_mul_f32 v[88:89], v[132:133], v[160:161]
    v_pk_mul_f32 v[90:91], v[134:135], v[160:161]
    v_pk_mul_f32 v[92:93], v[136:137], v[160:161]
    v_pk_mul_f32 v[94:95], v[138:139], v[160:161]
    v_cvt_pk_bf16_f32 v88, v88, v89
    v_and_b32 v89, s18, v88
    v_lshlrev_b32 v88, 16, v88
    v_cvt_pk_bf16_f32 v90, v90, v91
    v_and_b32 v91, s18, v90
    v_lshlrev_b32 v90, 16, v90
    v_cvt_pk_bf16_f32 v92, v92, v93
    v_and_b32 v93, s18, v92
    v_lshlrev_b32 v92, 16, v92
    v_cvt_pk_bf16_f32 v94, v94, v95
    v_and_b32 v95, s18, v94
    v_lshlrev_b32 v94, 16, v94
    buffer_load_dwordx4 v19, s[56:59], s72 offen offset:2048 sc1 lds
    buffer_load_dwordx4 v5, s[56:59], s72 offen offset:3072 sc1 lds
    s_add_u32 s72, s72, s76
    v_pk_mul_f32 v[80:81], v[134:135], v[158:159]
    v_pk_mul_f32 v[82:83], v[136:137], v[158:159]
    v_pk_mul_f32 v[84:85], v[138:139], v[158:159]
    v_pk_mul_f32 v[86:87], v[140:141], v[158:159]
    v_cvt_pk_bf16_f32 v80, v80, v81
    v_and_b32 v81, s18, v80
    v_lshlrev_b32 v80, 16, v80
    v_cvt_pk_bf16_f32 v82, v82, v83
    v_and_b32 v83, s18, v82
    v_lshlrev_b32 v82, 16, v82
    v_cvt_pk_bf16_f32 v84, v84, v85
    v_and_b32 v85, s18, v84
    v_lshlrev_b32 v84, 16, v84
    v_cvt_pk_bf16_f32 v86, v86, v87
    v_and_b32 v87, s18, v86
    v_lshlrev_b32 v86, 16, v86
    v_pk_add_f32 v[88:89], v[88:89], v[80:81]
    v_pk_add_f32 v[90:91], v[90:91], v[82:83]
    v_pk_add_f32 v[92:93], v[92:93], v[84:85]
    v_pk_add_f32 v[94:95], v[94:95], v[86:87]
    v_cvt_pk_bf16_f32 v88, v88, v89
    v_and_b32 v89, s18, v88
    v_lshlrev_b32 v88, 16, v88
    v_cvt_pk_bf16_f32 v90, v90, v91
    v_and_b32 v91, s18, v90
    v_lshlrev_b32 v90, 16, v90
    v_cvt_pk_bf16_f32 v92, v92, v93
    v_and_b32 v93, s18, v92
    v_lshlrev_b32 v92, 16, v92
    v_cvt_pk_bf16_f32 v94, v94, v95
    v_and_b32 v95, s18, v94
    v_lshlrev_b32 v94, 16, v94
    s_add_u32 m0, s74, 98304
    s_nop 0
    buffer_load_dwordx4 v12, s[56:59], s72 offen offset:0 sc1 lds
    buffer_load_dwordx4 v18, s[56:59], s72 offen offset:1024 sc1 lds
    v_pk_mul_f32 v[72:73], v[136:137], v[156:157]
    v_pk_mul_f32 v[74:75], v[138:139], v[156:157]
    v_pk_mul_f32 v[76:77], v[140:141], v[156:157]
    v_pk_mul_f32 v[78:79], v[142:143], v[156:157]
    v_cvt_pk_bf16_f32 v72, v72, v73
    v_and_b32 v73, s18, v72
    v_lshlrev_b32 v72, 16, v72
    v_cvt_pk_bf16_f32 v74, v74, v75
    v_and_b32 v75, s18, v74
    v_lshlrev_b32 v74, 16, v74
    v_cvt_pk_bf16_f32 v76, v76, v77
    v_and_b32 v77, s18, v76
    v_lshlrev_b32 v76, 16, v76
    v_cvt_pk_bf16_f32 v78, v78, v79
    v_and_b32 v79, s18, v78
    v_lshlrev_b32 v78, 16, v78
    v_pk_add_f32 v[88:89], v[88:89], v[72:73]
    v_pk_add_f32 v[90:91], v[90:91], v[74:75]
    v_pk_add_f32 v[92:93], v[92:93], v[76:77]
    v_pk_add_f32 v[94:95], v[94:95], v[78:79]
    v_cvt_pk_bf16_f32 v88, v88, v89
    v_and_b32 v89, s18, v88
    v_lshlrev_b32 v88, 16, v88
    v_cvt_pk_bf16_f32 v90, v90, v91
    v_and_b32 v91, s18, v90
    v_lshlrev_b32 v90, 16, v90
    v_cvt_pk_bf16_f32 v92, v92, v93
    v_and_b32 v93, s18, v92
    v_lshlrev_b32 v92, 16, v92
    v_cvt_pk_bf16_f32 v94, v94, v95
    v_and_b32 v95, s18, v94
    v_lshlrev_b32 v94, 16, v94
    buffer_load_dwordx4 v19, s[56:59], s72 offen offset:2048 sc1 lds
    buffer_load_dwordx4 v5, s[56:59], s72 offen offset:3072 sc1 lds
    s_add_u32 s72, s72, s76
    v_pk_mul_f32 v[64:65], v[138:139], v[154:155]
    v_pk_mul_f32 v[66:67], v[140:141], v[154:155]
    v_pk_mul_f32 v[68:69], v[142:143], v[154:155]
    v_pk_mul_f32 v[70:71], v[144:145], v[154:155]
    v_cvt_pk_bf16_f32 v64, v64, v65
    v_and_b32 v65, s18, v64
    v_lshlrev_b32 v64, 16, v64
    v_cvt_pk_bf16_f32 v66, v66, v67
    v_and_b32 v67, s18, v66
    v_lshlrev_b32 v66, 16, v66
    v_cvt_pk_bf16_f32 v68, v68, v69
    v_and_b32 v69, s18, v68
    v_lshlrev_b32 v68, 16, v68
    v_cvt_pk_bf16_f32 v70, v70, v71
    v_and_b32 v71, s18, v70
    v_lshlrev_b32 v70, 16, v70
    v_pk_add_f32 v[88:89], v[88:89], v[64:65]
    v_pk_add_f32 v[90:91], v[90:91], v[66:67]
    v_pk_add_f32 v[92:93], v[92:93], v[68:69]
    v_pk_add_f32 v[94:95], v[94:95], v[70:71]
    v_cvt_pk_bf16_f32 v88, v88, v89
    v_and_b32 v89, s18, v88
    v_lshlrev_b32 v88, 16, v88
    v_cvt_pk_bf16_f32 v90, v90, v91
    v_and_b32 v91, s18, v90
    v_lshlrev_b32 v90, 16, v90
    v_cvt_pk_bf16_f32 v92, v92, v93
    v_and_b32 v93, s18, v92
    v_lshlrev_b32 v92, 16, v92
    v_cvt_pk_bf16_f32 v94, v94, v95
    v_and_b32 v95, s18, v94
    v_lshlrev_b32 v94, 16, v94
    s_add_u32 m0, s74, 114688
    s_nop 0
    buffer_load_dwordx4 v12, s[56:59], s72 offen offset:0 sc1 lds
    buffer_load_dwordx4 v18, s[56:59], s72 offen offset:1024 sc1 lds
    v_pk_mul_f32 v[88:89], v[88:89], v[146:147]
    v_pk_mul_f32 v[90:91], v[90:91], v[148:149]
    v_pk_mul_f32 v[92:93], v[92:93], v[150:151]
    v_pk_mul_f32 v[94:95], v[94:95], v[152:153]
    v_cvt_pk_bf16_f32 v162, v94, v92
    v_cvt_pk_bf16_f32 v163, v90, v88
    ds_write_b64 v22, v[162:163] offset:0
    v_cvt_pk_bf16_f32 v164, v95, v93
    v_cvt_pk_bf16_f32 v165, v91, v89
    ds_write_b64 v22, v[164:165] offset:128
    v_accvgpr_read_b32 v100, a129
    v_accvgpr_read_b32 v101, a133
    v_accvgpr_read_b32 v102, a137
    v_accvgpr_read_b32 v103, a141
    v_accvgpr_read_b32 v104, a145
    v_accvgpr_read_b32 v105, a149
    v_accvgpr_read_b32 v106, a153
    v_accvgpr_read_b32 v107, a157
    v_accvgpr_read_b32 v108, a161
    v_accvgpr_read_b32 v109, a165
    v_accvgpr_read_b32 v110, a169
    v_accvgpr_read_b32 v111, a176
    v_accvgpr_read_b32 v112, a177
    v_accvgpr_read_b32 v113, a178
    v_accvgpr_read_b32 v114, a179
    v_lshlrev_b32 v132, 16, v100
    v_and_b32 v133, s18, v100
    v_lshlrev_b32 v134, 16, v101
    v_and_b32 v135, s18, v101
    v_lshlrev_b32 v136, 16, v102
    v_and_b32 v137, s18, v102
    v_lshlrev_b32 v138, 16, v103
    v_and_b32 v139, s18, v103
    v_lshlrev_b32 v140, 16, v104
    v_and_b32 v141, s18, v104
    v_lshlrev_b32 v142, 16, v105
    v_and_b32 v143, s18, v105
    v_lshlrev_b32 v144, 16, v106
    v_and_b32 v145, s18, v106
    v_lshlrev_b32 v146, 16, v107
    v_and_b32 v147, s18, v107
    v_lshlrev_b32 v148, 16, v108
    v_and_b32 v149, s18, v108
    v_lshlrev_b32 v150, 16, v109
    v_and_b32 v151, s18, v109
    v_lshlrev_b32 v152, 16, v110
    v_and_b32 v153, s18, v110
    v_lshlrev_b32 v154, 16, v111
    v_lshlrev_b32 v155, 16, v113
    v_and_b32 v156, s18, v111
    v_and_b32 v157, s18, v113
    v_lshlrev_b32 v158, 16, v112
    v_lshlrev_b32 v159, 16, v114
    v_and_b32 v160, s18, v112
    v_and_b32 v161, s18, v114
    buffer_load_dwordx4 v19, s[56:59], s72 offen offset:2048 sc1 lds
    buffer_load_dwordx4 v5, s[56:59], s72 offen offset:3072 sc1 lds
    s_add_u32 s72, s72, s76
    v_pk_mul_f32 v[88:89], v[132:133], v[160:161]
    v_pk_mul_f32 v[90:91], v[134:135], v[160:161]
    v_pk_mul_f32 v[92:93], v[136:137], v[160:161]
    v_pk_mul_f32 v[94:95], v[138:139], v[160:161]
    v_cvt_pk_bf16_f32 v88, v88, v89
    v_and_b32 v89, s18, v88
    v_lshlrev_b32 v88, 16, v88
    v_cvt_pk_bf16_f32 v90, v90, v91
    v_and_b32 v91, s18, v90
    v_lshlrev_b32 v90, 16, v90
    v_cvt_pk_bf16_f32 v92, v92, v93
    v_and_b32 v93, s18, v92
    v_lshlrev_b32 v92, 16, v92
    v_cvt_pk_bf16_f32 v94, v94, v95
    v_and_b32 v95, s18, v94
    v_lshlrev_b32 v94, 16, v94
    s_waitcnt vmcnt(12)
    s_barrier
    s_lshl_b32 s66, s30, 5
    s_add_u32 s66, s66, s31
    s_lshl_b32 s67, s66, 3
    s_add_u32 s67, s67, 2048
    s_cmp_lg_u32 s3, 0
    s_cbranch_scc1 nosig_6
    s_mov_b64 exec, 1
    v_mov_b32 v28, s64
    v_mov_b32 v29, s65
    v_mov_b32 v30, 0
    buffer_store_dwordx2 v[28:29], v30, s[60:63], s67 offen sc1
    s_mov_b64 exec, -1
nosig_6:
    s_add_u32 m0, s74, 0
    s_nop 0
    buffer_load_dwordx4 v12, s[56:59], s72 offen offset:0 sc1 lds
    buffer_load_dwordx4 v18, s[56:59], s72 offen offset:1024 sc1 lds
    v_pk_mul_f32 v[80:81], v[134:135], v[158:159]
    v_pk_mul_f32 v[82:83], v[136:137], v[158:159]
    v_pk_mul_f32 v[84:85], v[138:139], v[158:159]
    v_pk_mul_f32 v[86:87], v[140:141], v[158:159]
    v_cvt_pk_bf16_f32 v80, v80, v81
    v_and_b32 v81, s18, v80
    v_lshlrev_b32 v80, 16, v80
    v_cvt_pk_bf16_f32 v82, v82, v83
    v_and_b32 v83, s18, v82
    v_lshlrev_b32 v82, 16, v82
    v_cvt_pk_bf16_f32 v84, v84, v85
    v_and_b32 v85, s18, v84
    v_lshlrev_b32 v84, 16, v84
    v_cvt_pk_bf16_f32 v86, v86, v87
    v_and_b32 v87, s18, v86
    v_lshlrev_b32 v86, 16, v86
    v_pk_add_f32 v[88:89], v[88:89], v[80:81]
    v_pk_add_f32 v[90:91], v[90:91], v[82:83]
    v_pk_add_f32 v[92:93], v[92:93], v[84:85]
    v_pk_add_f32 v[94:95], v[94:95], v[86:87]
    v_cvt_pk_bf16_f32 v88, v88, v89
    v_and_b32 v89, s18, v88
    v_lshlrev_b32 v88, 16, v88
    v_cvt_pk_bf16_f32 v90, v90, v91
    v_and_b32 v91, s18, v90
    v_lshlrev_b32 v90, 16, v90
    v_cvt_pk_bf16_f32 v92, v92, v93
    v_and_b32 v93, s18, v92
    v_lshlrev_b32 v92, 16, v92
    v_cvt_pk_bf16_f32 v94, v94, v95
    v_and_b32 v95, s18, v94
    v_lshlrev_b32 v94, 16, v94
    buffer_load_dwordx4 v19, s[56:59], s72 offen offset:2048 sc1 lds
    buffer_load_dwordx4 v5, s[56:59], s72 offen offset:3072 sc1 lds
    s_add_u32 s72, s72, s76
    v_pk_mul_f32 v[72:73], v[136:137], v[156:157]
    v_pk_mul_f32 v[74:75], v[138:139], v[156:157]
    v_pk_mul_f32 v[76:77], v[140:141], v[156:157]
    v_pk_mul_f32 v[78:79], v[142:143], v[156:157]
    v_cvt_pk_bf16_f32 v72, v72, v73
    v_and_b32 v73, s18, v72
    v_lshlrev_b32 v72, 16, v72
    v_cvt_pk_bf16_f32 v74, v74, v75
    v_and_b32 v75, s18, v74
    v_lshlrev_b32 v74, 16, v74
    v_cvt_pk_bf16_f32 v76, v76, v77
    v_and_b32 v77, s18, v76
    v_lshlrev_b32 v76, 16, v76
    v_cvt_pk_bf16_f32 v78, v78, v79
    v_and_b32 v79, s18, v78
    v_lshlrev_b32 v78, 16, v78
    v_pk_add_f32 v[88:89], v[88:89], v[72:73]
    v_pk_add_f32 v[90:91], v[90:91], v[74:75]
    v_pk_add_f32 v[92:93], v[92:93], v[76:77]
    v_pk_add_f32 v[94:95], v[94:95], v[78:79]
    v_cvt_pk_bf16_f32 v88, v88, v89
    v_and_b32 v89, s18, v88
    v_lshlrev_b32 v88, 16, v88
    v_cvt_pk_bf16_f32 v90, v90, v91
    v_and_b32 v91, s18, v90
    v_lshlrev_b32 v90, 16, v90
    v_cvt_pk_bf16_f32 v92, v92, v93
    v_and_b32 v93, s18, v92
    v_lshlrev_b32 v92, 16, v92
    v_cvt_pk_bf16_f32 v94, v94, v95
    v_and_b32 v95, s18, v94
    v_lshlrev_b32 v94, 16, v94
    s_add_u32 m0, s74, 16384
    s_nop 0
    buffer_load_dwordx4 v12, s[56:59], s72 offen offset:0 sc1 lds
    buffer_load_dwordx4 v18, s[56:59], s72 offen offset:1024 sc1 lds
    v_pk_mul_f32 v[64:65], v[138:139], v[154:155]
    v_pk_mul_f32 v[66:67], v[140:141], v[154:155]
    v_pk_mul_f32 v[68:69], v[142:143], v[154:155]
    v_pk_mul_f32 v[70:71], v[144:145], v[154:155]
    v_cvt_pk_bf16_f32 v64, v64, v65
    v_and_b32 v65, s18, v64
    v_lshlrev_b32 v64, 16, v64
    v_cvt_pk_bf16_f32 v66, v66, v67
    v_and_b32 v67, s18, v66
    v_lshlrev_b32 v66, 16, v66
    v_cvt_pk_bf16_f32 v68, v68, v69
    v_and_b32 v69, s18, v68
    v_lshlrev_b32 v68, 16, v68
    v_cvt_pk_bf16_f32 v70, v70, v71
    v_and_b32 v71, s18, v70
    v_lshlrev_b32 v70, 16, v70
    v_pk_add_f32 v[88:89], v[88:89], v[64:65]
    v_pk_add_f32 v[90:91], v[90:91], v[66:67]
    v_pk_add_f32 v[92:93], v[92:93], v[68:69]
    v_pk_add_f32 v[94:95], v[94:95], v[70:71]
    v_cvt_pk_bf16_f32 v88, v88, v89
    v_and_b32 v89, s18, v88
    v_lshlrev_b32 v88, 16, v88
    v_cvt_pk_bf16_f32 v90, v90, v91
    v_and_b32 v91, s18, v90
    v_lshlrev_b32 v90, 16, v90
    v_cvt_pk_bf16_f32 v92, v92, v93
    v_and_b32 v93, s18, v92
    v_lshlrev_b32 v92, 16, v92
    v_cvt_pk_bf16_f32 v94, v94, v95
    v_and_b32 v95, s18, v94
    v_lshlrev_b32 v94, 16, v94
    buffer_load_dwordx4 v19, s[56:59], s72 offen offset:2048 sc1 lds
    buffer_load_dwordx4 v5, s[56:59], s72 offen offset:3072 sc1 lds
    s_add_u32 s72, s72, s76
    v_pk_mul_f32 v[88:89], v[88:89], v[146:147]
    v_pk_mul_f32 v[90:91], v[90:91], v[148:149]
    v_pk_mul_f32 v[92:93], v[92:93], v[150:151]
    v_pk_mul_f32 v[94:95], v[94:95], v[152:153]
    v_cvt_pk_bf16_f32 v162, v94, v92
    v_cvt_pk_bf16_f32 v163, v90, v88
    ds_write_b64 v22, v[162:163] offset:256
    v_cvt_pk_bf16_f32 v164, v95, v93
    v_cvt_pk_bf16_f32 v165, v91, v89
    ds_write_b64 v22, v[164:165] offset:384
    v_accvgpr_read_b32 v100, a130
    v_accvgpr_read_b32 v101, a134
    v_accvgpr_read_b32 v102, a138
    v_accvgpr_read_b32 v103, a142
    v_accvgpr_read_b32 v104, a146
    v_accvgpr_read_b32 v105, a150
    v_accvgpr_read_b32 v106, a154
    v_accvgpr_read_b32 v107, a158
    v_accvgpr_read_b32 v108, a162
    v_accvgpr_read_b32 v109, a166
    v_accvgpr_read_b32 v110, a170
    v_accvgpr_read_b32 v111, a180
    v_accvgpr_read_b32 v112, a181
    v_accvgpr_read_b32 v113, a182
    v_accvgpr_read_b32 v114, a183
    v_lshlrev_b32 v132, 16, v100
    v_and_b32 v133, s18, v100
    v_lshlrev_b32 v134, 16, v101
    v_and_b32 v135, s18, v101
    v_lshlrev_b32 v136, 16, v102
    v_and_b32 v137, s18, v102
    v_lshlrev_b32 v138, 16, v103
    v_and_b32 v139, s18, v103
    v_lshlrev_b32 v140, 16, v104
    v_and_b32 v141, s18, v104
    v_lshlrev_b32 v142, 16, v105
    v_and_b32 v143, s18, v105
    v_lshlrev_b32 v144, 16, v106
    v_and_b32 v145, s18, v106
    v_lshlrev_b32 v146, 16, v107
    v_and_b32 v147, s18, v107
    v_lshlrev_b32 v148, 16, v108
    v_and_b32 v149, s18, v108
    v_lshlrev_b32 v150, 16, v109
    v_and_b32 v151, s18, v109
    v_lshlrev_b32 v152, 16, v110
    v_and_b32 v153, s18, v110
    v_lshlrev_b32 v154, 16, v111
    v_lshlrev_b32 v155, 16, v113
    v_and_b32 v156, s18, v111
    v_and_b32 v157, s18, v113
    v_lshlrev_b32 v158, 16, v112
    v_lshlrev_b32 v159, 16, v114
    v_and_b32 v160, s18, v112
    v_and_b32 v161, s18, v114
    s_add_u32 m0, s74, 32768
    s_nop 0
    buffer_load_dwordx4 v12, s[56:59], s72 offen offset:0 sc1 lds
    buffer_load_dwordx4 v18, s[56:59], s72 offen offset:1024 sc1 lds
    v_pk_mul_f32 v[88:89], v[132:133], v[160:161]
    v_pk_mul_f32 v[90:91], v[134:135], v[160:161]
    v_pk_mul_f32 v[92:93], v[136:137], v[160:161]
    v_pk_mul_f32 v[94:95], v[138:139], v[160:161]
    v_cvt_pk_bf16_f32 v88, v88, v89
    v_and_b32 v89, s18, v88
    v_lshlrev_b32 v88, 16, v88
    v_cvt_pk_bf16_f32 v90, v90, v91
    v_and_b32 v91, s18, v90
    v_lshlrev_b32 v90, 16, v90
    v_cvt_pk_bf16_f32 v92, v92, v93
    v_and_b32 v93, s18, v92
    v_lshlrev_b32 v92, 16, v92
    v_cvt_pk_bf16_f32 v94, v94, v95
    v_and_b32 v95, s18, v94
    v_lshlrev_b32 v94, 16, v94
    buffer_load_dwordx4 v19, s[56:59], s72 offen offset:2048 sc1 lds
    buffer_load_dwordx4 v5, s[56:59], s72 offen offset:3072 sc1 lds
    s_add_u32 s72, s72, s76
    v_pk_mul_f32 v[80:81], v[134:135], v[158:159]
    v_pk_mul_f32 v[82:83], v[136:137], v[158:159]
    v_pk_mul_f32 v[84:85], v[138:139], v[158:159]
    v_pk_mul_f32 v[86:87], v[140:141], v[158:159]
    v_cvt_pk_bf16_f32 v80, v80, v81
    v_and_b32 v81, s18, v80
    v_lshlrev_b32 v80, 16, v80
    v_cvt_pk_bf16_f32 v82, v82, v83
    v_and_b32 v83, s18, v82
    v_lshlrev_b32 v82, 16, v82
    v_cvt_pk_bf16_f32 v84, v84, v85
    v_and_b32 v85, s18, v84
    v_lshlrev_b32 v84, 16, v84
    v_cvt_pk_bf16_f32 v86, v86, v87
    v_and_b32 v87, s18, v86
    v_lshlrev_b32 v86, 16, v86
    v_pk_add_f32 v[88:89], v[88:89], v[80:81]
    v_pk_add_f32 v[90:91], v[90:91], v[82:83]
    v_pk_add_f32 v[92:93], v[92:93], v[84:85]
    v_pk_add_f32 v[94:95], v[94:95], v[86:87]
    v_cvt_pk_bf16_f32 v88, v88, v89
    v_and_b32 v89, s18, v88
    v_lshlrev_b32 v88, 16, v88
    v_cvt_pk_bf16_f32 v90, v90, v91
    v_and_b32 v91, s18, v90
    v_lshlrev_b32 v90, 16, v90
    v_cvt_pk_bf16_f32 v92, v92, v93
    v_and_b32 v93, s18, v92
    v_lshlrev_b32 v92, 16, v92
    v_cvt_pk_bf16_f32 v94, v94, v95
    v_and_b32 v95, s18, v94
    v_lshlrev_b32 v94, 16, v94
    s_add_u32 m0, s74, 49152
    s_nop 0
    buffer_load_dwordx4 v12, s[56:59], s72 offen offset:0 sc1 lds
    buffer_load_dwordx4 v18, s[56:59], s72 offen offset:1024 sc1 lds
    v_pk_mul_f32 v[72:73], v[136:137], v[156:157]
    v_pk_mul_f32 v[74:75], v[138:139], v[156:157]
    v_pk_mul_f32 v[76:77], v[140:141], v[156:157]
    v_pk_mul_f32 v[78:79], v[142:143], v[156:157]
    v_cvt_pk_bf16_f32 v72, v72, v73
    v_and_b32 v73, s18, v72
    v_lshlrev_b32 v72, 16, v72
    v_cvt_pk_bf16_f32 v74, v74, v75
    v_and_b32 v75, s18, v74
    v_lshlrev_b32 v74, 16, v74
    v_cvt_pk_bf16_f32 v76, v76, v77
    v_and_b32 v77, s18, v76
    v_lshlrev_b32 v76, 16, v76
    v_cvt_pk_bf16_f32 v78, v78, v79
    v_and_b32 v79, s18, v78
    v_lshlrev_b32 v78, 16, v78
    v_pk_add_f32 v[88:89], v[88:89], v[72:73]
    v_pk_add_f32 v[90:91], v[90:91], v[74:75]
    v_pk_add_f32 v[92:93], v[92:93], v[76:77]
    v_pk_add_f32 v[94:95], v[94:95], v[78:79]
    v_cvt_pk_bf16_f32 v88, v88, v89
    v_and_b32 v89, s18, v88
    v_lshlrev_b32 v88, 16, v88
    v_cvt_pk_bf16_f32 v90, v90, v91
    v_and_b32 v91, s18, v90
    v_lshlrev_b32 v90, 16, v90
    v_cvt_pk_bf16_f32 v92, v92, v93
    v_and_b32 v93, s18, v92
    v_lshlrev_b32 v92, 16, v92
    v_cvt_pk_bf16_f32 v94, v94, v95
    v_and_b32 v95, s18, v94
    v_lshlrev_b32 v94, 16, v94
    buffer_load_dwordx4 v19, s[56:59], s72 offen offset:2048 sc1 lds
    buffer_load_dwordx4 v5, s[56:59], s72 offen offset:3072 sc1 lds
    s_add_u32 s72, s72, s76
    v_pk_mul_f32 v[64:65], v[138:139], v[154:155]
    v_pk_mul_f32 v[66:67], v[140:141], v[154:155]
    v_pk_mul_f32 v[68:69], v[142:143], v[154:155]
    v_pk_mul_f32 v[70:71], v[144:145], v[154:155]
    v_cvt_pk_bf16_f32 v64, v64, v65
    v_and_b32 v65, s18, v64
    v_lshlrev_b32 v64, 16, v64
    v_cvt_pk_bf16_f32 v66, v66, v67
    v_and_b32 v67, s18, v66
    v_lshlrev_b32 v66, 16, v66
    v_cvt_pk_bf16_f32 v68, v68, v69
    v_and_b32 v69, s18, v68
    v_lshlrev_b32 v68, 16, v68
    v_cvt_pk_bf16_f32 v70, v70, v71
    v_and_b32 v71, s18, v70
    v_lshlrev_b32 v70, 16, v70
    v_pk_add_f32 v[88:89], v[88:89], v[64:65]
    v_pk_add_f32 v[90:91], v[90:91], v[66:67]
    v_pk_add_f32 v[92:93], v[92:93], v[68:69]
    v_pk_add_f32 v[94:95], v[94:95], v[70:71]
    v_cvt_pk_bf16_f32 v88, v88, v89
    v_and_b32 v89, s18, v88
    v_lshlrev_b32 v88, 16, v88
    v_cvt_pk_bf16_f32 v90, v90, v91
    v_and_b32 v91, s18, v90
    v_lshlrev_b32 v90, 16, v90
    v_cvt_pk_bf16_f32 v92, v92, v93
    v_and_b32 v93, s18, v92
    v_lshlrev_b32 v92, 16, v92
    v_cvt_pk_bf16_f32 v94, v94, v95
    v_and_b32 v95, s18, v94
    v_lshlrev_b32 v94, 16, v94
    s_lshr_b32 s79, s32, 1
    s_lshl_b32 s79, s79, 8
    s_add_u32 s75, s79, 0
    s_add_u32 s79, s79, 2048
    s_cmp_lg_u32 s3, 0
    s_cbranch_scc1 nph_7
    buffer_load_dwordx2 v[26:27], v13, s[60:63], s75 offen sc1
    buffer_load_dwordx2 v[20:21], v13, s[60:63], s79 offen sc1
nph_7:
    s_add_u32 m0, s74, 65536
    s_nop 0
    buffer_load_dwordx4 v12, s[56:59], s72 offen offset:0 sc1 lds
    buffer_load_dwordx4 v18, s[56:59], s72 offen offset:1024 sc1 lds
    v_pk_mul_f32 v[88:89], v[88:89], v[146:147]
    v_pk_mul_f32 v[90:91], v[90:91], v[148:149]
    v_pk_mul_f32 v[92:93], v[92:93], v[150:151]
    v_pk_mul_f32 v[94:95], v[94:95], v[152:153]
    v_cvt_pk_bf16_f32 v162, v94, v92
    v_cvt_pk_bf16_f32 v163, v90, v88
    ds_write_b64 v22, v[162:163] offset:512
    v_cvt_pk_bf16_f32 v164, v95, v93
    v_cvt_pk_bf16_f32 v165, v91, v89
    ds_write_b64 v22, v[164:165] offset:640
    v_accvgpr_read_b32 v100, a131
    v_accvgpr_read_b32 v101, a135
    v_accvgpr_read_b32 v102, a139
    v_accvgpr_read_b32 v103, a143
    v_accvgpr_read_b32 v104, a147
    v_accvgpr_read_b32 v105, a151
    v_accvgpr_read_b32 v106, a155
    v_accvgpr_read_b32 v107, a159
    v_accvgpr_read_b32 v108, a163
    v_accvgpr_read_b32 v109, a167
    v_accvgpr_read_b32 v110, a171
    v_accvgpr_read_b32 v111, a184
    v_accvgpr_read_b32 v112, a185
    v_accvgpr_read_b32 v113, a186
    v_accvgpr_read_b32 v114, a187
    v_lshlrev_b32 v132, 16, v100
    v_and_b32 v133, s18, v100
    v_lshlrev_b32 v134, 16, v101
    v_and_b32 v135, s18, v101
    v_lshlrev_b32 v136, 16, v102
    v_and_b32 v137, s18, v102
    v_lshlrev_b32 v138, 16, v103
    v_and_b32 v139, s18, v103
    v_lshlrev_b32 v140, 16, v104
    v_and_b32 v141, s18, v104
    v_lshlrev_b32 v142, 16, v105
    v_and_b32 v143, s18, v105
    v_lshlrev_b32 v144, 16, v106
    v_and_b32 v145, s18, v106
    v_lshlrev_b32 v146, 16, v107
    v_and_b32 v147, s18, v107
    v_lshlrev_b32 v148, 16, v108
    v_and_b32 v149, s18, v108
    v_lshlrev_b32 v150, 16, v109
    v_and_b32 v151, s18, v109
    v_lshlrev_b32 v152, 16, v110
    v_and_b32 v153, s18, v110
    v_lshlrev_b32 v154, 16, v111
    v_lshlrev_b32 v155, 16, v113
    v_and_b32 v156, s18, v111
    v_and_b32 v157, s18, v113
    v_lshlrev_b32 v158, 16, v112
    v_lshlrev_b32 v159, 16, v114
    v_and_b32 v160, s18, v112
    v_and_b32 v161, s18, v114
    buffer_load_dwordx4 v19, s[56:59], s72 offen offset:2048 sc1 lds
    buffer_load_dwordx4 v5, s[56:59], s72 offen offset:3072 sc1 lds
    s_add_u32 s72, s72, s76
    v_pk_mul_f32 v[88:89], v[132:133], v[160:161]
    v_pk_mul_f32 v[90:91], v[134:135], v[160:161]
    v_pk_mul_f32 v[92:93], v[136:137], v[160:161]
    v_pk_mul_f32 v[94:95], v[138:139], v[160:161]
    v_cvt_pk_bf16_f32 v88, v88, v89
    v_and_b32 v89, s18, v88
    v_lshlrev_b32 v88, 16, v88
    v_cvt_pk_bf16_f32 v90, v90, v91
    v_and_b32 v91, s18, v90
    v_lshlrev_b32 v90, 16, v90
    v_cvt_pk_bf16_f32 v92, v92, v93
    v_and_b32 v93, s18, v92
    v_lshlrev_b32 v92, 16, v92
    v_cvt_pk_bf16_f32 v94, v94, v95
    v_and_b32 v95, s18, v94
    v_lshlrev_b32 v94, 16, v94
    v_pk_mul_f32 v[80:81], v[134:135], v[158:159]
    v_pk_mul_f32 v[82:83], v[136:137], v[158:159]
    v_pk_mul_f32 v[84:85], v[138:139], v[158:159]
    v_pk_mul_f32 v[86:87], v[140:141], v[158:159]
    v_cvt_pk_bf16_f32 v80, v80, v81
    v_and_b32 v81, s18, v80
    v_lshlrev_b32 v80, 16, v80
    v_cvt_pk_bf16_f32 v82, v82, v83
    v_and_b32 v83, s18, v82
    v_lshlrev_b32 v82, 16, v82
    v_cvt_pk_bf16_f32 v84, v84, v85
    v_and_b32 v85, s18, v84
    v_lshlrev_b32 v84, 16, v84
    v_cvt_pk_bf16_f32 v86, v86, v87
    v_and_b32 v87, s18, v86
    v_lshlrev_b32 v86, 16, v86
    v_pk_add_f32 v[88:89], v[88:89], v[80:81]
    v_pk_add_f32 v[90:91], v[90:91], v[82:83]
    v_pk_add_f32 v[92:93], v[92:93], v[84:85]
    v_pk_add_f32 v[94:95], v[94:95], v[86:87]
    v_cvt_pk_bf16_f32 v88, v88, v89
    v_and_b32 v89, s18, v88
    v_lshlrev_b32 v88, 16, v88
    v_cvt_pk_bf16_f32 v90, v90, v91
    v_and_b32 v91, s18, v90
    v_lshlrev_b32 v90, 16, v90
    v_cvt_pk_bf16_f32 v92, v92, v93
    v_and_b32 v93, s18, v92
    v_lshlrev_b32 v92, 16, v92
    v_cvt_pk_bf16_f32 v94, v94, v95
    v_and_b32 v95, s18, v94
    v_lshlrev_b32 v94, 16, v94
    v_pk_mul_f32 v[72:73], v[136:137], v[156:157]
    v_pk_mul_f32 v[74:75], v[138:139], v[156:157]
    v_pk_mul_f32 v[76:77], v[140:141], v[156:157]
    v_pk_mul_f32 v[78:79], v[142:143], v[156:157]
    v_cvt_pk_bf16_f32 v72, v72, v73
    v_and_b32 v73, s18, v72
    v_lshlrev_b32 v72, 16, v72
    v_cvt_pk_bf16_f32 v74, v74, v75
    v_and_b32 v75, s18, v74
    v_lshlrev_b32 v74, 16, v74
    v_cvt_pk_bf16_f32 v76, v76, v77
    v_and_b32 v77, s18, v76
    v_lshlrev_b32 v76, 16, v76
    v_cvt_pk_bf16_f32 v78, v78, v79
    v_and_b32 v79, s18, v78
    v_lshlrev_b32 v78, 16, v78
    v_pk_add_f32 v[88:89], v[88:89], v[72:73]
    v_pk_add_f32 v[90:91], v[90:91], v[74:75]
    v_pk_add_f32 v[92:93], v[92:93], v[76:77]
    v_pk_add_f32 v[94:95], v[94:95], v[78:79]
    v_cvt_pk_bf16_f32 v88, v88, v89
    v_and_b32 v89, s18, v88
    v_lshlrev_b32 v88, 16, v88
    v_cvt_pk_bf16_f32 v90, v90, v91
    v_and_b32 v91, s18, v90
    v_lshlrev_b32 v90, 16, v90
    v_cvt_pk_bf16_f32 v92, v92, v93
    v_and_b32 v93, s18, v92
    v_lshlrev_b32 v92, 16, v92
    v_cvt_pk_bf16_f32 v94, v94, v95
    v_and_b32 v95, s18, v94
    v_lshlrev_b32 v94, 16, v94
    s_cmp_lg_u32 s3, 0
    s_cbranch_scc1 nph_8
    buffer_load_dwordx2 v[14:15], v13, s[60:63], s79 offen sc1
nph_8:
    v_pk_mul_f32 v[64:65], v[138:139], v[154:155]
    v_pk_mul_f32 v[66:67], v[140:141], v[154:155]
    v_pk_mul_f32 v[68:69], v[142:143], v[154:155]
    v_pk_mul_f32 v[70:71], v[144:145], v[154:155]
    v_cvt_pk_bf16_f32 v64, v64, v65
    v_and_b32 v65, s18, v64
    v_lshlrev_b32 v64, 16, v64
    v_cvt_pk_bf16_f32 v66, v66, v67
    v_and_b32 v67, s18, v66
    v_lshlrev_b32 v66, 16, v66
    v_cvt_pk_bf16_f32 v68, v68, v69
    v_and_b32 v69, s18, v68
    v_lshlrev_b32 v68, 16, v68
    v_cvt_pk_bf16_f32 v70, v70, v71
    v_and_b32 v71, s18, v70
    v_lshlrev_b32 v70, 16, v70
    v_pk_add_f32 v[88:89], v[88:89], v[64:65]
    v_pk_add_f32 v[90:91], v[90:91], v[66:67]
    v_pk_add_f32 v[92:93], v[92:93], v[68:69]
    v_pk_add_f32 v[94:95], v[94:95], v[70:71]
    v_cvt_pk_bf16_f32 v88, v88, v89
    v_and_b32 v89, s18, v88
    v_lshlrev_b32 v88, 16, v88
    v_cvt_pk_bf16_f32 v90, v90, v91
    v_and_b32 v91, s18, v90
    v_lshlrev_b32 v90, 16, v90
    v_cvt_pk_bf16_f32 v92, v92, v93
    v_and_b32 v93, s18, v92
    v_lshlrev_b32 v92, 16, v92
    v_cvt_pk_bf16_f32 v94, v94, v95
    v_and_b32 v95, s18, v94
    v_lshlrev_b32 v94, 16, v94
    v_pk_mul_f32 v[88:89], v[88:89], v[146:147]
    v_pk_mul_f32 v[90:91], v[90:91], v[148:149]
    v_pk_mul_f32 v[92:93], v[92:93], v[150:151]
    v_pk_mul_f32 v[94:95], v[94:95], v[152:153]
    v_cvt_pk_bf16_f32 v162, v94, v92
    v_cvt_pk_bf16_f32 v163, v90, v88
    ds_write_b64 v22, v[162:163] offset:768
    v_cvt_pk_bf16_f32 v164, v95, v93
    v_cvt_pk_bf16_f32 v165, v91, v89
    ds_write_b64 v22, v[164:165] offset:896
    v_lshrrev_b32 v17, 3, v1
    v_and_b32 v16, 7, v1
    v_mul_u32_u24 v24, 32, v2
    v_add_u32 v24, v24, v17
    v_lshrrev_b32 v22, 3, v24
    v_and_b32 v22, 7, v22
    v_xor_b32 v22, v22, v16
    v_lshlrev_b32 v22, 4, v22
    v_mul_u32_u24 v23, 128, v24
    v_add_u32 v22, v22, v23
    v_add_u32 v22, 131072, v22
    v_xor_b32 v23, 16, v22
    v_xor_b32 v28, 32, v22
    v_xor_b32 v29, 48, v22
    v_mul_u32_u24 v24, 4608, v24
    v_lshl_add_u32 v24, v16, 4, v24
    v_lshrrev_b32 v17, 4, v1
    v_and_b32 v16, 15, v1
    s_lshl_b32 s66, s32, 2
    s_add_u32 s66, s66, s3
    s_lshl_b32 s69, s66, 8
    s_mul_i32 s66, s66, 229376
    s_add_u32 s66, s66, 4194304
    s_add_u32 s36, s28, s66
    s_addc_u32 s37, s29, 0
    s_mov_b32 s38, 229376
    s_mov_b32 s39, 0x20000
    s_cmp_lg_u32 s3, 0
    s_cbranch_scc1 h_seen
    s_waitcnt vmcnt(3)
    s_mov_b32 exec_lo, 0xffffffff
    s_mov_b32 exec_hi, 0
    s_mov_b32 s66, 0
poll_9:
    v_cmp_ne_u64 vcc, s[64:65], v[26:27]
    s_nop 1
    s_cmp_eq_u64 vcc, 0
    s_cbranch_scc1 polled_10
    s_add_u32 s66, s66, 1
    s_cmp_ge_u32 s66, 0x40000
    s_cbranch_scc1 polled_10
    buffer_load_dwordx2 v[26:27], v13, s[60:63], s75 offen sc1
    s_waitcnt vmcnt(0)
    s_branch poll_9
polled_10:
    s_mov_b64 exec, -1
    s_mov_b32 exec_hi, 0
    v_cmp_ne_u64 vcc, s[64:65], v[20:21]
    s_mov_b64 exec, -1
    s_nop 0
    s_cmp_eq_u64 vcc, 0
    s_cbranch_scc1 h_seen
    s_waitcnt vmcnt(0)
    s_mov_b32 exec_lo, 0xffffffff
    s_mov_b32 exec_hi, 0
    s_mov_b32 s66, 0
poll_11:
    v_cmp_ne_u64 vcc, s[64:65], v[14:15]
    s_nop 1
    s_cmp_eq_u64 vcc, 0
    s_cbranch_scc1 polled_12
    s_add_u32 s66, s66, 1
    s_cmp_ge_u32 s66, 0x40000
    s_cbranch_scc1 polled_12
    buffer_load_dwordx2 v[14:15], v13, s[60:63], s79 offen sc1
    s_waitcnt vmcnt(0)
    s_branch poll_11
polled_12:
    s_mov_b64 exec, -1
h_seen:
    s_waitcnt vmcnt(28) lgkmcnt(0)
    s_barrier
    ds_read_b128 v[128:131], v22 offset:0
    ds_read_b128 v[132:135], v23 offset:1024
    ds_read_b128 v[136:139], v28 offset:2048
    ds_read_b128 v[140:143], v29 offset:3072
    buffer_load_dwordx4 a[0:3], v10, s[36:39], s77 offen offset:0 sc1
    buffer_load_dwordx4 a[4:7], v10, s[36:39], s77 offen offset:1024 sc1
    buffer_load_dwordx4 a[8:11], v10, s[36:39], s77 offen offset:2048 sc1
    buffer_load_dwordx4 a[12:15], v10, s[36:39], s77 offen offset:3072 sc1
    s_add_u32 s77, s77, 4096
    buffer_load_dwordx4 a[16:19], v10, s[36:39], s77 offen offset:0 sc1
    buffer_load_dwordx4 a[20:23], v10, s[36:39], s77 offen offset:1024 sc1
    buffer_load_dwordx4 a[24:27], v10, s[36:39], s77 offen offset:2048 sc1
    buffer_load_dwordx4 a[28:31], v10, s[36:39], s77 offen offset:3072 sc1
    s_add_u32 s77, s77, 4096
    s_add_u32 s44, s28, 18874368
    s_addc_u32 s45, s29, 0
    s_mov_b32 s46, 4726784
    s_mov_b32 s47, 0x20000
    s_mul_i32 s68, s71, 589824
    s_mul_i32 s17, s70, 128
    s_sub_u32 s17, 3968, s17
    s_add_u32 s17, s17, s68
    s_add_u32 s68, s68, 4096
    s_waitcnt lgkmcnt(0)
    buffer_store_dwordx4 v[128:131], v24, s[44:47], s17 offen sc1
    s_add_u32 s17, s17, 36864
    buffer_store_dwordx4 v[132:135], v24, s[44:47], s17 offen sc1
    s_add_u32 s17, s17, 36864
    buffer_store_dwordx4 v[136:139], v24, s[44:47], s17 offen sc1
    s_add_u32 s17, s17, 36864
    buffer_store_dwordx4 v[140:143], v24, s[44:47], s17 offen sc1
    s_add_u32 s17, s17, 36864
    v_lshrrev_b32 v28, 5, v1
    v_lshl_add_u32 v29, v2, 5, v28
    v_mul_u32_u24 v25, 4608, v29
    v_and_b32 v29, 31, v1
    v_lshl_add_u32 v25, v29, 4, v25
    s_cmp_lg_u32 s70, 0
    s_cbranch_scc1 nopad
    v_mov_b32 v144, 0
    v_mov_b32 v145, 0
    v_mov_b32 v146, 0
    v_mov_b32 v147, 0
    buffer_store_dwordx4 v[144:147], v25, s[44:47], s68 offen sc1
    s_add_u32 s68, s68, 9216
    buffer_store_dwordx4 v[144:147], v25, s[44:47], s68 offen sc1
    s_add_u32 s68, s68, 9216
    buffer_store_dwordx4 v[144:147], v25, s[44:47], s68 offen sc1
    s_add_u32 s68, s68, 9216
    buffer_store_dwordx4 v[144:147], v25, s[44:47], s68 offen sc1
    s_add_u32 s68, s68, 9216
    buffer_store_dwordx4 v[144:147], v25, s[44:47], s68 offen sc1
    s_add_u32 s68, s68, 9216
    buffer_store_dwordx4 v[144:147], v25, s[44:47], s68 offen sc1
    s_add_u32 s68, s68, 9216
    buffer_store_dwordx4 v[144:147], v25, s[44:47], s68 offen sc1
    s_add_u32 s68, s68, 9216
    buffer_store_dwordx4 v[144:147], v25, s[44:47], s68 offen sc1
    s_add_u32 s68, s68, 9216
    buffer_store_dwordx4 v[144:147], v25, s[44:47], s68 offen sc1
    s_add_u32 s68, s68, 9216
    buffer_store_dwordx4 v[144:147], v25, s[44:47], s68 offen sc1
    s_add_u32 s68, s68, 9216
    buffer_store_dwordx4 v[144:147], v25, s[44:47], s68 offen sc1
    s_add_u32 s68, s68, 9216
    buffer_store_dwordx4 v[144:147], v25, s[44:47], s68 offen sc1
    s_add_u32 s68, s68, 9216
    buffer_store_dwordx4 v[144:147], v25, s[44:47], s68 offen sc1
    s_add_u32 s68, s68, 9216
    buffer_store_dwordx4 v[144:147], v25, s[44:47], s68 offen sc1
    s_add_u32 s68, s68, 9216
    buffer_store_dwordx4 v[144:147], v25, s[44:47], s68 offen sc1
    s_add_u32 s68, s68, 9216
    buffer_store_dwordx4 v[144:147], v25, s[44:47], s68 offen sc1
    s_add_u32 s68, s68, 9216
nopad:
    v_lshlrev_b32 v7, 3, v29
    v_lshlrev_b32 v28, 3, v28
    v_bfe_u32 v29, v1, 2, 2
    v_add_u32 v28, v28, v29
    v_lshlrev_b32 v28, 7, v28
    v_bfe_u32 v29, v1, 4, 1
    v_lshl_add_u32 v28, v29, 5, v28
    v_and_b32 v29, 3, v1
    v_lshl_add_u32 v28, v29, 3, v28
    v_bfe_u32 v29, v1, 3, 1
    v_lshl_add_u32 v8, v29, 6, v28
    v_xor_b32 v9, 64, v8
    v_add_u32 v3, 65536, v8
    v_add_u32 v4, 65536, v9
    ds_read_b64_tr_b16 v[64:65], v3 offset:16384
    ds_read_b64_tr_b16 v[66:67], v3 offset:16896
    ds_read_b64_tr_b16 v[68:69], v4 offset:16384
    ds_read_b64_tr_b16 v[70:71], v4 offset:16896
    ds_read_b64_tr_b16 v[72:73], v3 offset:18432
    ds_read_b64_tr_b16 v[74:75], v3 offset:18944
    ds_read_b64_tr_b16 v[76:77], v4 offset:18432
    ds_read_b64_tr_b16 v[78:79], v4 offset:18944
    ds_read_b64_tr_b16 v[80:81], v3 offset:20480
    ds_read_b64_tr_b16 v[82:83], v3 offset:20992
    ds_read_b64_tr_b16 v[84:85], v4 offset:20480
    ds_read_b64_tr_b16 v[86:87], v4 offset:20992
    ds_read_b64_tr_b16 v[88:89], v3 offset:22528
    ds_read_b64_tr_b16 v[90:91], v3 offset:23040
    ds_read_b64_tr_b16 v[92:93], v4 offset:22528
    ds_read_b64_tr_b16 v[94:95], v4 offset:23040
    s_waitcnt vmcnt(11) lgkmcnt(12)
    v_mfma_f32_32x32x16_bf16 v[32:47], v[64:67], a[0:3], 0
    ds_read_b64_tr_b16 v[64:65], v3 offset:24576
    ds_read_b64_tr_b16 v[66:67], v3 offset:25088
    v_mfma_f32_32x32x16_bf16 v[48:63], v[68:71], a[0:3], 0
    ds_read_b64_tr_b16 v[68:69], v4 offset:24576
    ds_read_b64_tr_b16 v[70:71], v4 offset:25088
    buffer_load_dwordx4 a[32:35], v10, s[36:39], s77 offen offset:0 sc1
    buffer_load_dwordx4 a[36:39], v10, s[36:39], s77 offen offset:1024 sc1
    s_waitcnt vmcnt(12) lgkmcnt(12)
    v_mfma_f32_32x32x16_bf16 v[32:47], v[72:75], a[4:7], v[32:47]
    ds_read_b64_tr_b16 v[72:73], v3 offset:26624
    ds_read_b64_tr_b16 v[74:75], v3 offset:27136
    s_mul_i32 s78, s34, 4608
    s_add_u32 s78, s78, 18874368
    s_add_u32 s44, s28, s78
    s_addc_u32 s45, s29, 0
    s_mov_b32 s46, 8192
    s_mov_b32 s47, 0x20000
    v_mfma_f32_32x32x16_bf16 v[48:63], v[76:79], a[4:7], v[48:63]
    ds_read_b64_tr_b16 v[76:77], v4 offset:26624
    ds_read_b64_tr_b16 v[78:79], v4 offset:27136
    buffer_load_dwordx4 a[40:43], v10, s[36:39], s77 offen offset:2048 sc1
    buffer_load_dwordx4 a[44:47], v10, s[36:39], s77 offen offset:3072 sc1
    s_add_u32 s77, s77, 4096
    s_mul_i32 s73, s3, 18752
    s_add_u32 s73, s73, 81920
    s_lshr_b32 s79, s2, 5
    s_mul_i32 s79, s79, 256
    s_add_u32 s79, s79, 4096
    s_add_u32 s48, s28, 28311552
    s_addc_u32 s49, s29, 0
    s_mov_b32 s50, 16384
    s_waitcnt vmcnt(13) lgkmcnt(12)
    v_mfma_f32_32x32x16_bf16 v[32:47], v[80:83], a[8:11], v[32:47]
    ds_read_b64_tr_b16 v[80:81], v3 offset:28672
    ds_read_b64_tr_b16 v[82:83], v3 offset:29184
    s_mov_b32 s51, 0x20000
    v_add_u32 v26, 1, v16
    v_and_b32 v22, 1, v26
    v_mul_u32_u24 v22, 4224, v22
    v_lshrrev_b32 v26, 1, v26
    v_lshl_add_u32 v22, v26, 3, v22
    v_mfma_f32_32x32x16_bf16 v[48:63], v[84:87], a[8:11], v[48:63]
    ds_read_b64_tr_b16 v[84:85], v4 offset:28672
    ds_read_b64_tr_b16 v[86:87], v4 offset:29184
    buffer_load_dwordx4 a[48:51], v10, s[36:39], s77 offen offset:0 sc1
    buffer_load_dwordx4 a[52:55], v10, s[36:39], s77 offen offset:1024 sc1
    v_lshl_add_u32 v22, v17, 4, v22
    v_add_u32 v22, s73, v22
    v_and_b32 v26, 1, v17
    v_mul_u32_u24 v24, 4224, v26
    v_lshl_add_u32 v24, v16, 2, v24
    v_add_u32 v24, s73, v24
    v_add_u32 v25, s73, v10
    v_and_b32 v23, 1, v16
    s_waitcnt vmcnt(14) lgkmcnt(12)
    v_mfma_f32_32x32x16_bf16 v[32:47], v[88:91], a[12:15], v[32:47]
    ds_read_b64_tr_b16 v[88:89], v3 offset:30720
    ds_read_b64_tr_b16 v[90:91], v3 offset:31232
    v_mul_u32_u24 v23, 5152, v23
    v_lshrrev_b32 v26, 1, v16
    v_lshlrev_b32 v26, 6, v26
    v_sub_u32 v23, v23, v26
    v_lshl_add_u32 v23, v17, 4, v23
    s_add_u32 s78, s73, 8896
    v_mfma_f32_32x32x16_bf16 v[48:63], v[92:95], a[12:15], v[48:63]
    ds_read_b64_tr_b16 v[92:93], v4 offset:30720
    ds_read_b64_tr_b16 v[94:95], v4 offset:31232
    buffer_load_dwordx4 a[56:59], v10, s[36:39], s77 offen offset:2048 sc1
    buffer_load_dwordx4 a[60:63], v10, s[36:39], s77 offen offset:3072 sc1
    s_add_u32 s77, s77, 4096
    v_add_u32 v23, s78, v23
    v_accvgpr_read_b32 v21, a237
    v_lshlrev_b32 v21, 16, v21
    v_mov_b32 v20, v21
    buffer_load_dwordx2 a[238:239], v7, s[48:51], s69 offen sc1
    s_waitcnt vmcnt(16) lgkmcnt(12)
    v_mfma_f32_32x32x16_bf16 v[32:47], v[64:67], a[16:19], v[32:47]
    s_waitcnt vmcnt(8)
    s_barrier
    ds_read_b64_tr_b16 v[64:65], v3 offset:32768
    ds_read_b64_tr_b16 v[66:67], v3 offset:33280
    s_mul_i32 s66, s71, 256
    s_lshl_b32 s67, s70, 3
    s_add_u32 s67, s67, s66
    s_add_u32 s67, s67, 4096
    s_cmp_lg_u32 s3, 0
    s_cbranch_scc1 nosig_13
    s_mov_b64 exec, 1
    v_mov_b32 v28, s64
    v_mov_b32 v29, s65
    v_mov_b32 v30, 0
    buffer_store_dwordx2 v[28:29], v30, s[60:63], s67 offen sc1
    s_mov_b64 exec, -1
nosig_13:
    v_mfma_f32_32x32x16_bf16 v[48:63], v[68:71], a[16:19], v[48:63]
    ds_read_b64_tr_b16 v[68:69], v4 offset:32768
    ds_read_b64_tr_b16 v[70:71], v4 offset:33280
    buffer_load_dwordx4 a[0:3], v10, s[36:39], s77 offen offset:0 sc1
    buffer_load_dwordx4 a[4:7], v10, s[36:39], s77 offen offset:1024 sc1
    s_waitcnt vmcnt(17) lgkmcnt(12)
    v_mfma_f32_32x32x16_bf16 v[32:47], v[72:75], a[20:23], v[32:47]
    ds_read_b64_tr_b16 v[72:73], v3 offset:34816
    ds_read_b64_tr_b16 v[74:75], v3 offset:35328
    v_mfma_f32_32x32x16_bf16 v[48:63], v[76:79], a[20:23], v[48:63]
    ds_read_b64_tr_b16 v[76:77], v4 offset:34816
    ds_read_b64_tr_b16 v[78:79], v4 offset:35328
    buffer_load_dwordx4 a[8:11], v10, s[36:39], s77 offen offset:2048 sc1
    buffer_load_dwordx4 a[12:15], v10, s[36:39], s77 offen offset:3072 sc1
    s_add_u32 s77, s77, 4096
    s_waitcnt vmcnt(18) lgkmcnt(12)
    v_mfma_f32_32x32x16_bf16 v[32:47], v[80:83], a[24:27], v[32:47]
    ds_read_b64_tr_b16 v[80:81], v3 offset:36864
    ds_read_b64_tr_b16 v[82:83], v3 offset:37376
    v_mfma_f32_32x32x16_bf16 v[48:63], v[84:87], a[24:27], v[48:63]
    ds_read_b64_tr_b16 v[84:85], v4 offset:36864
    ds_read_b64_tr_b16 v[86:87], v4 offset:37376
    buffer_load_dwordx4 a[16:19], v10, s[36:39], s77 offen offset:0 sc1
    buffer_load_dwordx4 a[20:23], v10, s[36:39], s77 offen offset:1024 sc1
    s_waitcnt vmcnt(19) lgkmcnt(12)
    v_mfma_f32_32x32x16_bf16 v[32:47], v[88:91], a[28:31], v[32:47]
    ds_read_b64_tr_b16 v[88:89], v3 offset:38912
    ds_read_b64_tr_b16 v[90:91], v3 offset:39424
    v_mfma_f32_32x32x16_bf16 v[48:63], v[92:95], a[28:31], v[48:63]
    ds_read_b64_tr_b16 v[92:93], v4 offset:38912
    ds_read_b64_tr_b16 v[94:95], v4 offset:39424
    buffer_load_dwordx4 a[24:27], v10, s[36:39], s77 offen offset:2048 sc1
    buffer_load_dwordx4 a[28:31], v10, s[36:39], s77 offen offset:3072 sc1
    s_add_u32 s77, s77, 4096
    s_waitcnt vmcnt(16) lgkmcnt(12)
    v_mfma_f32_32x32x16_bf16 v[32:47], v[64:67], a[32:35], v[32:47]
    ds_read_b64_tr_b16 v[64:65], v3 offset:40960
    ds_read_b64_tr_b16 v[66:67], v3 offset:41472
    v_mfma_f32_32x32x16_bf16 v[48:63], v[68:71], a[32:35], v[48:63]
    ds_read_b64_tr_b16 v[68:69], v4 offset:40960
    ds_read_b64_tr_b16 v[70:71], v4 offset:41472
    buffer_load_dwordx4 a[32:35], v10, s[36:39], s77 offen offset:0 sc1
    s_waitcnt vmcnt(16) lgkmcnt(12)
    v_mfma_f32_32x32x16_bf16 v[32:47], v[72:75], a[36:39], v[32:47]
    ds_read_b64_tr_b16 v[72:73], v3 offset:43008
    ds_read_b64_tr_b16 v[74:75], v3 offset:43520
    v_mfma_f32_32x32x16_bf16 v[48:63], v[76:79], a[36:39], v[48:63]
    ds_read_b64_tr_b16 v[76:77], v4 offset:43008
    ds_read_b64_tr_b16 v[78:79], v4 offset:43520
    buffer_load_dwordx4 a[36:39], v10, s[36:39], s77 offen offset:1024 sc1
    s_waitcnt vmcnt(16) lgkmcnt(12)
    v_mfma_f32_32x32x16_bf16 v[32:47], v[80:83], a[40:43], v[32:47]
    ds_read_b64_tr_b16 v[80:81], v3 offset:45056
    ds_read_b64_tr_b16 v[82:83], v3 offset:45568
    v_mfma_f32_32x32x16_bf16 v[48:63], v[84:87], a[40:43], v[48:63]
    ds_read_b64_tr_b16 v[84:85], v4 offset:45056
    ds_read_b64_tr_b16 v[86:87], v4 offset:45568
    buffer_load_dwordx4 a[40:43], v10, s[36:39], s77 offen offset:2048 sc1
    s_waitcnt vmcnt(16) lgkmcnt(12)
    v_mfma_f32_32x32x16_bf16 v[32:47], v[88:91], a[44:47], v[32:47]
    ds_read_b64_tr_b16 v[88:89], v3 offset:47104
    ds_read_b64_tr_b16 v[90:91], v3 offset:47616
    v_mfma_f32_32x32x16_bf16 v[48:63], v[92:95], a[44:47], v[48:63]
    ds_read_b64_tr_b16 v[92:93], v4 offset:47104
    ds_read_b64_tr_b16 v[94:95], v4 offset:47616
    buffer_load_dwordx4 a[44:47], v10, s[36:39], s77 offen offset:3072 sc1
    s_add_u32 s77, s77, 4096
    s_waitcnt vmcnt(16) lgkmcnt(12)
    v_mfma_f32_32x32x16_bf16 v[32:47], v[64:67], a[48:51], v[32:47]
    s_waitcnt vmcnt(53)
    s_barrier
    ds_read_b64_tr_b16 v[64:65], v3 offset:49152
    ds_read_b64_tr_b16 v[66:67], v3 offset:49664
    v_mfma_f32_32x32x16_bf16 v[48:63], v[68:71], a[48:51], v[48:63]
    ds_read_b64_tr_b16 v[68:69], v4 offset:49152
    ds_read_b64_tr_b16 v[70:71], v4 offset:49664
    buffer_load_dwordx4 a[48:51], v10, s[36:39], s77 offen offset:0 sc1
    s_waitcnt vmcnt(16) lgkmcnt(12)
    v_mfma_f32_32x32x16_bf16 v[32:47], v[72:75], a[52:55], v[32:47]
    ds_read_b64_tr_b16 v[72:73], v3 offset:51200
    ds_read_b64_tr_b16 v[74:75], v3 offset:51712
    v_mfma_f32_32x32x16_bf16 v[48:63], v[76:79], a[52:55], v[48:63]
    ds_read_b64_tr_b16 v[76:77], v4 offset:51200
    ds_read_b64_tr_b16 v[78:79], v4 offset:51712
    buffer_load_dwordx4 a[52:55], v10, s[36:39], s77 offen offset:1024 sc1
    s_waitcnt vmcnt(16) lgkmcnt(12)
    v_mfma_f32_32x32x16_bf16 v[32:47], v[80:83], a[56:59], v[32:47]
    ds_read_b64_tr_b16 v[80:81], v3 offset:53248
    ds_read_b64_tr_b16 v[82:83], v3 offset:53760
    v_mfma_f32_32x32x16_bf16 v[48:63], v[84:87], a[56:59], v[48:63]
    ds_read_b64_tr_b16 v[84:85], v4 offset:53248
    ds_read_b64_tr_b16 v[86:87], v4 offset:53760
    buffer_load_dwordx4 a[56:59], v10, s[36:39], s77 offen offset:2048 sc1
    s_waitcnt vmcnt(16) lgkmcnt(12)
    v_mfma_f32_32x32x16_bf16 v[32:47], v[88:91], a[60:63], v[32:47]
    ds_read_b64_tr_b16 v[88:89], v3 offset:55296
    ds_read_b64_tr_b16 v[90:91], v3 offset:55808
    v_mfma_f32_32x32x16_bf16 v[48:63], v[92:95], a[60:63], v[48:63]
    ds_read_b64_tr_b16 v[92:93], v4 offset:55296
    ds_read_b64_tr_b16 v[94:95], v4 offset:55808
    buffer_load_dwordx4 a[60:63], v10, s[36:39], s77 offen offset:3072 sc1
    s_add_u32 s77, s77, 4096
    s_waitcnt vmcnt(15) lgkmcnt(12)
    v_mfma_f32_32x32x16_bf16 v[32:47], v[64:67], a[0:3], v[32:47]
    ds_read_b64_tr_b16 v[64:65], v3 offset:57344
    ds_read_b64_tr_b16 v[66:67], v3 offset:57856
    v_mfma_f32_32x32x16_bf16 v[48:63], v[68:71], a[0:3], v[48:63]
    ds_read_b64_tr_b16 v[68:69], v4 offset:57344
    ds_read_b64_tr_b16 v[70:71], v4 offset:57856
    buffer_load_dwordx4 a[0:3], v10, s[36:39], s77 offen offset:0 sc1
    s_waitcnt vmcnt(15) lgkmcnt(12)
    v_mfma_f32_32x32x16_bf16 v[32:47], v[72:75], a[4:7], v[32:47]
    ds_read_b64_tr_b16 v[72:73], v3 offset:59392
    ds_read_b64_tr_b16 v[74:75], v3 offset:59904
    v_mfma_f32_32x32x16_bf16 v[48:63], v[76:79], a[4:7], v[48:63]
    ds_read_b64_tr_b16 v[76:77], v4 offset:59392
    ds_read_b64_tr_b16 v[78:79], v4 offset:59904
    buffer_load_dwordx4 a[4:7], v10, s[36:39], s77 offen offset:1024 sc1
    s_waitcnt vmcnt(15) lgkmcnt(12)
    v_mfma_f32_32x32x16_bf16 v[32:47], v[80:83], a[8:11], v[32:47]
    ds_read_b64_tr_b16 v[80:81], v3 offset:61440
    ds_read_b64_tr_b16 v[82:83], v3 offset:61952
    v_mfma_f32_32x32x16_bf16 v[48:63], v[84:87], a[8:11], v[48:63]
    ds_read_b64_tr_b16 v[84:85], v4 offset:61440
    ds_read_b64_tr_b16 v[86:87], v4 offset:61952
    buffer_load_dwordx4 a[8:11], v10, s[36:39], s77 offen offset:2048 sc1
    s_waitcnt vmcnt(15) lgkmcnt(12)
    v_mfma_f32_32x32x16_bf16 v[32:47], v[88:91], a[12:15], v[32:47]
    ds_read_b64_tr_b16 v[88:89], v3 offset:63488
    ds_read_b64_tr_b16 v[90:91], v3 offset:64000
    v_mfma_f32_32x32x16_bf16 v[48:63], v[92:95], a[12:15], v[48:63]
    ds_read_b64_tr_b16 v[92:93], v4 offset:63488
    ds_read_b64_tr_b16 v[94:95], v4 offset:64000
    buffer_load_dwordx4 a[12:15], v10, s[36:39], s77 offen offset:3072 sc1
    s_add_u32 s77, s77, 4096
    s_waitcnt vmcnt(15) lgkmcnt(12)
    v_mfma_f32_32x32x16_bf16 v[32:47], v[64:67], a[16:19], v[32:47]
    s_waitcnt vmcnt(57)
    s_barrier
    ds_read_b64_tr_b16 v[64:65], v8 offset:0
    ds_read_b64_tr_b16 v[66:67], v8 offset:512
    v_mfma_f32_32x32x16_bf16 v[48:63], v[68:71], a[16:19], v[48:63]
    ds_read_b64_tr_b16 v[68:69], v9 offset:0
    ds_read_b64_tr_b16 v[70:71], v9 offset:512
    buffer_load_dwordx4 a[16:19], v10, s[36:39], s77 offen offset:0 sc1
    s_waitcnt vmcnt(15) lgkmcnt(12)
    v_mfma_f32_32x32x16_bf16 v[32:47], v[72:75], a[20:23], v[32:47]
    ds_read_b64_tr_b16 v[72:73], v8 offset:2048
    ds_read_b64_tr_b16 v[74:75], v8 offset:2560
    v_mfma_f32_32x32x16_bf16 v[48:63], v[76:79], a[20:23], v[48:63]
    ds_read_b64_tr_b16 v[76:77], v9 offset:2048
    ds_read_b64_tr_b16 v[78:79], v9 offset:2560
    buffer_load_dwordx4 a[20:23], v10, s[36:39], s77 offen offset:1024 sc1
    s_waitcnt vmcnt(15) lgkmcnt(12)
    v_mfma_f32_32x32x16_bf16 v[32:47], v[80:83], a[24:27], v[32:47]
    ds_read_b64_tr_b16 v[80:81], v8 offset:4096
    ds_read_b64_tr_b16 v[82:83], v8 offset:4608
    v_mfma_f32_32x32x16_bf16 v[48:63], v[84:87], a[24:27], v[48:63]
    ds_read_b64_tr_b16 v[84:85], v9 offset:4096
    ds_read_b64_tr_b16 v[86:87], v9 offset:4608
    buffer_load_dwordx4 a[24:27], v10, s[36:39], s77 offen offset:2048 sc1
    s_waitcnt vmcnt(15) lgkmcnt(12)
    v_mfma_f32_32x32x16_bf16 v[32:47], v[88:91], a[28:31], v[32:47]
    ds_read_b64_tr_b16 v[88:89], v8 offset:6144
    ds_read_b64_tr_b16 v[90:91], v8 offset:6656
    v_mfma_f32_32x32x16_bf16 v[48:63], v[92:95], a[28:31], v[48:63]
    ds_read_b64_tr_b16 v[92:93], v9 offset:6144
    ds_read_b64_tr_b16 v[94:95], v9 offset:6656
    buffer_load_dwordx4 a[28:31], v10, s[36:39], s77 offen offset:3072 sc1
    s_add_u32 s77, s77, 4096
    s_waitcnt vmcnt(15) lgkmcnt(12)
    v_mfma_f32_32x32x16_bf16 v[32:47], v[64:67], a[32:35], v[32:47]
    ds_read_b64_tr_b16 v[64:65], v8 offset:8192
    ds_read_b64_tr_b16 v[66:67], v8 offset:8704
    v_mfma_f32_32x32x16_bf16 v[48:63], v[68:71], a[32:35], v[48:63]
    ds_read_b64_tr_b16 v[68:69], v9 offset:8192
    ds_read_b64_tr_b16 v[70:71], v9 offset:8704
    buffer_load_dwordx4 a[32:35], v10, s[36:39], s77 offen offset:0 sc1
    s_waitcnt vmcnt(15) lgkmcnt(12)
    v_mfma_f32_32x32x16_bf16 v[32:47], v[72:75], a[36:39], v[32:47]
    ds_read_b64_tr_b16 v[72:73], v8 offset:10240
    ds_read_b64_tr_b16 v[74:75], v8 offset:10752
    v_mfma_f32_32x32x16_bf16 v[48:63], v[76:79], a[36:39], v[48:63]
    ds_read_b64_tr_b16 v[76:77], v9 offset:10240
    ds_read_b64_tr_b16 v[78:79], v9 offset:10752
    buffer_load_dwordx4 a[36:39], v10, s[36:39], s77 offen offset:1024 sc1
    s_waitcnt vmcnt(15) lgkmcnt(12)
    v_mfma_f32_32x32x16_bf16 v[32:47], v[80:83], a[40:43], v[32:47]
    ds_read_b64_tr_b16 v[80:81], v8 offset:12288
    ds_read_b64_tr_b16 v[82:83], v8 offset:12800
    buffer_load_dwordx2 v[14:15], v13, s[60:63], s79 offen sc1
    v_mfma_f32_32x32x16_bf16 v[48:63], v[84:87], a[40:43], v[48:63]
    ds_read_b64_tr_b16 v[84:85], v9 offset:12288
    ds_read_b64_tr_b16 v[86:87], v9 offset:12800
    buffer_load_dwordx4 a[40:43], v10, s[36:39], s77 offen offset:2048 sc1
    s_waitcnt vmcnt(16) lgkmcnt(12)
    v_mfma_f32_32x32x16_bf16 v[32:47], v[88:91], a[44:47], v[32:47]
    ds_read_b64_tr_b16 v[88:89], v8 offset:14336
    ds_read_b64_tr_b16 v[90:91], v8 offset:14848
    v_mfma_f32_32x32x16_bf16 v[48:63], v[92:95], a[44:47], v[48:63]
    ds_read_b64_tr_b16 v[92:93], v9 offset:14336
    ds_read_b64_tr_b16 v[94:95], v9 offset:14848
    buffer_load_dwordx4 a[44:47], v10, s[36:39], s77 offen offset:3072 sc1
    s_add_u32 s77, s77, 4096
    s_waitcnt vmcnt(16) lgkmcnt(12)
    v_mfma_f32_32x32x16_bf16 v[32:47], v[64:67], a[48:51], v[32:47]
    s_waitcnt vmcnt(62)
    s_barrier
    ds_read_b64_tr_b16 v[64:65], v8 offset:16384
    ds_read_b64_tr_b16 v[66:67], v8 offset:16896
    v_mfma_f32_32x32x16_bf16 v[48:63], v[68:71], a[48:51], v[48:63]
    ds_read_b64_tr_b16 v[68:69], v9 offset:16384
    ds_read_b64_tr_b16 v[70:71], v9 offset:16896
    buffer_load_dwordx4 a[48:51], v10, s[36:39], s77 offen offset:0 sc1
    s_waitcnt vmcnt(16) lgkmcnt(12)
    v_mfma_f32_32x32x16_bf16 v[32:47], v[72:75], a[52:55], v[32:47]
    ds_read_b64_tr_b16 v[72:73], v8 offset:18432
    ds_read_b64_tr_b16 v[74:75], v8 offset:18944
    v_mfma_f32_32x32x16_bf16 v[48:63], v[76:79], a[52:55], v[48:63]
    ds_read_b64_tr_b16 v[76:77], v9 offset:18432
    ds_read_b64_tr_b16 v[78:79], v9 offset:18944
    buffer_load_dwordx4 a[52:55], v10, s[36:39], s77 offen offset:1024 sc1
    s_waitcnt vmcnt(16) lgkmcnt(12)
    v_mfma_f32_32x32x16_bf16 v[32:47], v[80:83], a[56:59], v[32:47]
    ds_read_b64_tr_b16 v[80:81], v8 offset:20480
    ds_read_b64_tr_b16 v[82:83], v8 offset:20992
    v_mfma_f32_32x32x16_bf16 v[48:63], v[84:87], a[56:59], v[48:63]
    ds_read_b64_tr_b16 v[84:85], v9 offset:20480
    ds_read_b64_tr_b16 v[86:87], v9 offset:20992
    buffer_load_dwordx4 a[56:59], v10, s[36:39], s77 offen offset:2048 sc1
    s_waitcnt vmcnt(16) lgkmcnt(12)
    v_mfma_f32_32x32x16_bf16 v[32:47], v[88:91], a[60:63], v[32:47]
    ds_read_b64_tr_b16 v[88:89], v8 offset:22528
    ds_read_b64_tr_b16 v[90:91], v8 offset:23040
    v_mfma_f32_32x32x16_bf16 v[48:63], v[92:95], a[60:63], v[48:63]
    ds_read_b64_tr_b16 v[92:93], v9 offset:22528
    ds_read_b64_tr_b16 v[94:95], v9 offset:23040
    buffer_load_dwordx4 a[60:63], v10, s[36:39], s77 offen offset:3072 sc1
    s_add_u32 s77, s77, 4096
    s_waitcnt vmcnt(16) lgkmcnt(12)
    v_mfma_f32_32x32x16_bf16 v[32:47], v[64:67], a[0:3], v[32:47]
    ds_read_b64_tr_b16 v[64:65], v8 offset:24576
    ds_read_b64_tr_b16 v[66:67], v8 offset:25088
    v_mfma_f32_32x32x16_bf16 v[48:63], v[68:71], a[0:3], v[48:63]
    ds_read_b64_tr_b16 v[68:69], v9 offset:24576
    ds_read_b64_tr_b16 v[70:71], v9 offset:25088
    buffer_load_dwordx4 a[0:3], v10, s[36:39], s77 offen offset:0 sc1
    s_waitcnt vmcnt(16) lgkmcnt(12)
    v_mfma_f32_32x32x16_bf16 v[32:47], v[72:75], a[4:7], v[32:47]
    ds_read_b64_tr_b16 v[72:73], v8 offset:26624
    ds_read_b64_tr_b16 v[74:75], v8 offset:27136
    v_mfma_f32_32x32x16_bf16 v[48:63], v[76:79], a[4:7], v[48:63]
    ds_read_b64_tr_b16 v[76:77], v9 offset:26624
    ds_read_b64_tr_b16 v[78:79], v9 offset:27136
    buffer_load_dwordx4 a[4:7], v10, s[36:39], s77 offen offset:1024 sc1
    s_waitcnt vmcnt(16) lgkmcnt(12)
    v_mfma_f32_32x32x16_bf16 v[32:47], v[80:83], a[8:11], v[32:47]
    ds_read_b64_tr_b16 v[80:81], v8 offset:28672
    ds_read_b64_tr_b16 v[82:83], v8 offset:29184
    s_waitcnt vmcnt(8)
    s_mov_b32 exec_lo, 0xffffffff
    s_mov_b32 exec_hi, 0
    s_mov_b32 s66, 0
poll_14:
    v_cmp_ne_u64 vcc, s[64:65], v[14:15]
    s_nop 1
    s_cmp_eq_u64 vcc, 0
    s_cbranch_scc1 polled_15
    s_add_u32 s66, s66, 1
    s_cmp_ge_u32 s66, 0x40000
    s_cbranch_scc1 polled_15
    buffer_load_dwordx2 v[14:15], v13, s[60:63], s79 offen sc1
    s_waitcnt vmcnt(0)
    s_branch poll_14
polled_15:
    s_mov_b64 exec, -1
    v_mfma_f32_32x32x16_bf16 v[48:63], v[84:87], a[8:11], v[48:63]
    ds_read_b64_tr_b16 v[84:85], v9 offset:28672
    ds_read_b64_tr_b16 v[86:87], v9 offset:29184
    buffer_load_dwordx4 a[8:11], v10, s[36:39], s77 offen offset:2048 sc1
    s_mov_b32 s78, 0
    buffer_load_dwordx4 v[192:195], v10, s[44:47], s78 offen offset:0 sc1
    s_waitcnt vmcnt(17) lgkmcnt(12)
    v_mfma_f32_32x32x16_bf16 v[32:47], v[88:91], a[12:15], v[32:47]
    ds_read_b64_tr_b16 v[88:89], v8 offset:30720
    ds_read_b64_tr_b16 v[90:91], v8 offset:31232
    s_mov_b32 s78, 4
    buffer_load_dwordx4 v[212:215], v10, s[44:47], s78 offen offset:0 sc1
    s_mov_b32 s78, 0
    buffer_load_dwordx4 v[196:199], v10, s[44:47], s78 offen offset:1024 sc1
    v_mfma_f32_32x32x16_bf16 v[48:63], v[92:95], a[12:15], v[48:63]
    ds_read_b64_tr_b16 v[92:93], v9 offset:30720
    ds_read_b64_tr_b16 v[94:95], v9 offset:31232
    buffer_load_dwordx4 a[12:15], v10, s[36:39], s77 offen offset:3072 sc1
    s_add_u32 s77, s77, 4096
    s_mov_b32 s78, 4
    buffer_load_dwordx4 v[216:219], v10, s[44:47], s78 offen offset:1024 sc1
    s_waitcnt vmcnt(20) lgkmcnt(12)
    v_mfma_f32_32x32x16_bf16 v[32:47], v[64:67], a[16:19], v[32:47]
    s_waitcnt vmcnt(63)
    s_barrier
    ds_read_b64_tr_b16 v[64:65], v8 offset:32768
    ds_read_b64_tr_b16 v[66:67], v8 offset:33280
    s_add_u32 m0, s74, 0
    s_nop 0
    buffer_load_dwordx4 v12, s[56:59], s72 offen offset:0 sc1 lds
    v_mfma_f32_32x32x16_bf16 v[48:63], v[68:71], a[16:19], v[48:63]
    ds_read_b64_tr_b16 v[68:69], v9 offset:32768
    ds_read_b64_tr_b16 v[70:71], v9 offset:33280
    buffer_load_dwordx4 a[16:19], v10, s[36:39], s77 offen offset:0 sc1
    s_mov_b32 s78, 0
    buffer_load_dwordx4 v[200:203], v10, s[44:47], s78 offen offset:2048 sc1
    s_waitcnt vmcnt(22) lgkmcnt(12)
    v_mfma_f32_32x32x16_bf16 v[32:47], v[72:75], a[20:23], v[32:47]
    ds_read_b64_tr_b16 v[72:73], v8 offset:34816
    ds_read_b64_tr_b16 v[74:75], v8 offset:35328
    s_mov_b32 s78, 4
    buffer_load_dwordx4 v[220:223], v10, s[44:47], s78 offen offset:2048 sc1
    v_mfma_f32_32x32x16_bf16 v[48:63], v[76:79], a[20:23], v[48:63]
    ds_read_b64_tr_b16 v[76:77], v9 offset:34816
    ds_read_b64_tr_b16 v[78:79], v9 offset:35328
    buffer_load_dwordx4 a[20:23], v10, s[36:39], s77 offen offset:1024 sc1
    s_mov_b32 s78, 0
    buffer_load_dwordx4 v[204:207], v10, s[44:47], s78 offen offset:3072 sc1
    s_waitcnt vmcnt(24) lgkmcnt(12)
    v_mfma_f32_32x32x16_bf16 v[32:47], v[80:83], a[24:27], v[32:47]
    ds_read_b64_tr_b16 v[80:81], v8 offset:36864
    ds_read_b64_tr_b16 v[82:83], v8 offset:37376
    buffer_load_dwordx4 v18, s[56:59], s72 offen offset:1024 sc1 lds
    v_mfma_f32_32x32x16_bf16 v[48:63], v[84:87], a[24:27], v[48:63]
    ds_read_b64_tr_b16 v[84:85], v9 offset:36864
    ds_read_b64_tr_b16 v[86:87], v9 offset:37376
    buffer_load_dwordx4 a[24:27], v10, s[36:39], s77 offen offset:2048 sc1
    s_mov_b32 s78, 4
    buffer_load_dwordx4 v[224:227], v10, s[44:47], s78 offen offset:3072 sc1
    s_mov_b32 s78, 4096
    buffer_load_dwordx4 v[208:211], v10, s[44:47], s78 offen offset:0 sc1
    s_waitcnt vmcnt(27) lgkmcnt(12)
    v_mfma_f32_32x32x16_bf16 v[32:47], v[88:91], a[28:31], v[32:47]
    ds_read_b64_tr_b16 v[88:89], v8 offset:38912
    ds_read_b64_tr_b16 v[90:91], v8 offset:39424
    s_mov_b32 s78, 4100
    buffer_load_dwordx4 v[228:231], v10, s[44:47], s78 offen offset:0 sc1
    v_mfma_f32_32x32x16_bf16 v[48:63], v[92:95], a[28:31], v[48:63]
    ds_read_b64_tr_b16 v[92:93], v9 offset:38912
    ds_read_b64_tr_b16 v[94:95], v9 offset:39424
    buffer_load_dwordx4 a[28:31], v10, s[36:39], s77 offen offset:3072 sc1
    s_add_u32 s77, s77, 4096
    ds_write_b32 v24, a236
    ds_write_b128 v25, a[188:191] offset:64
    s_waitcnt vmcnt(28) lgkmcnt(14)
    v_mfma_f32_32x32x16_bf16 v[32:47], v[64:67], a[32:35], v[32:47]
    ds_read_b64_tr_b16 v[64:65], v8 offset:40960
    ds_read_b64_tr_b16 v[66:67], v8 offset:41472
    buffer_load_dwordx4 v19, s[56:59], s72 offen offset:2048 sc1 lds
    v_mfma_f32_32x32x16_bf16 v[48:63], v[68:71], a[32:35], v[48:63]
    ds_read_b64_tr_b16 v[68:69], v9 offset:40960
    ds_read_b64_tr_b16 v[70:71], v9 offset:41472
    buffer_load_dwordx4 a[32:35], v10, s[36:39], s77 offen offset:0 sc1
    ds_write_b128 v25, a[192:195] offset:1088
    s_waitcnt vmcnt(29) lgkmcnt(15)
    v_mfma_f32_32x32x16_bf16 v[32:47], v[72:75], a[36:39], v[32:47]
    ds_read_b64_tr_b16 v[72:73], v8 offset:43008
    ds_read_b64_tr_b16 v[74:75], v8 offset:43520
    ds_write_b128 v25, a[196:199] offset:2112
    ds_write_b128 v25, a[200:203] offset:3136
    v_mfma_f32_32x32x16_bf16 v[48:63], v[76:79], a[36:39], v[48:63]
    ds_read_b64_tr_b16 v[76:77], v9 offset:43008
    ds_read_b64_tr_b16 v[78:79], v9 offset:43520
    buffer_load_dwordx4 a[36:39], v10, s[36:39], s77 offen offset:1024 sc1
    ds_write_b128 v25, a[204:207] offset:4288
    s_waitcnt vmcnt(28) lgkmcnt(15)
    v_mfma_f32_32x32x16_bf16 v[32:47], v[80:83], a[40:43], v[32:47]
    ds_read_b64_tr_b16 v[80:81], v8 offset:45056
    ds_read_b64_tr_b16 v[82:83], v8 offset:45568
    buffer_load_dwordx4 v5, s[56:59], s72 offen offset:3072 sc1 lds
    s_add_u32 s72, s72, s76
    v_mfma_f32_32x32x16_bf16 v[48:63], v[84:87], a[40:43], v[48:63]
    ds_read_b64_tr_b16 v[84:85], v9 offset:45056
    ds_read_b64_tr_b16 v[86:87], v9 offset:45568
    buffer_load_dwordx4 a[40:43], v10, s[36:39], s77 offen offset:2048 sc1
    ds_write_b128 v25, a[208:211] offset:5312
    ds_write_b128 v25, a[212:215] offset:6336
    s_waitcnt vmcnt(29) lgkmcnt(15)
    v_mfma_f32_32x32x16_bf16 v[32:47], v[88:91], a[44:47], v[32:47]
    ds_read_b64_tr_b16 v[88:89], v8 offset:47104
    ds_read_b64_tr_b16 v[90:91], v8 offset:47616
    ds_write_b128 v25, a[216:219] offset:7360
    v_mfma_f32_32x32x16_bf16 v[48:63], v[92:95], a[44:47], v[48:63]
    ds_read_b64_tr_b16 v[92:93], v9 offset:47104
    ds_read_b64_tr_b16 v[94:95], v9 offset:47616
    buffer_load_dwordx4 a[44:47], v10, s[36:39], s77 offen offset:3072 sc1
    s_add_u32 s77, s77, 4096
    s_waitcnt vmcnt(21)
    ds_write_b128 v25, v[192:195] offset:13600
    v_alignbit_b32 v212, v212, v192, 16
    v_alignbit_b32 v213, v213, v193, 16
    v_alignbit_b32 v214, v214, v194, 16
    v_alignbit_b32 v215, v215, v195, 16
    ds_write_b128 v25, v[212:215] offset:8448
    s_waitcnt vmcnt(29) lgkmcnt(15)
    v_mfma_f32_32x32x16_bf16 v[32:47], v[64:67], a[48:51], v[32:47]
    s_waitcnt vmcnt(63)
    s_barrier
    ds_read_b64_tr_b16 v[64:65], v8 offset:49152
    ds_read_b64_tr_b16 v[66:67], v8 offset:49664
    s_add_u32 m0, s74, 16384
    s_nop 0
    buffer_load_dwordx4 v12, s[56:59], s72 offen offset:0 sc1 lds
    v_mfma_f32_32x32x16_bf16 v[48:63], v[68:71], a[48:51], v[48:63]
    ds_read_b64_tr_b16 v[68:69], v9 offset:49152
    ds_read_b64_tr_b16 v[70:71], v9 offset:49664
    buffer_load_dwordx4 a[48:51], v10, s[36:39], s77 offen offset:0 sc1
    s_waitcnt vmcnt(20)
    ds_write_b128 v25, v[196:199] offset:14624
    s_waitcnt vmcnt(30) lgkmcnt(15)
    v_mfma_f32_32x32x16_bf16 v[32:47], v[72:75], a[52:55], v[32:47]
    ds_read_b64_tr_b16 v[72:73], v8 offset:51200
    ds_read_b64_tr_b16 v[74:75], v8 offset:51712
    v_alignbit_b32 v216, v216, v196, 16
    v_alignbit_b32 v217, v217, v197, 16
    v_alignbit_b32 v218, v218, v198, 16
    v_alignbit_b32 v219, v219, v199, 16
    ds_write_b128 v25, v[216:219] offset:9472
    v_mfma_f32_32x32x16_bf16 v[48:63], v[76:79], a[52:55], v[48:63]
    ds_read_b64_tr_b16 v[76:77], v9 offset:51200
    ds_read_b64_tr_b16 v[78:79], v9 offset:51712
    buffer_load_dwordx4 a[52:55], v10, s[36:39], s77 offen offset:1024 sc1
    s_waitcnt vmcnt(17)
    ds_write_b128 v25, v[200:203] offset:15648
    s_waitcnt vmcnt(30) lgkmcnt(15)
    v_mfma_f32_32x32x16_bf16 v[32:47], v[80:83], a[56:59], v[32:47]
    ds_read_b64_tr_b16 v[80:81], v8 offset:53248
    ds_read_b64_tr_b16 v[82:83], v8 offset:53760
    buffer_load_dwordx4 v18, s[56:59], s72 offen offset:1024 sc1 lds
    v_mfma_f32_32x32x16_bf16 v[48:63], v[84:87], a[56:59], v[48:63]
    ds_read_b64_tr_b16 v[84:85], v9 offset:53248
    ds_read_b64_tr_b16 v[86:87], v9 offset:53760
    buffer_load_dwordx4 a[56:59], v10, s[36:39], s77 offen offset:2048 sc1
    v_alignbit_b32 v220, v220, v200, 16
    v_alignbit_b32 v221, v221, v201, 16
    v_alignbit_b32 v222, v222, v202, 16
    v_alignbit_b32 v223, v223, v203, 16
    ds_write_b128 v25, v[220:223] offset:10496
    s_waitcnt vmcnt(31) lgkmcnt(15)
    v_mfma_f32_32x32x16_bf16 v[32:47], v[88:91], a[60:63], v[32:47]
    ds_read_b64_tr_b16 v[88:89], v8 offset:55296
    ds_read_b64_tr_b16 v[90:91], v8 offset:55808
    s_waitcnt vmcnt(14)
    ds_write_b128 v25, v[204:207] offset:16672
    v_mfma_f32_32x32x16_bf16 v[48:63], v[92:95], a[60:63], v[48:63]
    ds_read_b64_tr_b16 v[92:93], v9 offset:55296
    ds_read_b64_tr_b16 v[94:95], v9 offset:55808
    buffer_load_dwordx4 a[60:63], v10, s[36:39], s77 offen offset:3072 sc1
    s_add_u32 s77, s77, 4096
    v_alignbit_b32 v224, v224, v204, 16
    v_alignbit_b32 v225, v225, v205, 16
    v_alignbit_b32 v226, v226, v206, 16
    v_alignbit_b32 v227, v227, v207, 16
    ds_write_b128 v25, v[224:227] offset:11520
    s_waitcnt vmcnt(31) lgkmcnt(15)
    v_mfma_f32_32x32x16_bf16 v[32:47], v[64:67], a[0:3], v[32:47]
    ds_read_b64_tr_b16 v[64:65], v8 offset:57344
    ds_read_b64_tr_b16 v[66:67], v8 offset:57856
    buffer_load_dwordx4 v19, s[56:59], s72 offen offset:2048 sc1 lds
    v_mfma_f32_32x32x16_bf16 v[48:63], v[68:71], a[0:3], v[48:63]
    ds_read_b64_tr_b16 v[68:69], v9 offset:57344
    ds_read_b64_tr_b16 v[70:71], v9 offset:57856
    buffer_load_dwordx4 a[0:3], v10, s[36:39], s77 offen offset:0 sc1
    s_waitcnt vmcnt(15)
    ds_write_b128 v25, v[208:211] offset:17696
    s_waitcnt vmcnt(32) lgkmcnt(15)
    v_mfma_f32_32x32x16_bf16 v[32:47], v[72:75], a[4:7], v[32:47]
    ds_read_b64_tr_b16 v[72:73], v8 offset:59392
    ds_read_b64_tr_b16 v[74:75], v8 offset:59904
    v_alignbit_b32 v228, v228, v208, 16
    v_alignbit_b32 v229, v229, v209, 16
    v_alignbit_b32 v230, v230, v210, 16
    v_alignbit_b32 v231, v231, v211, 16
    ds_write_b128 v25, v[228:231] offset:12544
    v_mfma_f32_32x32x16_bf16 v[48:63], v[76:79], a[4:7], v[48:63]
    ds_read_b64_tr_b16 v[76:77], v9 offset:59392
    ds_read_b64_tr_b16 v[78:79], v9 offset:59904
    buffer_load_dwordx4 a[4:7], v10, s[36:39], s77 offen offset:1024 sc1
    ds_read_b64 v[128:129], v22 offset:0
    ds_read_b64 v[130:131], v22 offset:8
    ds_read_b128 v[160:163], v23 offset:3584
    ds_read_b64 v[132:133], v22 offset:512
    s_waitcnt vmcnt(32) lgkmcnt(15)
    v_mfma_f32_32x32x16_bf16 v[32:47], v[80:83], a[8:11], v[32:47]
    ds_read_b64_tr_b16 v[80:81], v8 offset:61440
    ds_read_b64_tr_b16 v[82:83], v8 offset:61952
    buffer_load_dwordx4 v5, s[56:59], s72 offen offset:3072 sc1 lds
    s_add_u32 s72, s72, s76
    v_mfma_f32_32x32x16_bf16 v[48:63], v[84:87], a[8:11], v[48:63]
    ds_read_b64_tr_b16 v[84:85], v9 offset:61440
    ds_read_b64_tr_b16 v[86:87], v9 offset:61952
    buffer_load_dwordx4 a[8:11], v10, s[36:39], s77 offen offset:2048 sc1
    ds_read_b64 v[134:135], v22 offset:520
    ds_read_b128 v[164:167], v23 offset:3072
    ds_read_b64 v[136:137], v22 offset:1024
    ds_read_b64 v[138:139], v22 offset:1032
    ds_read_b128 v[168:171], v23 offset:2560
    s_waitcnt vmcnt(30) lgkmcnt(15)
    v_mfma_f32_32x32x16_bf16 v[32:47], v[88:91], a[12:15], v[32:47]
    ds_read_b64_tr_b16 v[88:89], v8 offset:63488
    ds_read_b64_tr_b16 v[90:91], v8 offset:64000
    ds_read_b64 v[140:141], v22 offset:1536
    ds_read_b64 v[142:143], v22 offset:1544
    ds_read_b128 v[172:175], v23 offset:2048
    ds_read_b64 v[144:145], v22 offset:2048
    ds_read_b64 v[146:147], v22 offset:2056
    ds_read_b128 v[176:179], v23 offset:1536
    v_mfma_f32_32x32x16_bf16 v[48:63], v[92:95], a[12:15], v[48:63]
    ds_read_b64_tr_b16 v[92:93], v9 offset:63488
    ds_read_b64_tr_b16 v[94:95], v9 offset:64000
    buffer_load_dwordx4 a[12:15], v10, s[36:39], s77 offen offset:3072 sc1
    s_add_u32 s77, s77, 4096
    ds_read_b64 v[148:149], v22 offset:2560
    ds_read_b64 v[150:151], v22 offset:2568
    ds_read_b128 v[180:183], v23 offset:1024
    ds_read_b64 v[152:153], v22 offset:3072
    ds_read_b64 v[154:155], v22 offset:3080
    ds_read_b128 v[184:187], v23 offset:512
    ds_read_b64 v[156:157], v22 offset:3584
    s_waitcnt vmcnt(28) lgkmcnt(15)
    v_mfma_f32_32x32x16_bf16 v[32:47], v[64:67], a[16:19], v[32:47]
    s_waitcnt vmcnt(63)
    s_barrier
    ds_read_b64_tr_b16 v[64:65], v3 offset:0
    ds_read_b64_tr_b16 v[66:67], v3 offset:512
    s_add_u32 m0, s74, 32768
    s_nop 0
    buffer_load_dwordx4 v12, s[56:59], s72 offen offset:0 sc1 lds
    v_mfma_f32_32x32x16_bf16 v[48:63], v[68:71], a[16:19], v[48:63]
    ds_read_b64_tr_b16 v[68:69], v4 offset:0
    ds_read_b64_tr_b16 v[70:71], v4 offset:512
    buffer_load_dwordx4 a[16:19], v10, s[36:39], s77 offen offset:0 sc1
    ds_read_b64 v[158:159], v22 offset:3592
    ds_read_b128 v[188:191], v23 offset:0
    s_waitcnt vmcnt(27) lgkmcnt(15)
    v_mfma_f32_32x32x16_bf16 v[32:47], v[72:75], a[20:23], v[32:47]
    ds_read_b64_tr_b16 v[72:73], v3 offset:2048
    ds_read_b64_tr_b16 v[74:75], v3 offset:2560
    s_waitcnt lgkmcnt(2)
    v_mfma_f32_16x16x32_bf16 v[96:99], v[160:163], v[128:131], 0
    ds_read_b64 v[192:193], v22 offset:64
    v_mfma_f32_16x16x32_bf16 v[100:103], v[164:167], v[128:131], 0
    ds_read_b64 v[194:195], v22 offset:72
    v_mfma_f32_32x32x16_bf16 v[48:63], v[76:79], a[20:23], v[48:63]
    ds_read_b64_tr_b16 v[76:77], v4 offset:2048
    ds_read_b64_tr_b16 v[78:79], v4 offset:2560
    buffer_load_dwordx4 a[20:23], v10, s[36:39], s77 offen offset:1024 sc1
    v_mfma_f32_16x16x32_bf16 v[104:107], v[168:171], v[128:131], 0
    ds_read_b128 v[224:227], v23 offset:3648
    v_mfma_f32_16x16x32_bf16 v[108:111], v[172:175], v[128:131], 0
    ds_read_b64 v[196:197], v22 offset:576
    v_mfma_f32_16x16x32_bf16 v[112:115], v[176:179], v[128:131], 0
    ds_read_b64 v[198:199], v22 offset:584
    s_waitcnt vmcnt(25) lgkmcnt(15)
    v_mfma_f32_32x32x16_bf16 v[32:47], v[80:83], a[24:27], v[32:47]
    ds_read_b64_tr_b16 v[80:81], v3 offset:4096
    ds_read_b64_tr_b16 v[82:83], v3 offset:4608
    buffer_load_dwordx4 v18, s[56:59], s72 offen offset:1024 sc1 lds
    v_mfma_f32_16x16x32_bf16 v[116:119], v[180:183], v[128:131], 0
    ds_read_b128 v[228:231], v23 offset:3136
    v_mfma_f32_16x16x32_bf16 v[120:123], v[184:187], v[128:131], 0
    ds_read_b64 v[200:201], v22 offset:1088
    v_mfma_f32_32x32x16_bf16 v[48:63], v[84:87], a[24:27], v[48:63]
    ds_read_b64_tr_b16 v[84:85], v4 offset:4096
    ds_read_b64_tr_b16 v[86:87], v4 offset:4608
    buffer_load_dwordx4 a[24:27], v10, s[36:39], s77 offen offset:2048 sc1
    v_mfma_f32_16x16x32_bf16 v[124:127], v[188:191], v[128:131], 0
    ds_read_b64 v[202:203], v22 offset:1096
    v_mfma_f32_16x16x32_bf16 v[100:103], v[160:163], v[132:135], v[100:103]
    ds_read_b128 v[232:235], v23 offset:2624
    v_mfma_f32_16x16x32_bf16 v[104:107], v[164:167], v[132:135], v[104:107]
    ds_read_b64 v[204:205], v22 offset:1600
    s_waitcnt vmcnt(23) lgkmcnt(15)
    v_mfma_f32_32x32x16_bf16 v[32:47], v[88:91], a[28:31], v[32:47]
    ds_read_b64_tr_b16 v[88:89], v3 offset:6144
    ds_read_b64_tr_b16 v[90:91], v3 offset:6656
    v_mfma_f32_16x16x32_bf16 v[108:111], v[168:171], v[132:135], v[108:111]
    ds_read_b64 v[206:207], v22 offset:1608
    v_mfma_f32_16x16x32_bf16 v[112:115], v[172:175], v[132:135], v[112:115]
    ds_read_b128 v[236:239], v23 offset:2112
    v_mfma_f32_32x32x16_bf16 v[48:63], v[92:95], a[28:31], v[48:63]
    ds_read_b64_tr_b16 v[92:93], v4 offset:6144
    ds_read_b64_tr_b16 v[94:95], v4 offset:6656
    buffer_load_dwordx4 a[28:31], v10, s[36:39], s77 offen offset:3072 sc1
    s_add_u32 s77, s77, 4096
    v_mfma_f32_16x16x32_bf16 v[116:119], v[176:179], v[132:135], v[116:119]
    ds_read_b64 v[208:209], v22 offset:2112
    v_mfma_f32_16x16x32_bf16 v[120:123], v[180:183], v[132:135], v[120:123]
    ds_read_b64 v[210:211], v22 offset:2120
    v_mfma_f32_16x16x32_bf16 v[124:127], v[184:187], v[132:135], v[124:127]
    ds_read_b128 v[240:243], v23 offset:1600
    s_waitcnt vmcnt(22) lgkmcnt(15)
    v_mfma_f32_32x32x16_bf16 v[32:47], v[64:67], a[32:35], v[32:47]
    ds_read_b64_tr_b16 v[64:65], v3 offset:8192
    ds_read_b64_tr_b16 v[66:67], v3 offset:8704
    buffer_load_dwordx4 v19, s[56:59], s72 offen offset:2048 sc1 lds
    v_mfma_f32_16x16x32_bf16 v[104:107], v[160:163], v[136:139], v[104:107]
    ds_read_b64 v[212:213], v22 offset:2624
    v_mfma_f32_16x16x32_bf16 v[108:111], v[164:167], v[136:139], v[108:111]
    ds_read_b64 v[214:215], v22 offset:2632
    v_mfma_f32_32x32x16_bf16 v[48:63], v[68:71], a[32:35], v[48:63]
    ds_read_b64_tr_b16 v[68:69], v4 offset:8192
    ds_read_b64_tr_b16 v[70:71], v4 offset:8704
    buffer_load_dwordx4 a[32:35], v10, s[36:39], s77 offen offset:0 sc1
    v_mfma_f32_16x16x32_bf16 v[112:115], v[168:171], v[136:139], v[112:115]
    ds_read_b128 v[244:247], v23 offset:1088
    v_mfma_f32_16x16x32_bf16 v[116:119], v[172:175], v[136:139], v[116:119]
    ds_read_b64 v[216:217], v22 offset:3136
    v_mfma_f32_16x16x32_bf16 v[120:123], v[176:179], v[136:139], v[120:123]
    ds_read_b64 v[218:219], v22 offset:3144
    s_waitcnt vmcnt(23) lgkmcnt(15)
    v_mfma_f32_32x32x16_bf16 v[32:47], v[72:75], a[36:39], v[32:47]
    ds_read_b64_tr_b16 v[72:73], v3 offset:10240
    ds_read_b64_tr_b16 v[74:75], v3 offset:10752
    v_mfma_f32_16x16x32_bf16 v[124:127], v[180:183], v[136:139], v[124:127]
    ds_read_b128 v[248:251], v23 offset:576
    v_mfma_f32_16x16x32_bf16 v[108:111], v[160:163], v[140:143], v[108:111]
    ds_read_b64 v[220:221], v22 offset:3648
    v_mfma_f32_32x32x16_bf16 v[48:63], v[76:79], a[36:39], v[48:63]
    ds_read_b64_tr_b16 v[76:77], v4 offset:10240
    ds_read_b64_tr_b16 v[78:79], v4 offset:10752
    buffer_load_dwordx4 a[36:39], v10, s[36:39], s77 offen offset:1024 sc1
    v_mfma_f32_16x16x32_bf16 v[112:115], v[164:167], v[140:143], v[112:115]
    ds_read_b64 v[222:223], v22 offset:3656
    v_mfma_f32_16x16x32_bf16 v[116:119], v[168:171], v[140:143], v[116:119]
    ds_read_b128 v[252:255], v23 offset:64
    v_mfma_f32_16x16x32_bf16 v[120:123], v[172:175], v[140:143], v[120:123]
    s_waitcnt vmcnt(22) lgkmcnt(15)
    v_mfma_f32_32x32x16_bf16 v[32:47], v[80:83], a[40:43], v[32:47]
    ds_read_b64_tr_b16 v[80:81], v3 offset:12288
    ds_read_b64_tr_b16 v[82:83], v3 offset:12800
    buffer_load_dwordx4 v5, s[56:59], s72 offen offset:3072 sc1 lds
    s_add_u32 s72, s72, s76
    v_mfma_f32_16x16x32_bf16 v[124:127], v[176:179], v[140:143], v[124:127]
    v_mfma_f32_16x16x32_bf16 v[112:115], v[160:163], v[144:147], v[112:115]
    v_mfma_f32_32x32x16_bf16 v[48:63], v[84:87], a[40:43], v[48:63]
    ds_read_b64_tr_b16 v[84:85], v4 offset:12288
    ds_read_b64_tr_b16 v[86:87], v4 offset:12800
    buffer_load_dwordx4 a[40:43], v10, s[36:39], s77 offen offset:2048 sc1
    v_mfma_f32_16x16x32_bf16 v[116:119], v[164:167], v[144:147], v[116:119]
    v_mfma_f32_16x16x32_bf16 v[120:123], v[168:171], v[144:147], v[120:123]
    v_mfma_f32_16x16x32_bf16 v[124:127], v[172:175], v[144:147], v[124:127]
    s_waitcnt vmcnt(23) lgkmcnt(15)
    v_mfma_f32_32x32x16_bf16 v[32:47], v[88:91], a[44:47], v[32:47]
    ds_read_b64_tr_b16 v[88:89], v3 offset:14336
    ds_read_b64_tr_b16 v[90:91], v3 offset:14848
    v_mfma_f32_16x16x32_bf16 v[116:119], v[160:163], v[148:151], v[116:119]
    v_mfma_f32_16x16x32_bf16 v[120:123], v[164:167], v[148:151], v[120:123]
    v_mfma_f32_32x32x16_bf16 v[48:63], v[92:95], a[44:47], v[48:63]
    ds_read_b64_tr_b16 v[92:93], v4 offset:14336
    ds_read_b64_tr_b16 v[94:95], v4 offset:14848
    buffer_load_dwordx4 a[44:47], v10, s[36:39], s77 offen offset:3072 sc1
    s_add_u32 s77, s77, 4096
    v_mfma_f32_16x16x32_bf16 v[124:127], v[168:171], v[148:151], v[124:127]
    v_mfma_f32_16x16x32_bf16 v[120:123], v[160:163], v[152:155], v[120:123]
    v_mfma_f32_16x16x32_bf16 v[124:127], v[164:167], v[152:155], v[124:127]
    s_waitcnt vmcnt(22) lgkmcnt(15)
    v_mfma_f32_32x32x16_bf16 v[32:47], v[64:67], a[48:51], v[32:47]
    s_waitcnt vmcnt(26)
    s_barrier
    ds_read_b64_tr_b16 v[64:65], v8 offset:0
    ds_read_b64_tr_b16 v[66:67], v8 offset:512
    s_add_u32 m0, s74, 49152
    s_nop 0
    buffer_load_dwordx4 v12, s[56:59], s72 offen offset:0 sc1 lds
    v_mfma_f32_16x16x32_bf16 v[124:127], v[160:163], v[156:159], v[124:127]
    s_waitcnt lgkmcnt(10)
    v_mfma_f32_16x16x32_bf16 v[96:99], v[224:227], v[192:195], v[96:99]
    ds_read_b64 v[128:129], v22 offset:128
    v_mfma_f32_32x32x16_bf16 v[48:63], v[68:71], a[48:51], v[48:63]
    ds_read_b64_tr_b16 v[68:69], v9 offset:0
    ds_read_b64_tr_b16 v[70:71], v9 offset:512
    buffer_load_dwordx4 a[48:51], v10, s[36:39], s77 offen offset:0 sc1
    v_mfma_f32_16x16x32_bf16 v[100:103], v[228:231], v[192:195], v[100:103]
    ds_read_b64 v[130:131], v22 offset:136
    v_mfma_f32_16x16x32_bf16 v[104:107], v[232:235], v[192:195], v[104:107]
    ds_read_b128 v[160:163], v23 offset:3712
    v_mfma_f32_16x16x32_bf16 v[108:111], v[236:239], v[192:195], v[108:111]
    ds_read_b64 v[132:133], v22 offset:640
    s_waitcnt vmcnt(23) lgkmcnt(15)
    v_mfma_f32_32x32x16_bf16 v[32:47], v[72:75], a[52:55], v[32:47]
    ds_read_b64_tr_b16 v[72:73], v8 offset:2048
    ds_read_b64_tr_b16 v[74:75], v8 offset:2560
    v_mfma_f32_16x16x32_bf16 v[112:115], v[240:243], v[192:195], v[112:115]
    ds_read_b64 v[134:135], v22 offset:648
    v_mfma_f32_16x16x32_bf16 v[116:119], v[244:247], v[192:195], v[116:119]
    ds_read_b128 v[164:167], v23 offset:3200
    v_mfma_f32_32x32x16_bf16 v[48:63], v[76:79], a[52:55], v[48:63]
    ds_read_b64_tr_b16 v[76:77], v9 offset:2048
    ds_read_b64_tr_b16 v[78:79], v9 offset:2560
    buffer_load_dwordx4 a[52:55], v10, s[36:39], s77 offen offset:1024 sc1
    v_mfma_f32_16x16x32_bf16 v[120:123], v[248:251], v[192:195], v[120:123]
    ds_read_b64 v[136:137], v22 offset:1152
    v_mfma_f32_16x16x32_bf16 v[124:127], v[252:255], v[192:195], v[124:127]
    ds_read_b64 v[138:139], v22 offset:1160
    v_mfma_f32_16x16x32_bf16 v[100:103], v[224:227], v[196:199], v[100:103]
    ds_read_b128 v[168:171], v23 offset:2688
    s_waitcnt vmcnt(22) lgkmcnt(15)
    v_mfma_f32_32x32x16_bf16 v[32:47], v[80:83], a[56:59], v[32:47]
    ds_read_b64_tr_b16 v[80:81], v8 offset:4096
    ds_read_b64_tr_b16 v[82:83], v8 offset:4608
    buffer_load_dwordx4 v18, s[56:59], s72 offen offset:1024 sc1 lds
    v_mfma_f32_16x16x32_bf16 v[104:107], v[228:231], v[196:199], v[104:107]
    ds_read_b64 v[140:141], v22 offset:1664
    v_mfma_f32_16x16x32_bf16 v[108:111], v[232:235], v[196:199], v[108:111]
    ds_read_b64 v[142:143], v22 offset:1672
    v_mfma_f32_32x32x16_bf16 v[48:63], v[84:87], a[56:59], v[48:63]
    ds_read_b64_tr_b16 v[84:85], v9 offset:4096
    ds_read_b64_tr_b16 v[86:87], v9 offset:4608
    buffer_load_dwordx4 a[56:59], v10, s[36:39], s77 offen offset:2048 sc1
    v_mfma_f32_16x16x32_bf16 v[112:115], v[236:239], v[196:199], v[112:115]
    ds_read_b128 v[172:175], v23 offset:2176
    v_mfma_f32_16x16x32_bf16 v[116:119], v[240:243], v[196:199], v[116:119]
    ds_read_b64 v[144:145], v22 offset:2176
    v_mfma_f32_16x16x32_bf16 v[120:123], v[244:247], v[196:199], v[120:123]
    ds_read_b64 v[146:147], v22 offset:2184
    s_waitcnt vmcnt(23) lgkmcnt(15)
    v_mfma_f32_32x32x16_bf16 v[32:47], v[88:91], a[60:63], v[32:47]
    ds_read_b64_tr_b16 v[88:89], v8 offset:6144
    ds_read_b64_tr_b16 v[90:91], v8 offset:6656
    v_mfma_f32_16x16x32_bf16 v[124:127], v[248:251], v[196:199], v[124:127]
    ds_read_b128 v[176:179], v23 offset:1664
    v_mfma_f32_16x16x32_bf16 v[104:107], v[224:227], v[200:203], v[104:107]
    ds_read_b64 v[148:149], v22 offset:2688
    v_mfma_f32_32x32x16_bf16 v[48:63], v[92:95], a[60:63], v[48:63]
    ds_read_b64_tr_b16 v[92:93], v9 offset:6144
    ds_read_b64_tr_b16 v[94:95], v9 offset:6656
    buffer_load_dwordx4 a[60:63], v10, s[36:39], s77 offen offset:3072 sc1
    s_add_u32 s77, s77, 4096
    v_mfma_f32_16x16x32_bf16 v[108:111], v[228:231], v[200:203], v[108:111]
    ds_read_b64 v[150:151], v22 offset:2696
    v_mfma_f32_16x16x32_bf16 v[112:115], v[232:235], v[200:203], v[112:115]
    ds_read_b128 v[180:183], v23 offset:1152
    v_mfma_f32_16x16x32_bf16 v[116:119], v[236:239], v[200:203], v[116:119]
    ds_read_b64 v[152:153], v22 offset:3200
g2_late:
    s_waitcnt vmcnt(22) lgkmcnt(15)
    v_mfma_f32_32x32x16_bf16 v[32:47], v[64:67], a[0:3], v[32:47]
    ds_read_b64_tr_b16 v[64:65], v8 offset:8192
    ds_read_b64_tr_b16 v[66:67], v8 offset:8704
    buffer_load_dwordx4 v19, s[56:59], s72 offen offset:2048 sc1 lds
    v_mfma_f32_16x16x32_bf16 v[120:123], v[240:243], v[200:203], v[120:123]
    ds_read_b64 v[154:155], v22 offset:3208
    v_mfma_f32_16x16x32_bf16 v[124:127], v[244:247], v[200:203], v[124:127]
    ds_read_b128 v[184:187], v23 offset:640
    v_mfma_f32_32x32x16_bf16 v[48:63], v[68:71], a[0:3], v[48:63]
    ds_read_b64_tr_b16 v[68:69], v9 offset:8192
    ds_read_b64_tr_b16 v[70:71], v9 offset:8704
    buffer_load_dwordx4 a[0:3], v10, s[36:39], s77 offen offset:0 sc1
    v_mfma_f32_16x16x32_bf16 v[108:111], v[224:227], v[204:207], v[108:111]
    ds_read_b64 v[156:157], v22 offset:3712
    v_mfma_f32_16x16x32_bf16 v[112:115], v[228:231], v[204:207], v[112:115]
    ds_read_b64 v[158:159], v22 offset:3720
    v_mfma_f32_16x16x32_bf16 v[116:119], v[232:235], v[204:207], v[116:119]
    ds_read_b128 v[188:191], v23 offset:128
    s_waitcnt vmcnt(23) lgkmcnt(15)
    v_mfma_f32_32x32x16_bf16 v[32:47], v[72:75], a[4:7], v[32:47]
    ds_read_b64_tr_b16 v[72:73], v8 offset:10240
    ds_read_b64_tr_b16 v[74:75], v8 offset:10752
    v_mfma_f32_16x16x32_bf16 v[120:123], v[236:239], v[204:207], v[120:123]
    v_mfma_f32_16x16x32_bf16 v[124:127], v[240:243], v[204:207], v[124:127]
    v_mfma_f32_32x32x16_bf16 v[48:63], v[76:79], a[4:7], v[48:63]
    ds_read_b64_tr_b16 v[76:77], v9 offset:10240
    ds_read_b64_tr_b16 v[78:79], v9 offset:10752
    buffer_load_dwordx4 a[4:7], v10, s[36:39], s77 offen offset:1024 sc1
    v_mfma_f32_16x16x32_bf16 v[112:115], v[224:227], v[208:211], v[112:115]
    v_mfma_f32_16x16x32_bf16 v[116:119], v[228:231], v[208:211], v[116:119]
    v_mfma_f32_16x16x32_bf16 v[120:123], v[232:235], v[208:211], v[120:123]
    s_waitcnt vmcnt(22) lgkmcnt(15)
    v_mfma_f32_32x32x16_bf16 v[32:47], v[80:83], a[8:11], v[32:47]
    ds_read_b64_tr_b16 v[80:81], v8 offset:12288
    ds_read_b64_tr_b16 v[82:83], v8 offset:12800
    buffer_load_dwordx4 v5, s[56:59], s72 offen offset:3072 sc1 lds
    s_add_u32 s72, s72, s76
    v_mfma_f32_16x16x32_bf16 v[124:127], v[236:239], v[208:211], v[124:127]
    v_mfma_f32_16x16x32_bf16 v[116:119], v[224:227], v[212:215], v[116:119]
    v_mfma_f32_32x32x16_bf16 v[48:63], v[84:87], a[8:11], v[48:63]
    ds_read_b64_tr_b16 v[84:85], v9 offset:12288
    ds_read_b64_tr_b16 v[86:87], v9 offset:12800
    buffer_load_dwordx4 a[8:11], v10, s[36:39], s77 offen offset:2048 sc1
    v_mfma_f32_16x16x32_bf16 v[120:123], v[228:231], v[212:215], v[120:123]
    v_mfma_f32_16x16x32_bf16 v[124:127], v[232:235], v[212:215], v[124:127]
    v_mfma_f32_16x16x32_bf16 v[120:123], v[224:227], v[216:219], v[120:123]
    s_waitcnt vmcnt(23) lgkmcnt(15)
    v_mfma_f32_32x32x16_bf16 v[32:47], v[88:91], a[12:15], v[32:47]
    ds_read_b64_tr_b16 v[88:89], v8 offset:14336
    ds_read_b64_tr_b16 v[90:91], v8 offset:14848
    v_mfma_f32_16x16x32_bf16 v[124:127], v[228:231], v[216:219], v[124:127]
    v_mfma_f32_16x16x32_bf16 v[124:127], v[224:227], v[220:223], v[124:127]
    v_mfma_f32_32x32x16_bf16 v[48:63], v[92:95], a[12:15], v[48:63]
    ds_read_b64_tr_b16 v[92:93], v9 offset:14336
    ds_read_b64_tr_b16 v[94:95], v9 offset:14848
    buffer_load_dwordx4 a[12:15], v10, s[36:39], s77 offen offset:3072 sc1
    s_add_u32 s77, s77, 4096
    s_waitcnt lgkmcnt(12)
    v_mfma_f32_16x16x32_bf16 v[96:99], v[160:163], v[128:131], v[96:99]
    ds_read_b64 v[192:193], v22 offset:192
    v_mfma_f32_16x16x32_bf16 v[100:103], v[164:167], v[128:131], v[100:103]
    ds_read_b64 v[194:195], v22 offset:200
    v_mfma_f32_16x16x32_bf16 v[104:107], v[168:171], v[128:131], v[104:107]
    ds_read_b128 v[224:227], v23 offset:3776
    s_waitcnt vmcnt(22) lgkmcnt(15)
    v_mfma_f32_32x32x16_bf16 v[32:47], v[64:67], a[16:19], v[32:47]
    s_waitcnt vmcnt(26)
    s_barrier
    ds_read_b64_tr_b16 v[64:65], v8 offset:16384
    ds_read_b64_tr_b16 v[66:67], v8 offset:16896
    s_add_u32 m0, s74, 65536
    s_nop 0
    buffer_load_dwordx4 v12, s[56:59], s72 offen offset:0 sc1 lds
    v_mfma_f32_16x16x32_bf16 v[108:111], v[172:175], v[128:131], v[108:111]
    ds_read_b64 v[196:197], v22 offset:704
    v_mfma_f32_16x16x32_bf16 v[112:115], v[176:179], v[128:131], v[112:115]
    ds_read_b64 v[198:199], v22 offset:712
    v_mfma_f32_32x32x16_bf16 v[48:63], v[68:71], a[16:19], v[48:63]
    ds_read_b64_tr_b16 v[68:69], v9 offset:16384
    ds_read_b64_tr_b16 v[70:71], v9 offset:16896
    buffer_load_dwordx4 a[16:19], v10, s[36:39], s77 offen offset:0 sc1
    v_mfma_f32_16x16x32_bf16 v[116:119], v[180:183], v[128:131], v[116:119]
    ds_read_b128 v[228:231], v23 offset:3264
    v_mfma_f32_16x16x32_bf16 v[120:123], v[184:187], v[128:131], v[120:123]
    ds_read_b64 v[200:201], v22 offset:1216
    v_mfma_f32_16x16x32_bf16 v[124:127], v[188:191], v[128:131], v[124:127]
    ds_read_b64 v[202:203], v22 offset:1224
    s_waitcnt vmcnt(23) lgkmcnt(15)
    v_mfma_f32_32x32x16_bf16 v[32:47], v[72:75], a[20:23], v[32:47]
    ds_read_b64_tr_b16 v[72:73], v8 offset:18432
    ds_read_b64_tr_b16 v[74:75], v8 offset:18944
    v_mfma_f32_16x16x32_bf16 v[100:103], v[160:163], v[132:135], v[100:103]
    ds_read_b128 v[232:235], v23 offset:2752
    v_mfma_f32_16x16x32_bf16 v[104:107], v[164:167], v[132:135], v[104:107]
    ds_read_b64 v[204:205], v22 offset:1728
    v_mfma_f32_32x32x16_bf16 v[48:63], v[76:79], a[20:23], v[48:63]
    ds_read_b64_tr_b16 v[76:77], v9 offset:18432
    ds_read_b64_tr_b16 v[78:79], v9 offset:18944
    buffer_load_dwordx4 a[20:23], v10, s[36:39], s77 offen offset:1024 sc1
    v_mfma_f32_16x16x32_bf16 v[108:111], v[168:171], v[132:135], v[108:111]
    ds_read_b64 v[206:207], v22 offset:1736
    v_mfma_f32_16x16x32_bf16 v[112:115], v[172:175], v[132:135], v[112:115]
    ds_read_b128 v[236:239], v23 offset:2240
    v_mfma_f32_16x16x32_bf16 v[116:119], v[176:179], v[132:135], v[116:119]
    ds_read_b64 v[208:209], v22 offset:2240
    s_waitcnt vmcnt(22) lgkmcnt(15)
    v_mfma_f32_32x32x16_bf16 v[32:47], v[80:83], a[24:27], v[32:47]
    ds_read_b64_tr_b16 v[80:81], v8 offset:20480
    ds_read_b64_tr_b16 v[82:83], v8 offset:20992
    buffer_load_dwordx4 v18, s[56:59], s72 offen offset:1024 sc1 lds
    v_mfma_f32_16x16x32_bf16 v[120:123], v[180:183], v[132:135], v[120:123]
    ds_read_b64 v[210:211], v22 offset:2248
    v_mfma_f32_16x16x32_bf16 v[124:127], v[184:187], v[132:135], v[124:127]
    ds_read_b128 v[240:243], v23 offset:1728
    v_mfma_f32_32x32x16_bf16 v[48:63], v[84:87], a[24:27], v[48:63]
    ds_read_b64_tr_b16 v[84:85], v9 offset:20480
    ds_read_b64_tr_b16 v[86:87], v9 offset:20992
    buffer_load_dwordx4 a[24:27], v10, s[36:39], s77 offen offset:2048 sc1
    v_mfma_f32_16x16x32_bf16 v[104:107], v[160:163], v[136:139], v[104:107]
    ds_read_b64 v[212:213], v22 offset:2752
    v_mfma_f32_16x16x32_bf16 v[108:111], v[164:167], v[136:139], v[108:111]
    ds_read_b64 v[214:215], v22 offset:2760
    v_mfma_f32_16x16x32_bf16 v[112:115], v[168:171], v[136:139], v[112:115]
    ds_read_b128 v[244:247], v23 offset:1216
    s_waitcnt vmcnt(23) lgkmcnt(15)
    v_mfma_f32_32x32x16_bf16 v[32:47], v[88:91], a[28:31], v[32:47]
    ds_read_b64_tr_b16 v[88:89], v8 offset:22528
    ds_read_b64_tr_b16 v[90:91], v8 offset:23040
    v_mfma_f32_16x16x32_bf16 v[116:119], v[172:175], v[136:139], v[116:119]
    ds_read_b64 v[216:217], v22 offset:3264
    v_mfma_f32_16x16x32_bf16 v[120:123], v[176:179], v[136:139], v[120:123]
    ds_read_b64 v[218:219], v22 offset:3272
    v_mfma_f32_32x32x16_bf16 v[48:63], v[92:95], a[28:31], v[48:63]
    ds_read_b64_tr_b16 v[92:93], v9 offset:22528
    ds_read_b64_tr_b16 v[94:95], v9 offset:23040
    buffer_load_dwordx4 a[28:31], v10, s[36:39], s77 offen offset:3072 sc1
    s_add_u32 s77, s77, 4096
    v_mfma_f32_16x16x32_bf16 v[124:127], v[180:183], v[136:139], v[124:127]
    ds_read_b128 v[248:251], v23 offset:704
    v_mfma_f32_16x16x32_bf16 v[108:111], v[160:163], v[140:143], v[108:111]
    ds_read_b64 v[220:221], v22 offset:3776
    v_mfma_f32_16x16x32_bf16 v[112:115], v[164:167], v[140:143], v[112:115]
    ds_read_b64 v[222:223], v22 offset:3784
    s_waitcnt vmcnt(22) lgkmcnt(15)
    v_mfma_f32_32x32x16_bf16 v[32:47], v[64:67], a[32:35], v[32:47]
    ds_read_b64_tr_b16 v[64:65], v8 offset:24576
    ds_read_b64_tr_b16 v[66:67], v8 offset:25088
    buffer_load_dwordx4 v19, s[56:59], s72 offen offset:2048 sc1 lds
    v_mfma_f32_16x16x32_bf16 v[116:119], v[168:171], v[140:143], v[116:119]
    ds_read_b128 v[252:255], v23 offset:192
    v_mfma_f32_16x16x32_bf16 v[120:123], v[172:175], v[140:143], v[120:123]
    v_mfma_f32_32x32x16_bf16 v[48:63], v[68:71], a[32:35], v[48:63]
    ds_read_b64_tr_b16 v[68:69], v9 offset:24576
    ds_read_b64_tr_b16 v[70:71], v9 offset:25088
    buffer_load_dwordx4 a[32:35], v10, s[36:39], s77 offen offset:0 sc1
    v_mfma_f32_16x16x32_bf16 v[124:127], v[176:179], v[140:143], v[124:127]
    v_mfma_f32_16x16x32_bf16 v[112:115], v[160:163], v[144:147], v[112:115]
    v_mfma_f32_16x16x32_bf16 v[116:119], v[164:167], v[144:147], v[116:119]
    s_waitcnt vmcnt(23) lgkmcnt(15)
    v_mfma_f32_32x32x16_bf16 v[32:47], v[72:75], a[36:39], v[32:47]
    ds_read_b64_tr_b16 v[72:73], v8 offset:26624
    ds_read_b64_tr_b16 v[74:75], v8 offset:27136
    v_mfma_f32_16x16x32_bf16 v[120:123], v[168:171], v[144:147], v[120:123]
    v_mfma_f32_16x16x32_bf16 v[124:127], v[172:175], v[144:147], v[124:127]
    v_mfma_f32_32x32x16_bf16 v[48:63], v[76:79], a[36:39], v[48:63]
    ds_read_b64_tr_b16 v[76:77], v9 offset:26624
    ds_read_b64_tr_b16 v[78:79], v9 offset:27136
    buffer_load_dwordx4 a[36:39], v10, s[36:39], s77 offen offset:1024 sc1
    v_mfma_f32_16x16x32_bf16 v[116:119], v[160:163], v[148:151], v[116:119]
    v_mfma_f32_16x16x32_bf16 v[120:123], v[164:167], v[148:151], v[120:123]
    v_mfma_f32_16x16x32_bf16 v[124:127], v[168:171], v[148:151], v[124:127]
    s_waitcnt vmcnt(22) lgkmcnt(15)
    v_mfma_f32_32x32x16_bf16 v[32:47], v[80:83], a[40:43], v[32:47]
    ds_read_b64_tr_b16 v[80:81], v8 offset:28672
    ds_read_b64_tr_b16 v[82:83], v8 offset:29184
    buffer_load_dwordx4 v5, s[56:59], s72 offen offset:3072 sc1 lds
    s_add_u32 s72, s72, s76
    v_mfma_f32_16x16x32_bf16 v[120:123], v[160:163], v[152:155], v[120:123]
    v_mfma_f32_16x16x32_bf16 v[124:127], v[164:167], v[152:155], v[124:127]
    v_mfma_f32_32x32x16_bf16 v[48:63], v[84:87], a[40:43], v[48:63]
    ds_read_b64_tr_b16 v[84:85], v9 offset:28672
    ds_read_b64_tr_b16 v[86:87], v9 offset:29184
    buffer_load_dwordx4 a[40:43], v10, s[36:39], s77 offen offset:2048 sc1
    v_mfma_f32_16x16x32_bf16 v[124:127], v[160:163], v[156:159], v[124:127]
    s_waitcnt lgkmcnt(10)
    v_mfma_f32_16x16x32_bf16 v[96:99], v[224:227], v[192:195], v[96:99]
    ds_read_b64 v[128:129], v22 offset:256
    v_mfma_f32_16x16x32_bf16 v[100:103], v[228:231], v[192:195], v[100:103]
    ds_read_b64 v[130:131], v22 offset:264
    s_waitcnt vmcnt(23) lgkmcnt(15)
    v_mfma_f32_32x32x16_bf16 v[32:47], v[88:91], a[44:47], v[32:47]
    ds_read_b64_tr_b16 v[88:89], v8 offset:30720
    ds_read_b64_tr_b16 v[90:91], v8 offset:31232
    v_mfma_f32_16x16x32_bf16 v[104:107], v[232:235], v[192:195], v[104:107]
    ds_read_b128 v[160:163], v23 offset:3840
    v_mfma_f32_16x16x32_bf16 v[108:111], v[236:239], v[192:195], v[108:111]
    ds_read_b64 v[132:133], v22 offset:768
    v_mfma_f32_32x32x16_bf16 v[48:63], v[92:95], a[44:47], v[48:63]
    ds_read_b64_tr_b16 v[92:93], v9 offset:30720
    ds_read_b64_tr_b16 v[94:95], v9 offset:31232
    buffer_load_dwordx4 a[44:47], v10, s[36:39], s77 offen offset:3072 sc1
    s_add_u32 s77, s77, 4096
    v_mfma_f32_16x16x32_bf16 v[112:115], v[240:243], v[192:195], v[112:115]
    ds_read_b64 v[134:135], v22 offset:776
    v_mfma_f32_16x16x32_bf16 v[116:119], v[244:247], v[192:195], v[116:119]
    ds_read_b128 v[164:167], v23 offset:3328
    v_mfma_f32_16x16x32_bf16 v[120:123], v[248:251], v[192:195], v[120:123]
    ds_read_b64 v[136:137], v22 offset:1280
    s_waitcnt vmcnt(22) lgkmcnt(15)
    v_mfma_f32_32x32x16_bf16 v[32:47], v[64:67], a[48:51], v[32:47]
    s_waitcnt vmcnt(26)
    s_barrier
    ds_read_b64_tr_b16 v[64:65], v8 offset:32768
    ds_read_b64_tr_b16 v[66:67], v8 offset:33280
    s_add_u32 m0, s74, 0
    s_nop 0
    buffer_load_dwordx4 v12, s[56:59], s72 offen offset:0 sc1 lds
    v_mfma_f32_16x16x32_bf16 v[124:127], v[252:255], v[192:195], v[124:127]
    ds_read_b64 v[138:139], v22 offset:1288
    v_mfma_f32_16x16x32_bf16 v[100:103], v[224:227], v[196:199], v[100:103]
    ds_read_b128 v[168:171], v23 offset:2816
    v_mfma_f32_32x32x16_bf16 v[48:63], v[68:71], a[48:51], v[48:63]
    ds_read_b64_tr_b16 v[68:69], v9 offset:32768
    ds_read_b64_tr_b16 v[70:71], v9 offset:33280
    buffer_load_dwordx4 a[48:51], v10, s[36:39], s77 offen offset:0 sc1
    v_mfma_f32_16x16x32_bf16 v[104:107], v[228:231], v[196:199], v[104:107]
    ds_read_b64 v[140:141], v22 offset:1792
    v_mfma_f32_16x16x32_bf16 v[108:111], v[232:235], v[196:199], v[108:111]
    ds_read_b64 v[142:143], v22 offset:1800
    v_mfma_f32_16x16x32_bf16 v[112:115], v[236:239], v[196:199], v[112:115]
    ds_read_b128 v[172:175], v23 offset:2304
    s_waitcnt vmcnt(23) lgkmcnt(15)
    v_mfma_f32_32x32x16_bf16 v[32:47], v[72:75], a[52:55], v[32:47]
    ds_read_b64_tr_b16 v[72:73], v8 offset:34816
    ds_read_b64_tr_b16 v[74:75], v8 offset:35328
    v_mfma_f32_16x16x32_bf16 v[116:119], v[240:243], v[196:199], v[116:119]
    ds_read_b64 v[144:145], v22 offset:2304
    v_mfma_f32_16x16x32_bf16 v[120:123], v[244:247], v[196:199], v[120:123]
    ds_read_b64 v[146:147], v22 offset:2312
    v_mfma_f32_32x32x16_bf16 v[48:63], v[76:79], a[52:55], v[48:63]
    ds_read_b64_tr_b16 v[76:77], v9 offset:34816
    ds_read_b64_tr_b16 v[78:79], v9 offset:35328
    buffer_load_dwordx4 a[52:55], v10, s[36:39], s77 offen offset:1024 sc1
    v_mfma_f32_16x16x32_bf16 v[124:127], v[248:251], v[196:199], v[124:127]
    ds_read_b128 v[176:179], v23 offset:1792
    v_mfma_f32_16x16x32_bf16 v[104:107], v[224:227], v[200:203], v[104:107]
    ds_read_b64 v[148:149], v22 offset:2816
    v_mfma_f32_16x16x32_bf16 v[108:111], v[228:231], v[200:203], v[108:111]
    ds_read_b64 v[150:151], v22 offset:2824
    s_waitcnt vmcnt(22) lgkmcnt(15)
    v_mfma_f32_32x32x16_bf16 v[32:47], v[80:83], a[56:59], v[32:47]
    ds_read_b64_tr_b16 v[80:81], v8 offset:36864
    ds_read_b64_tr_b16 v[82:83], v8 offset:37376
    buffer_load_dwordx4 v18, s[56:59], s72 offen offset:1024 sc1 lds
    v_mfma_f32_16x16x32_bf16 v[112:115], v[232:235], v[200:203], v[112:115]
    ds_read_b128 v[180:183], v23 offset:1280
    v_mfma_f32_16x16x32_bf16 v[116:119], v[236:239], v[200:203], v[116:119]
    ds_read_b64 v[152:153], v22 offset:3328
    v_mfma_f32_32x32x16_bf16 v[48:63], v[84:87], a[56:59], v[48:63]
    ds_read_b64_tr_b16 v[84:85], v9 offset:36864
    ds_read_b64_tr_b16 v[86:87], v9 offset:37376
    buffer_load_dwordx4 a[56:59], v10, s[36:39], s77 offen offset:2048 sc1
    v_mfma_f32_16x16x32_bf16 v[120:123], v[240:243], v[200:203], v[120:123]
    ds_read_b64 v[154:155], v22 offset:3336
    v_mfma_f32_16x16x32_bf16 v[124:127], v[244:247], v[200:203], v[124:127]
    ds_read_b128 v[184:187], v23 offset:768
    v_mfma_f32_16x16x32_bf16 v[108:111], v[224:227], v[204:207], v[108:111]
    ds_read_b64 v[156:157], v22 offset:3840
    s_waitcnt vmcnt(23) lgkmcnt(15)
    v_mfma_f32_32x32x16_bf16 v[32:47], v[88:91], a[60:63], v[32:47]
    ds_read_b64_tr_b16 v[88:89], v8 offset:38912
    ds_read_b64_tr_b16 v[90:91], v8 offset:39424
    v_mfma_f32_16x16x32_bf16 v[112:115], v[228:231], v[204:207], v[112:115]
    ds_read_b64 v[158:159], v22 offset:3848
    v_mfma_f32_16x16x32_bf16 v[116:119], v[232:235], v[204:207], v[116:119]
    ds_read_b128 v[188:191], v23 offset:256
    v_mfma_f32_32x32x16_bf16 v[48:63], v[92:95], a[60:63], v[48:63]
    ds_read_b64_tr_b16 v[92:93], v9 offset:38912
    ds_read_b64_tr_b16 v[94:95], v9 offset:39424
    buffer_load_dwordx4 a[60:63], v10, s[36:39], s77 offen offset:3072 sc1
    s_add_u32 s77, s77, 4096
    v_mfma_f32_16x16x32_bf16 v[120:123], v[236:239], v[204:207], v[120:123]
    v_mfma_f32_16x16x32_bf16 v[124:127], v[240:243], v[204:207], v[124:127]
    v_mfma_f32_16x16x32_bf16 v[112:115], v[224:227], v[208:211], v[112:115]
    s_waitcnt vmcnt(22) lgkmcnt(15)
    v_mfma_f32_32x32x16_bf16 v[32:47], v[64:67], a[0:3], v[32:47]
    ds_read_b64_tr_b16 v[64:65], v8 offset:40960
    ds_read_b64_tr_b16 v[66:67], v8 offset:41472
    buffer_load_dwordx4 v19, s[56:59], s72 offen offset:2048 sc1 lds
    v_mfma_f32_16x16x32_bf16 v[116:119], v[228:231], v[208:211], v[116:119]
    v_mfma_f32_16x16x32_bf16 v[120:123], v[232:235], v[208:211], v[120:123]
    v_mfma_f32_32x32x16_bf16 v[48:63], v[68:71], a[0:3], v[48:63]
    ds_read_b64_tr_b16 v[68:69], v9 offset:40960
    ds_read_b64_tr_b16 v[70:71], v9 offset:41472
    buffer_load_dwordx4 a[0:3], v10, s[36:39], s77 offen offset:0 sc1
    v_mfma_f32_16x16x32_bf16 v[124:127], v[236:239], v[208:211], v[124:127]
    v_mfma_f32_16x16x32_bf16 v[116:119], v[224:227], v[212:215], v[116:119]
    v_mfma_f32_16x16x32_bf16 v[120:123], v[228:231], v[212:215], v[120:123]
    s_waitcnt vmcnt(23) lgkmcnt(15)
    v_mfma_f32_32x32x16_bf16 v[32:47], v[72:75], a[4:7], v[32:47]
    ds_read_b64_tr_b16 v[72:73], v8 offset:43008
    ds_read_b64_tr_b16 v[74:75], v8 offset:43520
    v_mfma_f32_16x16x32_bf16 v[124:127], v[232:235], v[212:215], v[124:127]
    v_mfma_f32_16x16x32_bf16 v[120:123], v[224:227], v[216:219], v[120:123]
    v_mfma_f32_32x32x16_bf16 v[48:63], v[76:79], a[4:7], v[48:63]
    ds_read_b64_tr_b16 v[76:77], v9 offset:43008
    ds_read_b64_tr_b16 v[78:79], v9 offset:43520
    buffer_load_dwordx4 a[4:7], v10, s[36:39], s77 offen offset:1024 sc1
    v_mfma_f32_16x16x32_bf16 v[124:127], v[228:231], v[216:219], v[124:127]
    v_mfma_f32_16x16x32_bf16 v[124:127], v[224:227], v[220:223], v[124:127]
    s_waitcnt lgkmcnt(10)
    v_mfma_f32_16x16x32_bf16 v[96:99], v[160:163], v[128:131], v[96:99]
    ds_read_b64 v[192:193], v22 offset:320
    s_waitcnt vmcnt(22) lgkmcnt(15)
    v_mfma_f32_32x32x16_bf16 v[32:47], v[80:83], a[8:11], v[32:47]
    ds_read_b64_tr_b16 v[80:81], v8 offset:45056
    ds_read_b64_tr_b16 v[82:83], v8 offset:45568
    buffer_load_dwordx4 v5, s[56:59], s72 offen offset:3072 sc1 lds
    s_add_u32 s72, s72, s76
    v_mfma_f32_16x16x32_bf16 v[100:103], v[164:167], v[128:131], v[100:103]
    ds_read_b64 v[194:195], v22 offset:328
    v_mfma_f32_16x16x32_bf16 v[104:107], v[168:171], v[128:131], v[104:107]
    ds_read_b128 v[224:227], v23 offset:3904
    v_mfma_f32_32x32x16_bf16 v[48:63], v[84:87], a[8:11], v[48:63]
    ds_read_b64_tr_b16 v[84:85], v9 offset:45056
    ds_read_b64_tr_b16 v[86:87], v9 offset:45568
    buffer_load_dwordx4 a[8:11], v10, s[36:39], s77 offen offset:2048 sc1
    v_mfma_f32_16x16x32_bf16 v[108:111], v[172:175], v[128:131], v[108:111]
    ds_read_b64 v[196:197], v22 offset:832
    v_mfma_f32_16x16x32_bf16 v[112:115], v[176:179], v[128:131], v[112:115]
    ds_read_b64 v[198:199], v22 offset:840
    v_mfma_f32_16x16x32_bf16 v[116:119], v[180:183], v[128:131], v[116:119]
    ds_read_b128 v[228:231], v23 offset:3392
    s_waitcnt vmcnt(23) lgkmcnt(15)
    v_mfma_f32_32x32x16_bf16 v[32:47], v[88:91], a[12:15], v[32:47]
    ds_read_b64_tr_b16 v[88:89], v8 offset:47104
    ds_read_b64_tr_b16 v[90:91], v8 offset:47616
    v_mfma_f32_16x16x32_bf16 v[120:123], v[184:187], v[128:131], v[120:123]
    ds_read_b64 v[200:201], v22 offset:1344
    v_mfma_f32_16x16x32_bf16 v[124:127], v[188:191], v[128:131], v[124:127]
    ds_read_b64 v[202:203], v22 offset:1352
    v_mfma_f32_32x32x16_bf16 v[48:63], v[92:95], a[12:15], v[48:63]
    ds_read_b64_tr_b16 v[92:93], v9 offset:47104
    ds_read_b64_tr_b16 v[94:95], v9 offset:47616
    buffer_load_dwordx4 a[12:15], v10, s[36:39], s77 offen offset:3072 sc1
    s_add_u32 s77, s77, 4096
    v_mfma_f32_16x16x32_bf16 v[100:103], v[160:163], v[132:135], v[100:103]
    ds_read_b128 v[232:235], v23 offset:2880
    v_mfma_f32_16x16x32_bf16 v[104:107], v[164:167], v[132:135], v[104:107]
    ds_read_b64 v[204:205], v22 offset:1856
    v_mfma_f32_16x16x32_bf16 v[108:111], v[168:171], v[132:135], v[108:111]
    ds_read_b64 v[206:207], v22 offset:1864
    s_waitcnt vmcnt(22) lgkmcnt(15)
    v_mfma_f32_32x32x16_bf16 v[32:47], v[64:67], a[16:19], v[32:47]
    s_waitcnt vmcnt(26)
    s_barrier
    ds_read_b64_tr_b16 v[64:65], v8 offset:49152
    ds_read_b64_tr_b16 v[66:67], v8 offset:49664
    s_add_u32 m0, s74, 16384
    s_nop 0
    buffer_load_dwordx4 v12, s[56:59], s72 offen offset:0 sc1 lds
    v_mfma_f32_16x16x32_bf16 v[112:115], v[172:175], v[132:135], v[112:115]
    ds_read_b128 v[236:239], v23 offset:2368
    v_mfma_f32_16x16x32_bf16 v[116:119], v[176:179], v[132:135], v[116:119]
    ds_read_b64 v[208:209], v22 offset:2368
    v_mfma_f32_32x32x16_bf16 v[48:63], v[68:71], a[16:19], v[48:63]
    ds_read_b64_tr_b16 v[68:69], v9 offset:49152
    ds_read_b64_tr_b16 v[70:71], v9 offset:49664
    buffer_load_dwordx4 a[16:19], v10, s[36:39], s77 offen offset:0 sc1
    v_mfma_f32_16x16x32_bf16 v[120:123], v[180:183], v[132:135], v[120:123]
    ds_read_b64 v[210:211], v22 offset:2376
    v_mfma_f32_16x16x32_bf16 v[124:127], v[184:187], v[132:135], v[124:127]
    ds_read_b128 v[240:243], v23 offset:1856
    v_mfma_f32_16x16x32_bf16 v[104:107], v[160:163], v[136:139], v[104:107]
    ds_read_b64 v[212:213], v22 offset:2880
    s_waitcnt vmcnt(23) lgkmcnt(15)
    v_mfma_f32_32x32x16_bf16 v[32:47], v[72:75], a[20:23], v[32:47]
    ds_read_b64_tr_b16 v[72:73], v8 offset:51200
    ds_read_b64_tr_b16 v[74:75], v8 offset:51712
    v_mfma_f32_16x16x32_bf16 v[108:111], v[164:167], v[136:139], v[108:111]
    ds_read_b64 v[214:215], v22 offset:2888
    v_mfma_f32_16x16x32_bf16 v[112:115], v[168:171], v[136:139], v[112:115]
    ds_read_b128 v[244:247], v23 offset:1344
    v_mfma_f32_32x32x16_bf16 v[48:63], v[76:79], a[20:23], v[48:63]
    ds_read_b64_tr_b16 v[76:77], v9 offset:51200
    ds_read_b64_tr_b16 v[78:79], v9 offset:51712
    buffer_load_dwordx4 a[20:23], v10, s[36:39], s77 offen offset:1024 sc1
    v_mfma_f32_16x16x32_bf16 v[116:119], v[172:175], v[136:139], v[116:119]
    ds_read_b64 v[216:217], v22 offset:3392
    v_mfma_f32_16x16x32_bf16 v[120:123], v[176:179], v[136:139], v[120:123]
    ds_read_b64 v[218:219], v22 offset:3400
    v_mfma_f32_16x16x32_bf16 v[124:127], v[180:183], v[136:139], v[124:127]
    ds_read_b128 v[248:251], v23 offset:832
    s_waitcnt vmcnt(22) lgkmcnt(15)
    v_mfma_f32_32x32x16_bf16 v[32:47], v[80:83], a[24:27], v[32:47]
    ds_read_b64_tr_b16 v[80:81], v8 offset:53248
    ds_read_b64_tr_b16 v[82:83], v8 offset:53760
    buffer_load_dwordx4 v18, s[56:59], s72 offen offset:1024 sc1 lds
    v_mfma_f32_16x16x32_bf16 v[108:111], v[160:163], v[140:143], v[108:111]
    ds_read_b64 v[220:221], v22 offset:3904
    v_mfma_f32_16x16x32_bf16 v[112:115], v[164:167], v[140:143], v[112:115]
    ds_read_b64 v[222:223], v22 offset:3912
    v_mfma_f32_32x32x16_bf16 v[48:63], v[84:87], a[24:27], v[48:63]
    ds_read_b64_tr_b16 v[84:85], v9 offset:53248
    ds_read_b64_tr_b16 v[86:87], v9 offset:53760
    buffer_load_dwordx4 a[24:27], v10, s[36:39], s77 offen offset:2048 sc1
    v_mfma_f32_16x16x32_bf16 v[116:119], v[168:171], v[140:143], v[116:119]
    ds_read_b128 v[252:255], v23 offset:320
    v_mfma_f32_16x16x32_bf16 v[120:123], v[172:175], v[140:143], v[120:123]
    v_mfma_f32_16x16x32_bf16 v[124:127], v[176:179], v[140:143], v[124:127]
    s_waitcnt vmcnt(23) lgkmcnt(15)
    v_mfma_f32_32x32x16_bf16 v[32:47], v[88:91], a[28:31], v[32:47]
    ds_read_b64_tr_b16 v[88:89], v8 offset:55296
    ds_read_b64_tr_b16 v[90:91], v8 offset:55808
    v_mfma_f32_16x16x32_bf16 v[112:115], v[160:163], v[144:147], v[112:115]
    v_mfma_f32_16x16x32_bf16 v[116:119], v[164:167], v[144:147], v[116:119]
    v_mfma_f32_32x32x16_bf16 v[48:63], v[92:95], a[28:31], v[48:63]
    ds_read_b64_tr_b16 v[92:93], v9 offset:55296
    ds_read_b64_tr_b16 v[94:95], v9 offset:55808
    buffer_load_dwordx4 a[28:31], v10, s[36:39], s77 offen offset:3072 sc1
    s_add_u32 s77, s77, 4096
    v_mfma_f32_16x16x32_bf16 v[120:123], v[168:171], v[144:147], v[120:123]
    v_mfma_f32_16x16x32_bf16 v[124:127], v[172:175], v[144:147], v[124:127]
    v_mfma_f32_16x16x32_bf16 v[116:119], v[160:163], v[148:151], v[116:119]
    s_waitcnt vmcnt(22) lgkmcnt(15)
    v_mfma_f32_32x32x16_bf16 v[32:47], v[64:67], a[32:35], v[32:47]
    ds_read_b64_tr_b16 v[64:65], v8 offset:57344
    ds_read_b64_tr_b16 v[66:67], v8 offset:57856
    buffer_load_dwordx4 v19, s[56:59], s72 offen offset:2048 sc1 lds
    v_mfma_f32_16x16x32_bf16 v[120:123], v[164:167], v[148:151], v[120:123]
    v_mfma_f32_16x16x32_bf16 v[124:127], v[168:171], v[148:151], v[124:127]
    v_mfma_f32_32x32x16_bf16 v[48:63], v[68:71], a[32:35], v[48:63]
    ds_read_b64_tr_b16 v[68:69], v9 offset:57344
    ds_read_b64_tr_b16 v[70:71], v9 offset:57856
    buffer_load_dwordx4 a[32:35], v10, s[36:39], s77 offen offset:0 sc1
    v_mfma_f32_16x16x32_bf16 v[120:123], v[160:163], v[152:155], v[120:123]
    v_mfma_f32_16x16x32_bf16 v[124:127], v[164:167], v[152:155], v[124:127]
    v_mfma_f32_16x16x32_bf16 v[124:127], v[160:163], v[156:159], v[124:127]
    s_waitcnt vmcnt(23) lgkmcnt(15)
    v_mfma_f32_32x32x16_bf16 v[32:47], v[72:75], a[36:39], v[32:47]
    ds_read_b64_tr_b16 v[72:73], v8 offset:59392
    ds_read_b64_tr_b16 v[74:75], v8 offset:59904
    s_waitcnt lgkmcnt(10)
    v_mfma_f32_16x16x32_bf16 v[96:99], v[224:227], v[192:195], v[96:99]
    ds_read_b64 v[128:129], v22 offset:384
    v_mfma_f32_16x16x32_bf16 v[100:103], v[228:231], v[192:195], v[100:103]
    ds_read_b64 v[130:131], v22 offset:392
    v_mfma_f32_32x32x16_bf16 v[48:63], v[76:79], a[36:39], v[48:63]
    ds_read_b64_tr_b16 v[76:77], v9 offset:59392
    ds_read_b64_tr_b16 v[78:79], v9 offset:59904
    buffer_load_dwordx4 a[36:39], v10, s[36:39], s77 offen offset:1024 sc1
    v_mfma_f32_16x16x32_bf16 v[104:107], v[232:235], v[192:195], v[104:107]
    ds_read_b128 v[160:163], v23 offset:3968
    v_mfma_f32_16x16x32_bf16 v[108:111], v[236:239], v[192:195], v[108:111]
    ds_read_b64 v[132:133], v22 offset:896
    v_mfma_f32_16x16x32_bf16 v[112:115], v[240:243], v[192:195], v[112:115]
    ds_read_b64 v[134:135], v22 offset:904
    s_waitcnt vmcnt(22) lgkmcnt(15)
    v_mfma_f32_32x32x16_bf16 v[32:47], v[80:83], a[40:43], v[32:47]
    ds_read_b64_tr_b16 v[80:81], v8 offset:61440
    ds_read_b64_tr_b16 v[82:83], v8 offset:61952
    buffer_load_dwordx4 v5, s[56:59], s72 offen offset:3072 sc1 lds
    s_add_u32 s72, s72, s76
    v_mfma_f32_16x16x32_bf16 v[116:119], v[244:247], v[192:195], v[116:119]
    ds_read_b128 v[164:167], v23 offset:3456
    v_mfma_f32_16x16x32_bf16 v[120:123], v[248:251], v[192:195], v[120:123]
    ds_read_b64 v[136:137], v22 offset:1408
    v_mfma_f32_32x32x16_bf16 v[48:63], v[84:87], a[40:43], v[48:63]
    ds_read_b64_tr_b16 v[84:85], v9 offset:61440
    ds_read_b64_tr_b16 v[86:87], v9 offset:61952
    buffer_load_dwordx4 a[40:43], v10, s[36:39], s77 offen offset:2048 sc1
    v_mfma_f32_16x16x32_bf16 v[124:127], v[252:255], v[192:195], v[124:127]
    ds_read_b64 v[138:139], v22 offset:1416
    v_mfma_f32_16x16x32_bf16 v[100:103], v[224:227], v[196:199], v[100:103]
    ds_read_b128 v[168:171], v23 offset:2944
    v_mfma_f32_16x16x32_bf16 v[104:107], v[228:231], v[196:199], v[104:107]
    ds_read_b64 v[140:141], v22 offset:1920
    s_waitcnt vmcnt(23) lgkmcnt(15)
    v_mfma_f32_32x32x16_bf16 v[32:47], v[88:91], a[44:47], v[32:47]
    ds_read_b64_tr_b16 v[88:89], v8 offset:63488
    ds_read_b64_tr_b16 v[90:91], v8 offset:64000
    v_mfma_f32_16x16x32_bf16 v[108:111], v[232:235], v[196:199], v[108:111]
    ds_read_b64 v[142:143], v22 offset:1928
    v_mfma_f32_16x16x32_bf16 v[112:115], v[236:239], v[196:199], v[112:115]
    ds_read_b128 v[172:175], v23 offset:2432
    v_mfma_f32_32x32x16_bf16 v[48:63], v[92:95], a[44:47], v[48:63]
    ds_read_b64_tr_b16 v[92:93], v9 offset:63488
    ds_read_b64_tr_b16 v[94:95], v9 offset:64000
    buffer_load_dwordx4 a[44:47], v10, s[36:39], s77 offen offset:3072 sc1
    s_add_u32 s77, s77, 4096
    v_mfma_f32_16x16x32_bf16 v[116:119], v[240:243], v[196:199], v[116:119]
    ds_read_b64 v[144:145], v22 offset:2432
    v_mfma_f32_16x16x32_bf16 v[120:123], v[244:247], v[196:199], v[120:123]
    ds_read_b64 v[146:147], v22 offset:2440
    v_mfma_f32_16x16x32_bf16 v[124:127], v[248:251], v[196:199], v[124:127]
    ds_read_b128 v[176:179], v23 offset:1920
    s_waitcnt vmcnt(22) lgkmcnt(15)
    v_mfma_f32_32x32x16_bf16 v[32:47], v[64:67], a[48:51], v[32:47]
    s_waitcnt vmcnt(26)
    s_barrier
    ds_read_b64_tr_b16 v[64:65], v3 offset:0
    ds_read_b64_tr_b16 v[66:67], v3 offset:512
    s_add_u32 m0, s74, 32768
    s_nop 0
    buffer_load_dwordx4 v12, s[56:59], s72 offen offset:0 sc1 lds
    v_mfma_f32_16x16x32_bf16 v[104:107], v[224:227], v[200:203], v[104:107]
    ds_read_b64 v[148:149], v22 offset:2944
    v_mfma_f32_16x16x32_bf16 v[108:111], v[228:231], v[200:203], v[108:111]
    ds_read_b64 v[150:151], v22 offset:2952
    v_mfma_f32_32x32x16_bf16 v[48:63], v[68:71], a[48:51], v[48:63]
    ds_read_b64_tr_b16 v[68:69], v4 offset:0
    ds_read_b64_tr_b16 v[70:71], v4 offset:512
    buffer_load_dwordx4 a[48:51], v10, s[36:39], s77 offen offset:0 sc1
    v_mfma_f32_16x16x32_bf16 v[112:115], v[232:235], v[200:203], v[112:115]
    ds_read_b128 v[180:183], v23 offset:1408
    v_mfma_f32_16x16x32_bf16 v[116:119], v[236:239], v[200:203], v[116:119]
    ds_read_b64 v[152:153], v22 offset:3456
    v_mfma_f32_16x16x32_bf16 v[120:123], v[240:243], v[200:203], v[120:123]
    ds_read_b64 v[154:155], v22 offset:3464
    s_waitcnt vmcnt(23) lgkmcnt(15)
    v_mfma_f32_32x32x16_bf16 v[32:47], v[72:75], a[52:55], v[32:47]
    ds_read_b64_tr_b16 v[72:73], v3 offset:2048
    ds_read_b64_tr_b16 v[74:75], v3 offset:2560
    v_mfma_f32_16x16x32_bf16 v[124:127], v[244:247], v[200:203], v[124:127]
    ds_read_b128 v[184:187], v23 offset:896
    v_mfma_f32_16x16x32_bf16 v[108:111], v[224:227], v[204:207], v[108:111]
    ds_read_b64 v[156:157], v22 offset:3968
    v_mfma_f32_32x32x16_bf16 v[48:63], v[76:79], a[52:55], v[48:63]
    ds_read_b64_tr_b16 v[76:77], v4 offset:2048
    ds_read_b64_tr_b16 v[78:79], v4 offset:2560
    buffer_load_dwordx4 a[52:55], v10, s[36:39], s77 offen offset:1024 sc1
    v_mfma_f32_16x16x32_bf16 v[112:115], v[228:231], v[204:207], v[112:115]
    ds_read_b64 v[158:159], v22 offset:3976
    v_mfma_f32_16x16x32_bf16 v[116:119], v[232:235], v[204:207], v[116:119]
    ds_read_b128 v[188:191], v23 offset:384
    v_mfma_f32_16x16x32_bf16 v[120:123], v[236:239], v[204:207], v[120:123]
    s_waitcnt vmcnt(22) lgkmcnt(15)
    v_mfma_f32_32x32x16_bf16 v[32:47], v[80:83], a[56:59], v[32:47]
    ds_read_b64_tr_b16 v[80:81], v3 offset:4096
    ds_read_b64_tr_b16 v[82:83], v3 offset:4608
    buffer_load_dwordx4 v18, s[56:59], s72 offen offset:1024 sc1 lds
    v_mfma_f32_16x16x32_bf16 v[124:127], v[240:243], v[204:207], v[124:127]
    v_mfma_f32_16x16x32_bf16 v[112:115], v[224:227], v[208:211], v[112:115]
    v_mfma_f32_32x32x16_bf16 v[48:63], v[84:87], a[56:59], v[48:63]
    ds_read_b64_tr_b16 v[84:85], v4 offset:4096
    ds_read_b64_tr_b16 v[86:87], v4 offset:4608
    buffer_load_dwordx4 a[56:59], v10, s[36:39], s77 offen offset:2048 sc1
    v_mfma_f32_16x16x32_bf16 v[116:119], v[228:231], v[208:211], v[116:119]
    v_mfma_f32_16x16x32_bf16 v[120:123], v[232:235], v[208:211], v[120:123]
    v_mfma_f32_16x16x32_bf16 v[124:127], v[236:239], v[208:211], v[124:127]
    s_waitcnt vmcnt(23) lgkmcnt(15)
    v_mfma_f32_32x32x16_bf16 v[32:47], v[88:91], a[60:63], v[32:47]
    ds_read_b64_tr_b16 v[88:89], v3 offset:6144
    ds_read_b64_tr_b16 v[90:91], v3 offset:6656
    v_mfma_f32_16x16x32_bf16 v[116:119], v[224:227], v[212:215], v[116:119]
    v_mfma_f32_16x16x32_bf16 v[120:123], v[228:231], v[212:215], v[120:123]
    v_mfma_f32_32x32x16_bf16 v[48:63], v[92:95], a[60:63], v[48:63]
    ds_read_b64_tr_b16 v[92:93], v4 offset:6144
    ds_read_b64_tr_b16 v[94:95], v4 offset:6656
    buffer_load_dwordx4 a[60:63], v10, s[36:39], s77 offen offset:3072 sc1
    s_add_u32 s77, s77, 4096
    v_mfma_f32_16x16x32_bf16 v[124:127], v[232:235], v[212:215], v[124:127]
    v_mfma_f32_16x16x32_bf16 v[120:123], v[224:227], v[216:219], v[120:123]
    v_mfma_f32_16x16x32_bf16 v[124:127], v[228:231], v[216:219], v[124:127]
    s_waitcnt vmcnt(22) lgkmcnt(15)
    v_mfma_f32_32x32x16_bf16 v[32:47], v[64:67], a[0:3], v[32:47]
    ds_read_b64_tr_b16 v[64:65], v3 offset:8192
    ds_read_b64_tr_b16 v[66:67], v3 offset:8704
    buffer_load_dwordx4 v19, s[56:59], s72 offen offset:2048 sc1 lds
    v_mfma_f32_16x16x32_bf16 v[124:127], v[224:227], v[220:223], v[124:127]
    s_waitcnt lgkmcnt(10)
    v_mfma_f32_16x16x32_bf16 v[96:99], v[160:163], v[128:131], v[96:99]
    ds_read_b64 v[192:193], v22 offset:448
    v_mfma_f32_32x32x16_bf16 v[48:63], v[68:71], a[0:3], v[48:63]
    ds_read_b64_tr_b16 v[68:69], v4 offset:8192
    ds_read_b64_tr_b16 v[70:71], v4 offset:8704
    buffer_load_dwordx4 a[0:3], v10, s[36:39], s77 offen offset:0 sc1
    v_mfma_f32_16x16x32_bf16 v[100:103], v[164:167], v[128:131], v[100:103]
    ds_read_b64 v[194:195], v22 offset:456
    v_mfma_f32_16x16x32_bf16 v[104:107], v[168:171], v[128:131], v[104:107]
    ds_read_b128 v[224:227], v23 offset:4032
    v_mfma_f32_16x16x32_bf16 v[108:111], v[172:175], v[128:131], v[108:111]
    ds_read_b64 v[196:197], v22 offset:960
    s_waitcnt vmcnt(23) lgkmcnt(15)
    v_mfma_f32_32x32x16_bf16 v[32:47], v[72:75], a[4:7], v[32:47]
    ds_read_b64_tr_b16 v[72:73], v3 offset:10240
    ds_read_b64_tr_b16 v[74:75], v3 offset:10752
    v_mfma_f32_16x16x32_bf16 v[112:115], v[176:179], v[128:131], v[112:115]
    ds_read_b64 v[198:199], v22 offset:968
    v_mfma_f32_16x16x32_bf16 v[116:119], v[180:183], v[128:131], v[116:119]
    ds_read_b128 v[228:231], v23 offset:3520
    v_mfma_f32_32x32x16_bf16 v[48:63], v[76:79], a[4:7], v[48:63]
    ds_read_b64_tr_b16 v[76:77], v4 offset:10240
    ds_read_b64_tr_b16 v[78:79], v4 offset:10752
    buffer_load_dwordx4 a[4:7], v10, s[36:39], s77 offen offset:1024 sc1
    v_mfma_f32_16x16x32_bf16 v[120:123], v[184:187], v[128:131], v[120:123]
    ds_read_b64 v[200:201], v22 offset:1472
    v_mfma_f32_16x16x32_bf16 v[124:127], v[188:191], v[128:131], v[124:127]
    ds_read_b64 v[202:203], v22 offset:1480
    v_mfma_f32_16x16x32_bf16 v[100:103], v[160:163], v[132:135], v[100:103]
    ds_read_b128 v[232:235], v23 offset:3008
    s_waitcnt vmcnt(22) lgkmcnt(15)
    v_mfma_f32_32x32x16_bf16 v[32:47], v[80:83], a[8:11], v[32:47]
    ds_read_b64_tr_b16 v[80:81], v3 offset:12288
    ds_read_b64_tr_b16 v[82:83], v3 offset:12800
    buffer_load_dwordx4 v5, s[56:59], s72 offen offset:3072 sc1 lds
    s_add_u32 s72, s72, s76
    v_mfma_f32_16x16x32_bf16 v[104:107], v[164:167], v[132:135], v[104:107]
    ds_read_b64 v[204:205], v22 offset:1984
    v_mfma_f32_16x16x32_bf16 v[108:111], v[168:171], v[132:135], v[108:111]
    ds_read_b64 v[206:207], v22 offset:1992
    v_mfma_f32_32x32x16_bf16 v[48:63], v[84:87], a[8:11], v[48:63]
    ds_read_b64_tr_b16 v[84:85], v4 offset:12288
    ds_read_b64_tr_b16 v[86:87], v4 offset:12800
    buffer_load_dwordx4 a[8:11], v10, s[36:39], s77 offen offset:2048 sc1
    v_mfma_f32_16x16x32_bf16 v[112:115], v[172:175], v[132:135], v[112:115]
    ds_read_b128 v[236:239], v23 offset:2496
    v_mfma_f32_16x16x32_bf16 v[116:119], v[176:179], v[132:135], v[116:119]
    ds_read_b64 v[208:209], v22 offset:2496
    v_mfma_f32_16x16x32_bf16 v[120:123], v[180:183], v[132:135], v[120:123]
    ds_read_b64 v[210:211], v22 offset:2504
    s_waitcnt vmcnt(23) lgkmcnt(15)
    v_mfma_f32_32x32x16_bf16 v[32:47], v[88:91], a[12:15], v[32:47]
    ds_read_b64_tr_b16 v[88:89], v3 offset:14336
    ds_read_b64_tr_b16 v[90:91], v3 offset:14848
    v_mfma_f32_16x16x32_bf16 v[124:127], v[184:187], v[132:135], v[124:127]
    ds_read_b128 v[240:243], v23 offset:1984
    v_mfma_f32_16x16x32_bf16 v[104:107], v[160:163], v[136:139], v[104:107]
    ds_read_b64 v[212:213], v22 offset:3008
    v_mfma_f32_32x32x16_bf16 v[48:63], v[92:95], a[12:15], v[48:63]
    ds_read_b64_tr_b16 v[92:93], v4 offset:14336
    ds_read_b64_tr_b16 v[94:95], v4 offset:14848
    buffer_load_dwordx4 a[12:15], v10, s[36:39], s77 offen offset:3072 sc1
    s_add_u32 s77, s77, 4096
    v_mfma_f32_16x16x32_bf16 v[108:111], v[164:167], v[136:139], v[108:111]
    ds_read_b64 v[214:215], v22 offset:3016
    v_mfma_f32_16x16x32_bf16 v[112:115], v[168:171], v[136:139], v[112:115]
    ds_read_b128 v[244:247], v23 offset:1472
    v_mfma_f32_16x16x32_bf16 v[116:119], v[172:175], v[136:139], v[116:119]
    ds_read_b64 v[216:217], v22 offset:3520
    s_waitcnt vmcnt(22) lgkmcnt(15)
    v_mfma_f32_32x32x16_bf16 v[32:47], v[64:67], a[16:19], v[32:47]
    s_waitcnt vmcnt(26)
    s_barrier
    ds_read_b64_tr_b16 v[64:65], v8 offset:0
    ds_read_b64_tr_b16 v[66:67], v8 offset:512
    s_add_u32 m0, s74, 49152
    s_nop 0
    buffer_load_dwordx4 v12, s[56:59], s72 offen offset:0 sc1 lds
    v_mfma_f32_16x16x32_bf16 v[120:123], v[176:179], v[136:139], v[120:123]
    ds_read_b64 v[218:219], v22 offset:3528
    v_mfma_f32_16x16x32_bf16 v[124:127], v[180:183], v[136:139], v[124:127]
    ds_read_b128 v[248:251], v23 offset:960
    v_mfma_f32_32x32x16_bf16 v[48:63], v[68:71], a[16:19], v[48:63]
    ds_read_b64_tr_b16 v[68:69], v9 offset:0
    ds_read_b64_tr_b16 v[70:71], v9 offset:512
    buffer_load_dwordx4 a[16:19], v10, s[36:39], s77 offen offset:0 sc1
    v_mfma_f32_16x16x32_bf16 v[108:111], v[160:163], v[140:143], v[108:111]
    ds_read_b64 v[220:221], v22 offset:4032
    v_mfma_f32_16x16x32_bf16 v[112:115], v[164:167], v[140:143], v[112:115]
    ds_read_b64 v[222:223], v22 offset:4040
    v_mfma_f32_16x16x32_bf16 v[116:119], v[168:171], v[140:143], v[116:119]
    ds_read_b128 v[252:255], v23 offset:448
    s_waitcnt vmcnt(23) lgkmcnt(15)
    v_mfma_f32_32x32x16_bf16 v[32:47], v[72:75], a[20:23], v[32:47]
    ds_read_b64_tr_b16 v[72:73], v8 offset:2048
    ds_read_b64_tr_b16 v[74:75], v8 offset:2560
    v_mfma_f32_16x16x32_bf16 v[120:123], v[172:175], v[140:143], v[120:123]
    v_mfma_f32_16x16x32_bf16 v[124:127], v[176:179], v[140:143], v[124:127]
    v_mfma_f32_32x32x16_bf16 v[48:63], v[76:79], a[20:23], v[48:63]
    ds_read_b64_tr_b16 v[76:77], v9 offset:2048
    ds_read_b64_tr_b16 v[78:79], v9 offset:2560
    buffer_load_dwordx4 a[20:23], v10, s[36:39], s77 offen offset:1024 sc1
    v_mfma_f32_16x16x32_bf16 v[112:115], v[160:163], v[144:147], v[112:115]
    v_mfma_f32_16x16x32_bf16 v[116:119], v[164:167], v[144:147], v[116:119]
    v_mfma_f32_16x16x32_bf16 v[120:123], v[168:171], v[144:147], v[120:123]
    s_waitcnt vmcnt(22) lgkmcnt(15)
    v_mfma_f32_32x32x16_bf16 v[32:47], v[80:83], a[24:27], v[32:47]
    ds_read_b64_tr_b16 v[80:81], v8 offset:4096
    ds_read_b64_tr_b16 v[82:83], v8 offset:4608
    buffer_load_dwordx4 v18, s[56:59], s72 offen offset:1024 sc1 lds
    v_mfma_f32_16x16x32_bf16 v[124:127], v[172:175], v[144:147], v[124:127]
    v_mfma_f32_16x16x32_bf16 v[116:119], v[160:163], v[148:151], v[116:119]
    v_mfma_f32_32x32x16_bf16 v[48:63], v[84:87], a[24:27], v[48:63]
    ds_read_b64_tr_b16 v[84:85], v9 offset:4096
    ds_read_b64_tr_b16 v[86:87], v9 offset:4608
    buffer_load_dwordx4 a[24:27], v10, s[36:39], s77 offen offset:2048 sc1
    v_mfma_f32_16x16x32_bf16 v[120:123], v[164:167], v[148:151], v[120:123]
    v_mfma_f32_16x16x32_bf16 v[124:127], v[168:171], v[148:151], v[124:127]
    v_mfma_f32_16x16x32_bf16 v[120:123], v[160:163], v[152:155], v[120:123]
    s_waitcnt vmcnt(23) lgkmcnt(15)
    v_mfma_f32_32x32x16_bf16 v[32:47], v[88:91], a[28:31], v[32:47]
    ds_read_b64_tr_b16 v[88:89], v8 offset:6144
    ds_read_b64_tr_b16 v[90:91], v8 offset:6656
    v_mfma_f32_16x16x32_bf16 v[124:127], v[164:167], v[152:155], v[124:127]
    v_mfma_f32_16x16x32_bf16 v[124:127], v[160:163], v[156:159], v[124:127]
    v_mfma_f32_32x32x16_bf16 v[48:63], v[92:95], a[28:31], v[48:63]
    ds_read_b64_tr_b16 v[92:93], v9 offset:6144
    ds_read_b64_tr_b16 v[94:95], v9 offset:6656
    buffer_load_dwordx4 a[28:31], v10, s[36:39], s77 offen offset:3072 sc1
    s_add_u32 s77, s77, 4096
    s_waitcnt lgkmcnt(12)
    v_mfma_f32_16x16x32_bf16 v[96:99], v[224:227], v[192:195], v[96:99]
    v_mfma_f32_16x16x32_bf16 v[100:103], v[228:231], v[192:195], v[100:103]
    v_mfma_f32_16x16x32_bf16 v[104:107], v[232:235], v[192:195], v[104:107]
    s_waitcnt vmcnt(22) lgkmcnt(15)
    v_mfma_f32_32x32x16_bf16 v[32:47], v[64:67], a[32:35], v[32:47]
    ds_read_b64_tr_b16 v[64:65], v8 offset:8192
    ds_read_b64_tr_b16 v[66:67], v8 offset:8704
    buffer_load_dwordx4 v19, s[56:59], s72 offen offset:2048 sc1 lds
    v_mfma_f32_16x16x32_bf16 v[108:111], v[236:239], v[192:195], v[108:111]
    v_mfma_f32_16x16x32_bf16 v[112:115], v[240:243], v[192:195], v[112:115]
    v_mfma_f32_32x32x16_bf16 v[48:63], v[68:71], a[32:35], v[48:63]
    ds_read_b64_tr_b16 v[68:69], v9 offset:8192
    ds_read_b64_tr_b16 v[70:71], v9 offset:8704
    buffer_load_dwordx4 a[32:35], v10, s[36:39], s77 offen offset:0 sc1
    v_mfma_f32_16x16x32_bf16 v[116:119], v[244:247], v[192:195], v[116:119]
    v_mfma_f32_16x16x32_bf16 v[120:123], v[248:251], v[192:195], v[120:123]
    v_mfma_f32_16x16x32_bf16 v[124:127], v[252:255], v[192:195], v[124:127]
    s_waitcnt vmcnt(23) lgkmcnt(12)
    v_mfma_f32_32x32x16_bf16 v[32:47], v[72:75], a[36:39], v[32:47]
    ds_read_b64_tr_b16 v[72:73], v8 offset:10240
    ds_read_b64_tr_b16 v[74:75], v8 offset:10752
    v_mfma_f32_16x16x32_bf16 v[100:103], v[224:227], v[196:199], v[100:103]
    v_mfma_f32_16x16x32_bf16 v[104:107], v[228:231], v[196:199], v[104:107]
    v_mfma_f32_32x32x16_bf16 v[48:63], v[76:79], a[36:39], v[48:63]
    ds_read_b64_tr_b16 v[76:77], v9 offset:10240
    ds_read_b64_tr_b16 v[78:79], v9 offset:10752
    buffer_load_dwordx4 a[36:39], v10, s[36:39], s77 offen offset:1024 sc1
    v_mfma_f32_16x16x32_bf16 v[108:111], v[232:235], v[196:199], v[108:111]
    v_mfma_f32_16x16x32_bf16 v[112:115], v[236:239], v[196:199], v[112:115]
    s_waitcnt vmcnt(22) lgkmcnt(12)
    v_mfma_f32_32x32x16_bf16 v[32:47], v[80:83], a[40:43], v[32:47]
    ds_read_b64_tr_b16 v[80:81], v8 offset:12288
    ds_read_b64_tr_b16 v[82:83], v8 offset:12800
    buffer_load_dwordx4 v5, s[56:59], s72 offen offset:3072 sc1 lds
    s_add_u32 s72, s72, s76
    v_mfma_f32_16x16x32_bf16 v[116:119], v[240:243], v[196:199], v[116:119]
    v_mfma_f32_16x16x32_bf16 v[120:123], v[244:247], v[196:199], v[120:123]
    v_mfma_f32_32x32x16_bf16 v[48:63], v[84:87], a[40:43], v[48:63]
    ds_read_b64_tr_b16 v[84:85], v9 offset:12288
    ds_read_b64_tr_b16 v[86:87], v9 offset:12800
    buffer_load_dwordx4 a[40:43], v10, s[36:39], s77 offen offset:2048 sc1
    v_mfma_f32_16x16x32_bf16 v[124:127], v[248:251], v[196:199], v[124:127]
    v_mfma_f32_16x16x32_bf16 v[104:107], v[224:227], v[200:203], v[104:107]
    s_waitcnt vmcnt(23) lgkmcnt(12)
    v_mfma_f32_32x32x16_bf16 v[32:47], v[88:91], a[44:47], v[32:47]
    ds_read_b64_tr_b16 v[88:89], v8 offset:14336
    ds_read_b64_tr_b16 v[90:91], v8 offset:14848
    v_mfma_f32_16x16x32_bf16 v[108:111], v[228:231], v[200:203], v[108:111]
    v_mfma_f32_16x16x32_bf16 v[112:115], v[232:235], v[200:203], v[112:115]
    v_mfma_f32_32x32x16_bf16 v[48:63], v[92:95], a[44:47], v[48:63]
    ds_read_b64_tr_b16 v[92:93], v9 offset:14336
    ds_read_b64_tr_b16 v[94:95], v9 offset:14848
    buffer_load_dwordx4 a[44:47], v10, s[36:39], s77 offen offset:3072 sc1
    s_add_u32 s77, s77, 4096
    v_mfma_f32_16x16x32_bf16 v[116:119], v[236:239], v[200:203], v[116:119]
    v_mfma_f32_16x16x32_bf16 v[120:123], v[240:243], v[200:203], v[120:123]
    s_waitcnt vmcnt(22) lgkmcnt(12)
    v_mfma_f32_32x32x16_bf16 v[32:47], v[64:67], a[48:51], v[32:47]
    s_waitcnt vmcnt(26)
    s_barrier
    ds_read_b64_tr_b16 v[64:65], v8 offset:16384
    ds_read_b64_tr_b16 v[66:67], v8 offset:16896
    s_add_u32 m0, s74, 65536
    s_nop 0
    buffer_load_dwordx4 v12, s[56:59], s72 offen offset:0 sc1 lds
    v_mfma_f32_16x16x32_bf16 v[124:127], v[244:247], v[200:203], v[124:127]
    v_mfma_f32_16x16x32_bf16 v[108:111], v[224:227], v[204:207], v[108:111]
    v_mfma_f32_32x32x16_bf16 v[48:63], v[68:71], a[48:51], v[48:63]
    ds_read_b64_tr_b16 v[68:69], v9 offset:16384
    ds_read_b64_tr_b16 v[70:71], v9 offset:16896
    buffer_load_dwordx4 a[48:51], v10, s[36:39], s77 offen offset:0 sc1
    v_mfma_f32_16x16x32_bf16 v[112:115], v[228:231], v[204:207], v[112:115]
    v_mfma_f32_16x16x32_bf16 v[116:119], v[232:235], v[204:207], v[116:119]
    s_waitcnt vmcnt(23) lgkmcnt(12)
    v_mfma_f32_32x32x16_bf16 v[32:47], v[72:75], a[52:55], v[32:47]
    ds_read_b64_tr_b16 v[72:73], v8 offset:18432
    ds_read_b64_tr_b16 v[74:75], v8 offset:18944
    v_mfma_f32_16x16x32_bf16 v[120:123], v[236:239], v[204:207], v[120:123]
    v_mfma_f32_16x16x32_bf16 v[124:127], v[240:243], v[204:207], v[124:127]
    v_mfma_f32_32x32x16_bf16 v[48:63], v[76:79], a[52:55], v[48:63]
    ds_read_b64_tr_b16 v[76:77], v9 offset:18432
    ds_read_b64_tr_b16 v[78:79], v9 offset:18944
    buffer_load_dwordx4 a[52:55], v10, s[36:39], s77 offen offset:1024 sc1
    v_mfma_f32_16x16x32_bf16 v[112:115], v[224:227], v[208:211], v[112:115]
    v_mfma_f32_16x16x32_bf16 v[116:119], v[228:231], v[208:211], v[116:119]
    s_waitcnt vmcnt(22) lgkmcnt(12)
    v_mfma_f32_32x32x16_bf16 v[32:47], v[80:83], a[56:59], v[32:47]
    ds_read_b64_tr_b16 v[80:81], v8 offset:20480
    ds_read_b64_tr_b16 v[82:83], v8 offset:20992
    buffer_load_dwordx4 v18, s[56:59], s72 offen offset:1024 sc1 lds
    v_mfma_f32_16x16x32_bf16 v[120:123], v[232:235], v[208:211], v[120:123]
    v_mfma_f32_16x16x32_bf16 v[124:127], v[236:239], v[208:211], v[124:127]
    v_mfma_f32_32x32x16_bf16 v[48:63], v[84:87], a[56:59], v[48:63]
    ds_read_b64_tr_b16 v[84:85], v9 offset:20480
    ds_read_b64_tr_b16 v[86:87], v9 offset:20992
    buffer_load_dwordx4 a[56:59], v10, s[36:39], s77 offen offset:2048 sc1
    v_mfma_f32_16x16x32_bf16 v[116:119], v[224:227], v[212:215], v[116:119]
    v_mfma_f32_16x16x32_bf16 v[120:123], v[228:231], v[212:215], v[120:123]
    s_waitcnt vmcnt(23) lgkmcnt(12)
    v_mfma_f32_32x32x16_bf16 v[32:47], v[88:91], a[60:63], v[32:47]
    ds_read_b64_tr_b16 v[88:89], v8 offset:22528
    ds_read_b64_tr_b16 v[90:91], v8 offset:23040
    v_mfma_f32_16x16x32_bf16 v[124:127], v[232:235], v[212:215], v[124:127]
    v_mfma_f32_16x16x32_bf16 v[120:123], v[224:227], v[216:219], v[120:123]
    v_mfma_f32_32x32x16_bf16 v[48:63], v[92:95], a[60:63], v[48:63]
    ds_read_b64_tr_b16 v[92:93], v9 offset:22528
    ds_read_b64_tr_b16 v[94:95], v9 offset:23040
    buffer_load_dwordx4 a[60:63], v10, s[36:39], s77 offen offset:3072 sc1
    s_add_u32 s77, s77, 4096
    v_mfma_f32_16x16x32_bf16 v[124:127], v[228:231], v[216:219], v[124:127]
    v_mfma_f32_16x16x32_bf16 v[124:127], v[224:227], v[220:223], v[124:127]
    s_waitcnt vmcnt(22) lgkmcnt(12)
    v_mfma_f32_32x32x16_bf16 v[32:47], v[64:67], a[0:3], v[32:47]
    ds_read_b64_tr_b16 v[64:65], v8 offset:24576
    ds_read_b64_tr_b16 v[66:67], v8 offset:25088
    buffer_load_dwordx4 v19, s[56:59], s72 offen offset:2048 sc1 lds
    v_mfma_f32_32x32x16_bf16 v[48:63], v[68:71], a[0:3], v[48:63]
    ds_read_b64_tr_b16 v[68:69], v9 offset:24576
    ds_read_b64_tr_b16 v[70:71], v9 offset:25088
    buffer_load_dwordx4 a[0:3], v10, s[36:39], s77 offen offset:0 sc1
    v_lshlrev_b32 v24, 7, v17
    v_lshl_add_u32 v24, v16, 2, v24
    s_add_u32 s78, s73, 14044
    v_sub_u32 v23, s78, v24
    v_add_u32 v24, s73, v24
    s_waitcnt vmcnt(23) lgkmcnt(12)
    v_mfma_f32_32x32x16_bf16 v[32:47], v[72:75], a[4:7], v[32:47]
    ds_read_b64_tr_b16 v[72:73], v8 offset:26624
    ds_read_b64_tr_b16 v[74:75], v8 offset:27136
    ds_read_b32 v128, v23 offset:3648
    ds_read_b32 v129, v23 offset:3584
    ds_read_b32 v130, v23 offset:3136
    ds_read_b32 v131, v23 offset:3072
    ds_read_b32 v132, v23 offset:2624
    ds_read_b32 v133, v23 offset:2560
    ds_read_b32 v134, v23 offset:2112
    v_mfma_f32_32x32x16_bf16 v[48:63], v[76:79], a[4:7], v[48:63]
    ds_read_b64_tr_b16 v[76:77], v9 offset:26624
    ds_read_b64_tr_b16 v[78:79], v9 offset:27136
    buffer_load_dwordx4 a[4:7], v10, s[36:39], s77 offen offset:1024 sc1
    ds_read_b32 v135, v23 offset:2048
    ds_read_b32 v136, v23 offset:1600
    ds_read_b32 v137, v23 offset:1536
    ds_read_b32 v138, v23 offset:1088
    ds_read_b32 v139, v23 offset:1024
    s_waitcnt vmcnt(22) lgkmcnt(15)
    v_mfma_f32_32x32x16_bf16 v[32:47], v[80:83], a[8:11], v[32:47]
    ds_read_b64_tr_b16 v[80:81], v8 offset:28672
    ds_read_b64_tr_b16 v[82:83], v8 offset:29184
    buffer_load_dwordx4 v5, s[56:59], s72 offen offset:3072 sc1 lds
    s_add_u32 s72, s72, s76
    v_mfma_f32_32x32x16_bf16 v[48:63], v[84:87], a[8:11], v[48:63]
    ds_read_b64_tr_b16 v[84:85], v9 offset:28672
    ds_read_b64_tr_b16 v[86:87], v9 offset:29184
    buffer_load_dwordx4 a[8:11], v10, s[36:39], s77 offen offset:2048 sc1
    ds_read_b32 v140, v23 offset:576
    ds_read_b32 v141, v23 offset:512
    ds_read_b32 v142, v23 offset:64
    ds_read_b32 v143, v23 offset:0
    s_lshl_b32 s78, s34, 12
    s_add_u32 s78, s78, 24117248
    s_add_u32 s40, s28, s78
    s_addc_u32 s41, s29, 0
    s_waitcnt vmcnt(23) lgkmcnt(15)
    v_mfma_f32_32x32x16_bf16 v[32:47], v[88:91], a[12:15], v[32:47]
    ds_read_b64_tr_b16 v[88:89], v8 offset:30720
    ds_read_b64_tr_b16 v[90:91], v8 offset:31232
    s_mov_b32 s42, 4096
    s_mov_b32 s43, 0x20000
    s_waitcnt lgkmcnt(15)
    v_and_b32 v26, s18, v128
    v_and_b32 v164, s18, v129
    v_lshlrev_b32 v27, 16, v128
    v_lshlrev_b32 v165, 16, v129
    v_mul_f32 v26, v26, v20
    v_mfma_f32_32x32x16_bf16 v[48:63], v[92:95], a[12:15], v[48:63]
    ds_read_b64_tr_b16 v[92:93], v9 offset:30720
    ds_read_b64_tr_b16 v[94:95], v9 offset:31232
    buffer_load_dwordx4 a[12:15], v10, s[36:39], s77 offen offset:3072 sc1
    s_add_u32 s77, s77, 4096
    v_mul_f32 v164, v164, v20
    v_mul_f32 v27, v27, v21
    v_mul_f32 v165, v165, v21
    v_cvt_pk_bf16_f32 v96, v96, v97
    v_cvt_pk_bf16_f32 v98, v98, v99
    v_and_b32 v97, s18, v96
    v_and_b32 v99, s18, v98
    v_lshlrev_b32 v96, 16, v96
    v_lshlrev_b32 v98, 16, v98
    v_cvt_pk_bf16_f32 v26, v26, v27
    v_cvt_pk_bf16_f32 v164, v164, v165
    v_and_b32 v27, s18, v26
    s_waitcnt vmcnt(22) lgkmcnt(15)
    v_mfma_f32_32x32x16_bf16 v[32:47], v[64:67], a[16:19], v[32:47]
    s_waitcnt vmcnt(26)
    s_barrier
    ds_read_b64_tr_b16 v[64:65], v8 offset:32768
    ds_read_b64_tr_b16 v[66:67], v8 offset:33280
    s_add_u32 m0, s74, 0
    s_nop 0
    buffer_load_dwordx4 v12, s[56:59], s72 offen offset:0 sc1 lds
    v_mfma_f32_32x32x16_bf16 v[48:63], v[68:71], a[16:19], v[48:63]
    ds_read_b64_tr_b16 v[68:69], v9 offset:32768
    ds_read_b64_tr_b16 v[70:71], v9 offset:33280
    buffer_load_dwordx4 a[16:19], v10, s[36:39], s77 offen offset:0 sc1
    v_and_b32 v165, s18, v164
    v_lshlrev_b32 v26, 16, v26
    v_lshlrev_b32 v164, 16, v164
    v_add_f32 v26, v26, v96
    v_add_f32 v164, v164, v98
    v_add_f32 v27, v27, v97
    v_add_f32 v165, v165, v99
    v_cvt_pk_bf16_f32 v128, v26, v27
    s_waitcnt vmcnt(23) lgkmcnt(15)
    v_mfma_f32_32x32x16_bf16 v[32:47], v[72:75], a[20:23], v[32:47]
    ds_read_b64_tr_b16 v[72:73], v8 offset:34816
    ds_read_b64_tr_b16 v[74:75], v8 offset:35328
    v_cvt_pk_bf16_f32 v129, v164, v165
    ds_write_b32 v24, v128 offset:0
    ds_write_b32 v24, v129 offset:64
    s_waitcnt lgkmcnt(15)
    v_and_b32 v26, s18, v130
    v_and_b32 v164, s18, v131
    v_lshlrev_b32 v27, 16, v130
    v_lshlrev_b32 v165, 16, v131
    v_mfma_f32_32x32x16_bf16 v[48:63], v[76:79], a[20:23], v[48:63]
    ds_read_b64_tr_b16 v[76:77], v9 offset:34816
    ds_read_b64_tr_b16 v[78:79], v9 offset:35328
    buffer_load_dwordx4 a[20:23], v10, s[36:39], s77 offen offset:1024 sc1
    v_mul_f32 v26, v26, v20
    v_mul_f32 v164, v164, v20
    v_mul_f32 v27, v27, v21
    v_mul_f32 v165, v165, v21
    v_cvt_pk_bf16_f32 v100, v100, v101
    v_cvt_pk_bf16_f32 v102, v102, v103
    v_and_b32 v101, s18, v100
    v_and_b32 v103, s18, v102
    s_waitcnt vmcnt(22) lgkmcnt(15)
    v_mfma_f32_32x32x16_bf16 v[32:47], v[80:83], a[24:27], v[32:47]
    ds_read_b64_tr_b16 v[80:81], v8 offset:36864
    ds_read_b64_tr_b16 v[82:83], v8 offset:37376
    buffer_load_dwordx4 v18, s[56:59], s72 offen offset:1024 sc1 lds
    v_mfma_f32_32x32x16_bf16 v[48:63], v[84:87], a[24:27], v[48:63]
    ds_read_b64_tr_b16 v[84:85], v9 offset:36864
    ds_read_b64_tr_b16 v[86:87], v9 offset:37376
    buffer_load_dwordx4 a[24:27], v10, s[36:39], s77 offen offset:2048 sc1
    v_lshlrev_b32 v100, 16, v100
    v_lshlrev_b32 v102, 16, v102
    v_cvt_pk_bf16_f32 v26, v26, v27
    v_cvt_pk_bf16_f32 v164, v164, v165
    v_and_b32 v27, s18, v26
    v_and_b32 v165, s18, v164
    v_lshlrev_b32 v26, 16, v26
    v_lshlrev_b32 v164, 16, v164
    v_add_f32 v26, v26, v100
    s_waitcnt vmcnt(23) lgkmcnt(14)
    v_mfma_f32_32x32x16_bf16 v[32:47], v[88:91], a[28:31], v[32:47]
    ds_read_b64_tr_b16 v[88:89], v8 offset:38912
    ds_read_b64_tr_b16 v[90:91], v8 offset:39424
    v_add_f32 v164, v164, v102
    v_add_f32 v27, v27, v101
    v_add_f32 v165, v165, v103
    v_cvt_pk_bf16_f32 v130, v26, v27
    v_cvt_pk_bf16_f32 v131, v164, v165
    ds_write_b32 v24, v130 offset:512
    ds_write_b32 v24, v131 offset:576
    v_mfma_f32_32x32x16_bf16 v[48:63], v[92:95], a[28:31], v[48:63]
    ds_read_b64_tr_b16 v[92:93], v9 offset:38912
    ds_read_b64_tr_b16 v[94:95], v9 offset:39424
    buffer_load_dwordx4 a[28:31], v10, s[36:39], s77 offen offset:3072 sc1
    s_add_u32 s77, s77, 4096
    s_waitcnt lgkmcnt(15)
    v_and_b32 v26, s18, v132
    v_and_b32 v164, s18, v133
    v_lshlrev_b32 v27, 16, v132
    v_lshlrev_b32 v165, 16, v133
    v_mul_f32 v26, v26, v20
    v_mul_f32 v164, v164, v20
    v_mul_f32 v27, v27, v21
    v_mul_f32 v165, v165, v21
    s_waitcnt vmcnt(22) lgkmcnt(15)
    v_mfma_f32_32x32x16_bf16 v[32:47], v[64:67], a[32:35], v[32:47]
    ds_read_b64_tr_b16 v[64:65], v8 offset:40960
    ds_read_b64_tr_b16 v[66:67], v8 offset:41472
    buffer_load_dwordx4 v19, s[56:59], s72 offen offset:2048 sc1 lds
    v_mfma_f32_32x32x16_bf16 v[48:63], v[68:71], a[32:35], v[48:63]
    ds_read_b64_tr_b16 v[68:69], v9 offset:40960
    ds_read_b64_tr_b16 v[70:71], v9 offset:41472
    buffer_load_dwordx4 a[32:35], v10, s[36:39], s77 offen offset:0 sc1
    v_cvt_pk_bf16_f32 v104, v104, v105
    v_cvt_pk_bf16_f32 v106, v106, v107
    v_and_b32 v105, s18, v104
    v_and_b32 v107, s18, v106
    v_lshlrev_b32 v104, 16, v104
    v_lshlrev_b32 v106, 16, v106
    v_cvt_pk_bf16_f32 v26, v26, v27
    v_cvt_pk_bf16_f32 v164, v164, v165
    s_waitcnt vmcnt(23) lgkmcnt(14)
    v_mfma_f32_32x32x16_bf16 v[32:47], v[72:75], a[36:39], v[32:47]
    ds_read_b64_tr_b16 v[72:73], v8 offset:43008
    ds_read_b64_tr_b16 v[74:75], v8 offset:43520
    v_and_b32 v27, s18, v26
    v_and_b32 v165, s18, v164
    v_lshlrev_b32 v26, 16, v26
    v_lshlrev_b32 v164, 16, v164
    v_add_f32 v26, v26, v104
    v_add_f32 v164, v164, v106
    v_add_f32 v27, v27, v105
    v_add_f32 v165, v165, v107
    v_cvt_pk_bf16_f32 v132, v26, v27
    v_cvt_pk_bf16_f32 v133, v164, v165
    v_mfma_f32_32x32x16_bf16 v[48:63], v[76:79], a[36:39], v[48:63]
    ds_read_b64_tr_b16 v[76:77], v9 offset:43008
    ds_read_b64_tr_b16 v[78:79], v9 offset:43520
    buffer_load_dwordx4 a[36:39], v10, s[36:39], s77 offen offset:1024 sc1
    ds_write_b32 v24, v132 offset:1024
    ds_write_b32 v24, v133 offset:1088
    s_waitcnt lgkmcnt(15)
    v_and_b32 v26, s18, v134
    v_and_b32 v164, s18, v135
    v_lshlrev_b32 v27, 16, v134
    s_waitcnt vmcnt(22) lgkmcnt(15)
    v_mfma_f32_32x32x16_bf16 v[32:47], v[80:83], a[40:43], v[32:47]
    ds_read_b64_tr_b16 v[80:81], v8 offset:45056
    ds_read_b64_tr_b16 v[82:83], v8 offset:45568
    buffer_load_dwordx4 v5, s[56:59], s72 offen offset:3072 sc1 lds
    s_add_u32 s72, s72, s76
    v_mfma_f32_32x32x16_bf16 v[48:63], v[84:87], a[40:43], v[48:63]
    ds_read_b64_tr_b16 v[84:85], v9 offset:45056
    ds_read_b64_tr_b16 v[86:87], v9 offset:45568
    buffer_load_dwordx4 a[40:43], v10, s[36:39], s77 offen offset:2048 sc1
    v_lshlrev_b32 v165, 16, v135
    v_mul_f32 v26, v26, v20
    v_mul_f32 v164, v164, v20
    v_mul_f32 v27, v27, v21
    v_mul_f32 v165, v165, v21
    v_cvt_pk_bf16_f32 v108, v108, v109
    v_cvt_pk_bf16_f32 v110, v110, v111
    v_and_b32 v109, s18, v108
    v_and_b32 v111, s18, v110
    s_waitcnt vmcnt(23) lgkmcnt(14)
    v_mfma_f32_32x32x16_bf16 v[32:47], v[88:91], a[44:47], v[32:47]
    ds_read_b64_tr_b16 v[88:89], v8 offset:47104
    ds_read_b64_tr_b16 v[90:91], v8 offset:47616
    v_lshlrev_b32 v108, 16, v108
    v_lshlrev_b32 v110, 16, v110
    v_cvt_pk_bf16_f32 v26, v26, v27
    v_cvt_pk_bf16_f32 v164, v164, v165
    v_and_b32 v27, s18, v26
    v_and_b32 v165, s18, v164
    v_lshlrev_b32 v26, 16, v26
    v_lshlrev_b32 v164, 16, v164
    v_add_f32 v26, v26, v108
    v_mfma_f32_32x32x16_bf16 v[48:63], v[92:95], a[44:47], v[48:63]
    ds_read_b64_tr_b16 v[92:93], v9 offset:47104
    ds_read_b64_tr_b16 v[94:95], v9 offset:47616
    buffer_load_dwordx4 a[44:47], v10, s[36:39], s77 offen offset:3072 sc1
    s_add_u32 s77, s77, 4096
    v_add_f32 v164, v164, v110
    v_add_f32 v27, v27, v109
    v_add_f32 v165, v165, v111
    v_cvt_pk_bf16_f32 v134, v26, v27
    v_cvt_pk_bf16_f32 v135, v164, v165
    ds_write_b32 v24, v134 offset:1536
    ds_write_b32 v24, v135 offset:1600
    s_waitcnt lgkmcnt(15)
    v_and_b32 v26, s18, v136
    v_and_b32 v164, s18, v137
    s_waitcnt vmcnt(22) lgkmcnt(15)
    v_mfma_f32_32x32x16_bf16 v[32:47], v[64:67], a[48:51], v[32:47]
    s_waitcnt vmcnt(26)
    s_barrier
    ds_read_b64_tr_b16 v[64:65], v8 offset:49152
    ds_read_b64_tr_b16 v[66:67], v8 offset:49664
    s_add_u32 m0, s74, 16384
    s_nop 0
    buffer_load_dwordx4 v12, s[56:59], s72 offen offset:0 sc1 lds
    v_mfma_f32_32x32x16_bf16 v[48:63], v[68:71], a[48:51], v[48:63]
    ds_read_b64_tr_b16 v[68:69], v9 offset:49152
    ds_read_b64_tr_b16 v[70:71], v9 offset:49664
    buffer_load_dwordx4 a[48:51], v10, s[36:39], s77 offen offset:0 sc1
    v_lshlrev_b32 v27, 16, v136
    v_lshlrev_b32 v165, 16, v137
    v_mul_f32 v26, v26, v20
    v_mul_f32 v164, v164, v20
    v_mul_f32 v27, v27, v21
    v_mul_f32 v165, v165, v21
    v_cvt_pk_bf16_f32 v112, v112, v113
    v_cvt_pk_bf16_f32 v114, v114, v115
    s_waitcnt vmcnt(23) lgkmcnt(15)
    v_mfma_f32_32x32x16_bf16 v[32:47], v[72:75], a[52:55], v[32:47]
    ds_read_b64_tr_b16 v[72:73], v8 offset:51200
    ds_read_b64_tr_b16 v[74:75], v8 offset:51712
    v_and_b32 v113, s18, v112
    v_and_b32 v115, s18, v114
    v_lshlrev_b32 v112, 16, v112
    v_lshlrev_b32 v114, 16, v114
    v_cvt_pk_bf16_f32 v26, v26, v27
    v_cvt_pk_bf16_f32 v164, v164, v165
    v_and_b32 v27, s18, v26
    v_and_b32 v165, s18, v164
    v_lshlrev_b32 v26, 16, v26
    v_lshlrev_b32 v164, 16, v164
    v_mfma_f32_32x32x16_bf16 v[48:63], v[76:79], a[52:55], v[48:63]
    ds_read_b64_tr_b16 v[76:77], v9 offset:51200
    ds_read_b64_tr_b16 v[78:79], v9 offset:51712
    buffer_load_dwordx4 a[52:55], v10, s[36:39], s77 offen offset:1024 sc1
    v_add_f32 v26, v26, v112
    v_add_f32 v164, v164, v114
    v_add_f32 v27, v27, v113
    v_add_f32 v165, v165, v115
    v_cvt_pk_bf16_f32 v136, v26, v27
    v_cvt_pk_bf16_f32 v137, v164, v165
    ds_write_b32 v24, v136 offset:2048
    s_waitcnt vmcnt(22) lgkmcnt(15)
    v_mfma_f32_32x32x16_bf16 v[32:47], v[80:83], a[56:59], v[32:47]
    ds_read_b64_tr_b16 v[80:81], v8 offset:53248
    ds_read_b64_tr_b16 v[82:83], v8 offset:53760
    buffer_load_dwordx4 v18, s[56:59], s72 offen offset:1024 sc1 lds
    v_mfma_f32_32x32x16_bf16 v[48:63], v[84:87], a[56:59], v[48:63]
    ds_read_b64_tr_b16 v[84:85], v9 offset:53248
    ds_read_b64_tr_b16 v[86:87], v9 offset:53760
    buffer_load_dwordx4 a[56:59], v10, s[36:39], s77 offen offset:2048 sc1
    ds_write_b32 v24, v137 offset:2112
    s_waitcnt lgkmcnt(15)
    v_and_b32 v26, s18, v138
    v_and_b32 v164, s18, v139
    v_lshlrev_b32 v27, 16, v138
    v_lshlrev_b32 v165, 16, v139
    v_mul_f32 v26, v26, v20
    v_mul_f32 v164, v164, v20
    s_waitcnt vmcnt(23) lgkmcnt(15)
    v_mfma_f32_32x32x16_bf16 v[32:47], v[88:91], a[60:63], v[32:47]
    ds_read_b64_tr_b16 v[88:89], v8 offset:55296
    ds_read_b64_tr_b16 v[90:91], v8 offset:55808
    v_mul_f32 v27, v27, v21
    v_mul_f32 v165, v165, v21
    v_cvt_pk_bf16_f32 v116, v116, v117
    v_cvt_pk_bf16_f32 v118, v118, v119
    v_and_b32 v117, s18, v116
    v_and_b32 v119, s18, v118
    v_lshlrev_b32 v116, 16, v116
    v_lshlrev_b32 v118, 16, v118
    v_cvt_pk_bf16_f32 v26, v26, v27
    v_mfma_f32_32x32x16_bf16 v[48:63], v[92:95], a[60:63], v[48:63]
    ds_read_b64_tr_b16 v[92:93], v9 offset:55296
    ds_read_b64_tr_b16 v[94:95], v9 offset:55808
    buffer_load_dwordx4 a[60:63], v10, s[36:39], s77 offen offset:3072 sc1
    s_add_u32 s77, s77, 4096
    v_cvt_pk_bf16_f32 v164, v164, v165
    v_and_b32 v27, s18, v26
    v_and_b32 v165, s18, v164
    v_lshlrev_b32 v26, 16, v26
    v_lshlrev_b32 v164, 16, v164
    v_add_f32 v26, v26, v116
    v_add_f32 v164, v164, v118
    v_add_f32 v27, v27, v117
    v_add_f32 v165, v165, v119
    s_waitcnt vmcnt(22) lgkmcnt(14)
    v_mfma_f32_32x32x16_bf16 v[32:47], v[64:67], a[0:3], v[32:47]
    ds_read_b64_tr_b16 v[64:65], v8 offset:57344
    ds_read_b64_tr_b16 v[66:67], v8 offset:57856
    buffer_load_dwordx4 v19, s[56:59], s72 offen offset:2048 sc1 lds
    v_mfma_f32_32x32x16_bf16 v[48:63], v[68:71], a[0:3], v[48:63]
    ds_read_b64_tr_b16 v[68:69], v9 offset:57344
    ds_read_b64_tr_b16 v[70:71], v9 offset:57856
    buffer_load_dwordx4 a[0:3], v10, s[36:39], s77 offen offset:0 sc1
    v_cvt_pk_bf16_f32 v138, v26, v27
    v_cvt_pk_bf16_f32 v139, v164, v165
    ds_write_b32 v24, v138 offset:2560
    ds_write_b32 v24, v139 offset:2624
    s_waitcnt lgkmcnt(15)
    v_and_b32 v26, s18, v140
    s_waitcnt vmcnt(23) lgkmcnt(15)
    v_mfma_f32_32x32x16_bf16 v[32:47], v[72:75], a[4:7], v[32:47]
    ds_read_b64_tr_b16 v[72:73], v8 offset:59392
    ds_read_b64_tr_b16 v[74:75], v8 offset:59904
    v_and_b32 v164, s18, v141
    v_lshlrev_b32 v27, 16, v140
    v_lshlrev_b32 v165, 16, v141
    v_mul_f32 v26, v26, v20
    v_mul_f32 v164, v164, v20
    v_mul_f32 v27, v27, v21
    v_mul_f32 v165, v165, v21
    v_cvt_pk_bf16_f32 v120, v120, v121
    v_cvt_pk_bf16_f32 v122, v122, v123
    v_and_b32 v121, s18, v120
    v_mfma_f32_32x32x16_bf16 v[48:63], v[76:79], a[4:7], v[48:63]
    ds_read_b64_tr_b16 v[76:77], v9 offset:59392
    ds_read_b64_tr_b16 v[78:79], v9 offset:59904
    buffer_load_dwordx4 a[4:7], v10, s[36:39], s77 offen offset:1024 sc1
    v_and_b32 v123, s18, v122
    v_lshlrev_b32 v120, 16, v120
    v_lshlrev_b32 v122, 16, v122
    v_cvt_pk_bf16_f32 v26, v26, v27
    v_cvt_pk_bf16_f32 v164, v164, v165
    v_and_b32 v27, s18, v26
    v_and_b32 v165, s18, v164
    v_lshlrev_b32 v26, 16, v26
    s_waitcnt vmcnt(22) lgkmcnt(15)
    v_mfma_f32_32x32x16_bf16 v[32:47], v[80:83], a[8:11], v[32:47]
    ds_read_b64_tr_b16 v[80:81], v8 offset:61440
    ds_read_b64_tr_b16 v[82:83], v8 offset:61952
    buffer_load_dwordx4 v5, s[56:59], s72 offen offset:3072 sc1 lds
    s_add_u32 s72, s72, s76
    v_mfma_f32_32x32x16_bf16 v[48:63], v[84:87], a[8:11], v[48:63]
    ds_read_b64_tr_b16 v[84:85], v9 offset:61440
    ds_read_b64_tr_b16 v[86:87], v9 offset:61952
    buffer_load_dwordx4 a[8:11], v10, s[36:39], s77 offen offset:2048 sc1
    v_lshlrev_b32 v164, 16, v164
    v_add_f32 v26, v26, v120
    v_add_f32 v164, v164, v122
    v_add_f32 v27, v27, v121
    v_add_f32 v165, v165, v123
    v_cvt_pk_bf16_f32 v140, v26, v27
    v_cvt_pk_bf16_f32 v141, v164, v165
    ds_write_b32 v24, v140 offset:3072
    s_waitcnt vmcnt(23) lgkmcnt(15)
    v_mfma_f32_32x32x16_bf16 v[32:47], v[88:91], a[12:15], v[32:47]
    ds_read_b64_tr_b16 v[88:89], v8 offset:63488
    ds_read_b64_tr_b16 v[90:91], v8 offset:64000
    ds_write_b32 v24, v141 offset:3136
    s_waitcnt lgkmcnt(15)
    v_and_b32 v26, s18, v142
    v_and_b32 v164, s18, v143
    v_lshlrev_b32 v27, 16, v142
    v_lshlrev_b32 v165, 16, v143
    v_mul_f32 v26, v26, v20
    v_mul_f32 v164, v164, v20
    v_mfma_f32_32x32x16_bf16 v[48:63], v[92:95], a[12:15], v[48:63]
    ds_read_b64_tr_b16 v[92:93], v9 offset:63488
    ds_read_b64_tr_b16 v[94:95], v9 offset:64000
    buffer_load_dwordx4 a[12:15], v10, s[36:39], s77 offen offset:3072 sc1
    s_add_u32 s77, s77, 4096
    v_mul_f32 v27, v27, v21
    v_mul_f32 v165, v165, v21
    v_cvt_pk_bf16_f32 v124, v124, v125
    v_cvt_pk_bf16_f32 v126, v126, v127
    v_and_b32 v125, s18, v124
    v_and_b32 v127, s18, v126
    v_lshlrev_b32 v124, 16, v124
    v_lshlrev_b32 v126, 16, v126
    v_cvt_pk_bf16_f32 v26, v26, v27
    v_cvt_pk_bf16_f32 v164, v164, v165
    v_and_b32 v27, s18, v26
    v_and_b32 v165, s18, v164
    s_waitcnt vmcnt(22) lgkmcnt(15)
    v_mfma_f32_32x32x16_bf16 v[32:47], v[64:67], a[16:19], v[32:47]
    s_waitcnt vmcnt(26)
    s_barrier
    ds_read_b64_tr_b16 v[64:65], v3 offset:0
    ds_read_b64_tr_b16 v[66:67], v3 offset:512
    s_add_u32 m0, s74, 32768
    s_nop 0
    buffer_load_dwordx4 v12, s[56:59], s72 offen offset:0 sc1 lds
    v_mfma_f32_32x32x16_bf16 v[48:63], v[68:71], a[16:19], v[48:63]
    ds_read_b64_tr_b16 v[68:69], v4 offset:0
    ds_read_b64_tr_b16 v[70:71], v4 offset:512
    buffer_load_dwordx4 a[16:19], v10, s[36:39], s77 offen offset:0 sc1
    v_lshlrev_b32 v26, 16, v26
    v_lshlrev_b32 v164, 16, v164
    v_add_f32 v26, v26, v124
    v_add_f32 v164, v164, v126
    v_add_f32 v27, v27, v125
    v_add_f32 v165, v165, v127
    v_cvt_pk_bf16_f32 v142, v26, v27
    v_cvt_pk_bf16_f32 v143, v164, v165
    s_waitcnt vmcnt(23) lgkmcnt(14)
    v_mfma_f32_32x32x16_bf16 v[32:47], v[72:75], a[20:23], v[32:47]
    ds_read_b64_tr_b16 v[72:73], v3 offset:2048
    ds_read_b64_tr_b16 v[74:75], v3 offset:2560
    ds_write_b32 v24, v142 offset:3584
    ds_write_b32 v24, v143 offset:3648
    ds_read_b128 v[144:147], v25 offset:0
    ds_read_b128 v[148:151], v25 offset:1024
    ds_read_b128 v[152:155], v25 offset:2048
    v_mfma_f32_32x32x16_bf16 v[48:63], v[76:79], a[20:23], v[48:63]
    ds_read_b64_tr_b16 v[76:77], v4 offset:2048
    ds_read_b64_tr_b16 v[78:79], v4 offset:2560
    buffer_load_dwordx4 a[20:23], v10, s[36:39], s77 offen offset:1024 sc1
    ds_read_b128 v[156:159], v25 offset:3072
    s_waitcnt vmcnt(22) lgkmcnt(15)
    v_mfma_f32_32x32x16_bf16 v[32:47], v[80:83], a[24:27], v[32:47]
    ds_read_b64_tr_b16 v[80:81], v3 offset:4096
    ds_read_b64_tr_b16 v[82:83], v3 offset:4608
    buffer_load_dwordx4 v18, s[56:59], s72 offen offset:1024 sc1 lds
    v_mfma_f32_32x32x16_bf16 v[48:63], v[84:87], a[24:27], v[48:63]
    ds_read_b64_tr_b16 v[84:85], v4 offset:4096
    ds_read_b64_tr_b16 v[86:87], v4 offset:4608
    buffer_load_dwordx4 a[24:27], v10, s[36:39], s77 offen offset:2048 sc1
    s_waitcnt lgkmcnt(9)
    buffer_store_dwordx4 v[144:147], v10, s[40:43], 0 offen offset:0 sc1
    s_waitcnt lgkmcnt(8)
    buffer_store_dwordx4 v[148:151], v10, s[40:43], 0 offen offset:1024 sc1
    s_waitcnt vmcnt(25) lgkmcnt(15)
    v_mfma_f32_32x32x16_bf16 v[32:47], v[88:91], a[28:31], v[32:47]
    ds_read_b64_tr_b16 v[88:89], v3 offset:6144
    ds_read_b64_tr_b16 v[90:91], v3 offset:6656
    s_waitcnt lgkmcnt(9)
    buffer_store_dwordx4 v[152:155], v10, s[40:43], 0 offen offset:2048 sc1
    v_mfma_f32_32x32x16_bf16 v[48:63], v[92:95], a[28:31], v[48:63]
    ds_read_b64_tr_b16 v[92:93], v4 offset:6144
    ds_read_b64_tr_b16 v[94:95], v4 offset:6656
    buffer_load_dwordx4 a[28:31], v10, s[36:39], s77 offen offset:3072 sc1
    s_add_u32 s77, s77, 4096
    s_waitcnt lgkmcnt(8)
    buffer_store_dwordx4 v[156:159], v10, s[40:43], 0 offen offset:3072 sc1
    s_waitcnt vmcnt(26) lgkmcnt(15)
    v_mfma_f32_32x32x16_bf16 v[32:47], v[64:67], a[32:35], v[32:47]
    ds_read_b64_tr_b16 v[64:65], v3 offset:8192
    ds_read_b64_tr_b16 v[66:67], v3 offset:8704
    buffer_load_dwordx4 v19, s[56:59], s72 offen offset:2048 sc1 lds
    v_mfma_f32_32x32x16_bf16 v[48:63], v[68:71], a[32:35], v[48:63]
    ds_read_b64_tr_b16 v[68:69], v4 offset:8192
    ds_read_b64_tr_b16 v[70:71], v4 offset:8704
    buffer_load_dwordx4 a[32:35], v10, s[36:39], s77 offen offset:0 sc1
    s_lshl_b32 s79, s33, 7
    s_add_u32 s79, s79, 6144
    s_add_u32 s40, s28, 24117248
    s_addc_u32 s41, s29, 0
    s_waitcnt vmcnt(27) lgkmcnt(13)
    v_mfma_f32_32x32x16_bf16 v[32:47], v[72:75], a[36:39], v[32:47]
    ds_read_b64_tr_b16 v[72:73], v3 offset:10240
    ds_read_b64_tr_b16 v[74:75], v3 offset:10752
    s_mov_b32 s42, 4194304
    s_mov_b32 s43, 0x20000
    v_lshlrev_b32 v20, 12, v17
    v_lshl_add_u32 v20, v16, 4, v20
    s_lshl_b32 s78, s33, 6
    s_lshl_b32 s75, s3, 4
    v_mfma_f32_32x32x16_bf16 v[48:63], v[76:79], a[36:39], v[48:63]
    ds_read_b64_tr_b16 v[76:77], v4 offset:10240
    ds_read_b64_tr_b16 v[78:79], v4 offset:10752
    buffer_load_dwordx4 a[36:39], v10, s[36:39], s77 offen offset:1024 sc1
    s_add_u32 s78, s78, s75
    s_lshl_b32 s70, s78, 12
    s_lshl_b32 s75, s32, 8
    s_add_u32 s70, s70, s75
    s_add_u32 s78, s74, 81920
    s_waitcnt vmcnt(26) lgkmcnt(12)
    v_mfma_f32_32x32x16_bf16 v[32:47], v[80:83], a[40:43], v[32:47]
    ds_read_b64_tr_b16 v[80:81], v3 offset:12288
    ds_read_b64_tr_b16 v[82:83], v3 offset:12800
    buffer_load_dwordx4 v5, s[56:59], s72 offen offset:3072 sc1 lds
    s_add_u32 s72, s72, s76
    v_mfma_f32_32x32x16_bf16 v[48:63], v[84:87], a[40:43], v[48:63]
    ds_read_b64_tr_b16 v[84:85], v4 offset:12288
    ds_read_b64_tr_b16 v[86:87], v4 offset:12800
    buffer_load_dwordx4 a[40:43], v10, s[36:39], s77 offen offset:2048 sc1
    v_add_u32 v21, s78, v10
    v_lshrrev_b32 v22, 5, v1
    v_lshlrev_b32 v22, 2, v22
    v_bfe_u32 v23, v1, 2, 2
    v_add_u32 v22, v22, v23
    s_waitcnt vmcnt(27) lgkmcnt(12)
    v_mfma_f32_32x32x16_bf16 v[32:47], v[88:91], a[44:47], v[32:47]
    ds_read_b64_tr_b16 v[88:89], v3 offset:14336
    ds_read_b64_tr_b16 v[90:91], v3 offset:14848
    v_lshlrev_b32 v22, 8, v22
    v_bfe_u32 v23, v1, 4, 1
    v_lshl_add_u32 v22, v23, 5, v22
    v_and_b32 v23, 3, v1
    v_lshl_add_u32 v22, v23, 3, v22
    s_lshl_b32 s78, s3, 6
    v_mfma_f32_32x32x16_bf16 v[48:63], v[92:95], a[44:47], v[48:63]
    ds_read_b64_tr_b16 v[92:93], v4 offset:14336
    ds_read_b64_tr_b16 v[94:95], v4 offset:14848
    buffer_load_dwordx4 a[44:47], v10, s[36:39], s77 offen offset:3072 sc1
    s_add_u32 s77, s77, 4096
    s_add_u32 s78, s78, 81920
    v_add_u32 v22, s78, v22
    v_accvgpr_read_b32 v160, a238
    v_accvgpr_read_b32 v161, a238
    v_accvgpr_read_b32 v162, a239
    v_accvgpr_read_b32 v163, a239
    v_accvgpr_read_b32 v26, a220
    v_accvgpr_read_b32 v27, a221
    s_waitcnt vmcnt(26) lgkmcnt(12)
    v_mfma_f32_32x32x16_bf16 v[32:47], v[64:67], a[48:51], v[32:47]
    s_waitcnt vmcnt(30)
    s_barrier
    ds_read_b64_tr_b16 v[64:65], v8 offset:0
    ds_read_b64_tr_b16 v[66:67], v8 offset:512
    s_add_u32 m0, s74, 49152
    s_nop 0
    buffer_load_dwordx4 v12, s[56:59], s72 offen offset:0 sc1 lds
    v_mfma_f32_32x32x16_bf16 v[48:63], v[68:71], a[48:51], v[48:63]
    ds_read_b64_tr_b16 v[68:69], v9 offset:0
    ds_read_b64_tr_b16 v[70:71], v9 offset:512
    buffer_load_dwordx4 a[48:51], v10, s[36:39], s77 offen offset:0 sc1
    v_lshlrev_b32 v192, 16, v26
    v_lshlrev_b32 v194, 16, v27
    v_and_b32 v193, s18, v26
    v_and_b32 v195, s18, v27
    v_sub_f32 v224, v192, v160
    s_waitcnt vmcnt(27) lgkmcnt(12)
    v_mfma_f32_32x32x16_bf16 v[32:47], v[72:75], a[52:55], v[32:47]
    ds_read_b64_tr_b16 v[72:73], v8 offset:2048
    ds_read_b64_tr_b16 v[74:75], v8 offset:2560
    v_sub_f32 v226, v194, v160
    v_sub_f32 v225, v193, v161
    v_sub_f32 v227, v195, v161
    v_cvt_pk_bf16_f32 v224, v224, v225
    v_cvt_pk_bf16_f32 v226, v226, v227
    v_and_b32 v225, s18, v224
    v_mfma_f32_32x32x16_bf16 v[48:63], v[76:79], a[52:55], v[48:63]
    ds_read_b64_tr_b16 v[76:77], v9 offset:2048
    ds_read_b64_tr_b16 v[78:79], v9 offset:2560
    buffer_load_dwordx4 a[52:55], v10, s[36:39], s77 offen offset:1024 sc1
    v_and_b32 v227, s18, v226
    v_lshlrev_b32 v224, 16, v224
    v_lshlrev_b32 v226, 16, v226
    v_mul_f32 v224, v224, v162
    v_mul_f32 v226, v226, v162
    s_waitcnt vmcnt(26) lgkmcnt(12)
    v_mfma_f32_32x32x16_bf16 v[32:47], v[80:83], a[56:59], v[32:47]
    ds_read_b64_tr_b16 v[80:81], v8 offset:4096
    ds_read_b64_tr_b16 v[82:83], v8 offset:4608
    buffer_load_dwordx4 v18, s[56:59], s72 offen offset:1024 sc1 lds
    v_mfma_f32_32x32x16_bf16 v[48:63], v[84:87], a[56:59], v[48:63]
    ds_read_b64_tr_b16 v[84:85], v9 offset:4096
    ds_read_b64_tr_b16 v[86:87], v9 offset:4608
    buffer_load_dwordx4 a[56:59], v10, s[36:39], s77 offen offset:2048 sc1
    v_mul_f32 v225, v225, v163
    v_mul_f32 v227, v227, v163
    v_cvt_pk_bf16_f32 v224, v224, v225
    v_cvt_pk_bf16_f32 v226, v226, v227
    v_and_b32 v225, s18, v224
    s_waitcnt vmcnt(27) lgkmcnt(12)
    v_mfma_f32_32x32x16_bf16 v[32:47], v[88:91], a[60:63], v[32:47]
    ds_read_b64_tr_b16 v[88:89], v8 offset:6144
    ds_read_b64_tr_b16 v[90:91], v8 offset:6656
    v_and_b32 v227, s18, v226
    v_lshlrev_b32 v224, 16, v224
    v_lshlrev_b32 v226, 16, v226
    v_accvgpr_read_b32 v26, a222
    v_accvgpr_read_b32 v27, a223
    v_lshlrev_b32 v196, 16, v26
    v_mfma_f32_32x32x16_bf16 v[48:63], v[92:95], a[60:63], v[48:63]
    ds_read_b64_tr_b16 v[92:93], v9 offset:6144
    ds_read_b64_tr_b16 v[94:95], v9 offset:6656
    buffer_load_dwordx4 a[60:63], v10, s[36:39], s77 offen offset:3072 sc1
    s_add_u32 s77, s77, 4096
    v_lshlrev_b32 v198, 16, v27
    v_and_b32 v197, s18, v26
    v_and_b32 v199, s18, v27
    v_sub_f32 v228, v196, v160
    v_sub_f32 v230, v198, v160
    s_waitcnt vmcnt(26) lgkmcnt(12)
    v_mfma_f32_32x32x16_bf16 v[32:47], v[64:67], a[0:3], v[32:47]
    ds_read_b64_tr_b16 v[64:65], v8 offset:8192
    ds_read_b64_tr_b16 v[66:67], v8 offset:8704
    buffer_load_dwordx4 v19, s[56:59], s72 offen offset:2048 sc1 lds
    v_mfma_f32_32x32x16_bf16 v[48:63], v[68:71], a[0:3], v[48:63]
    ds_read_b64_tr_b16 v[68:69], v9 offset:8192
    ds_read_b64_tr_b16 v[70:71], v9 offset:8704
    buffer_load_dwordx4 a[0:3], v10, s[36:39], s77 offen offset:0 sc1
    v_sub_f32 v229, v197, v161
    v_sub_f32 v231, v199, v161
    v_cvt_pk_bf16_f32 v228, v228, v229
    v_cvt_pk_bf16_f32 v230, v230, v231
    v_and_b32 v229, s18, v228
    s_waitcnt vmcnt(27) lgkmcnt(12)
    v_mfma_f32_32x32x16_bf16 v[32:47], v[72:75], a[4:7], v[32:47]
    ds_read_b64_tr_b16 v[72:73], v8 offset:10240
    ds_read_b64_tr_b16 v[74:75], v8 offset:10752
    v_and_b32 v231, s18, v230
    v_lshlrev_b32 v228, 16, v228
    v_lshlrev_b32 v230, 16, v230
    v_mul_f32 v228, v228, v162
    v_mul_f32 v230, v230, v162
    v_mul_f32 v229, v229, v163
    v_mfma_f32_32x32x16_bf16 v[48:63], v[76:79], a[4:7], v[48:63]
    ds_read_b64_tr_b16 v[76:77], v9 offset:10240
    ds_read_b64_tr_b16 v[78:79], v9 offset:10752
    buffer_load_dwordx4 a[4:7], v10, s[36:39], s77 offen offset:1024 sc1
    v_mul_f32 v231, v231, v163
    v_cvt_pk_bf16_f32 v228, v228, v229
    v_cvt_pk_bf16_f32 v230, v230, v231
    v_and_b32 v229, s18, v228
    v_and_b32 v231, s18, v230
    s_waitcnt vmcnt(26) lgkmcnt(12)
    v_mfma_f32_32x32x16_bf16 v[32:47], v[80:83], a[8:11], v[32:47]
    ds_read_b64_tr_b16 v[80:81], v8 offset:12288
    ds_read_b64_tr_b16 v[82:83], v8 offset:12800
    buffer_load_dwordx4 v5, s[56:59], s72 offen offset:3072 sc1 lds
    s_add_u32 s72, s72, s76
    v_mfma_f32_32x32x16_bf16 v[48:63], v[84:87], a[8:11], v[48:63]
    ds_read_b64_tr_b16 v[84:85], v9 offset:12288
    ds_read_b64_tr_b16 v[86:87], v9 offset:12800
    buffer_load_dwordx4 a[8:11], v10, s[36:39], s77 offen offset:2048 sc1
    v_lshlrev_b32 v228, 16, v228
    v_lshlrev_b32 v230, 16, v230
    v_accvgpr_read_b32 v26, a224
    v_accvgpr_read_b32 v27, a225
    v_lshlrev_b32 v200, 16, v26
    s_waitcnt vmcnt(27) lgkmcnt(12)
    v_mfma_f32_32x32x16_bf16 v[32:47], v[88:91], a[12:15], v[32:47]
    ds_read_b64_tr_b16 v[88:89], v8 offset:14336
    ds_read_b64_tr_b16 v[90:91], v8 offset:14848
    v_lshlrev_b32 v202, 16, v27
    v_and_b32 v201, s18, v26
    v_and_b32 v203, s18, v27
    v_sub_f32 v232, v200, v160
    v_sub_f32 v234, v202, v160
    v_sub_f32 v233, v201, v161
    v_mfma_f32_32x32x16_bf16 v[48:63], v[92:95], a[12:15], v[48:63]
    ds_read_b64_tr_b16 v[92:93], v9 offset:14336
    ds_read_b64_tr_b16 v[94:95], v9 offset:14848
    buffer_load_dwordx4 a[12:15], v10, s[36:39], s77 offen offset:3072 sc1
    s_add_u32 s77, s77, 4096
    v_sub_f32 v235, v203, v161
    v_cvt_pk_bf16_f32 v232, v232, v233
    v_cvt_pk_bf16_f32 v234, v234, v235
    v_and_b32 v233, s18, v232
    v_and_b32 v235, s18, v234
    v_lshlrev_b32 v232, 16, v232
    v_lshlrev_b32 v234, 16, v234
    v_mul_f32 v232, v232, v162
    s_waitcnt vmcnt(26) lgkmcnt(12)
    v_mfma_f32_32x32x16_bf16 v[32:47], v[64:67], a[16:19], v[32:47]
    s_waitcnt vmcnt(18)
    s_barrier
    ds_read_b64_tr_b16 v[64:65], v8 offset:16384
    ds_read_b64_tr_b16 v[66:67], v8 offset:16896
    s_add_u32 m0, s74, 65536
    s_nop 0
    buffer_load_dwordx4 v12, s[56:59], s72 offen offset:0 sc1 lds
    v_mfma_f32_32x32x16_bf16 v[48:63], v[68:71], a[16:19], v[48:63]
    ds_read_b64_tr_b16 v[68:69], v9 offset:16384
    ds_read_b64_tr_b16 v[70:71], v9 offset:16896
    buffer_load_dwordx4 a[16:19], v10, s[36:39], s77 offen offset:0 sc1
    v_mul_f32 v234, v234, v162
    v_mul_f32 v233, v233, v163
    v_mul_f32 v235, v235, v163
    v_cvt_pk_bf16_f32 v232, v232, v233
    v_cvt_pk_bf16_f32 v234, v234, v235
    s_waitcnt vmcnt(27) lgkmcnt(12)
    v_mfma_f32_32x32x16_bf16 v[32:47], v[72:75], a[20:23], v[32:47]
    ds_read_b64_tr_b16 v[72:73], v8 offset:18432
    ds_read_b64_tr_b16 v[74:75], v8 offset:18944
    s_lshl_b32 s67, s2, 3
    s_add_u32 s67, s67, 6144
    s_cmp_lg_u32 s3, 0
    s_cbranch_scc1 nosig_16
    s_mov_b64 exec, 1
    v_mov_b32 v28, s64
    v_mov_b32 v29, s65
    v_mov_b32 v30, 0
    buffer_store_dwordx2 v[28:29], v30, s[60:63], s67 offen sc1
    s_mov_b64 exec, -1
nosig_16:
    v_mfma_f32_32x32x16_bf16 v[48:63], v[76:79], a[20:23], v[48:63]
    ds_read_b64_tr_b16 v[76:77], v9 offset:18432
    ds_read_b64_tr_b16 v[78:79], v9 offset:18944
    buffer_load_dwordx4 a[20:23], v10, s[36:39], s77 offen offset:1024 sc1
    v_and_b32 v233, s18, v232
    v_and_b32 v235, s18, v234
    v_lshlrev_b32 v232, 16, v232
    v_lshlrev_b32 v234, 16, v234
    v_accvgpr_read_b32 v26, a226
    s_waitcnt vmcnt(26) lgkmcnt(12)
    v_mfma_f32_32x32x16_bf16 v[32:47], v[80:83], a[24:27], v[32:47]
    ds_read_b64_tr_b16 v[80:81], v8 offset:20480
    ds_read_b64_tr_b16 v[82:83], v8 offset:20992
    buffer_load_dwordx4 v18, s[56:59], s72 offen offset:1024 sc1 lds
    v_mfma_f32_32x32x16_bf16 v[48:63], v[84:87], a[24:27], v[48:63]
    ds_read_b64_tr_b16 v[84:85], v9 offset:20480
    ds_read_b64_tr_b16 v[86:87], v9 offset:20992
    buffer_load_dwordx4 a[24:27], v10, s[36:39], s77 offen offset:2048 sc1
    v_accvgpr_read_b32 v27, a227
    v_lshlrev_b32 v204, 16, v26
    v_lshlrev_b32 v206, 16, v27
    v_and_b32 v205, s18, v26
    v_and_b32 v207, s18, v27
    s_waitcnt vmcnt(24) lgkmcnt(12)
    v_mfma_f32_32x32x16_bf16 v[32:47], v[88:91], a[28:31], v[32:47]
    ds_read_b64_tr_b16 v[88:89], v8 offset:22528
    ds_read_b64_tr_b16 v[90:91], v8 offset:23040
    v_sub_f32 v236, v204, v160
    v_sub_f32 v238, v206, v160
    v_sub_f32 v237, v205, v161
    v_sub_f32 v239, v207, v161
    v_cvt_pk_bf16_f32 v236, v236, v237
    v_cvt_pk_bf16_f32 v238, v238, v239
    v_mfma_f32_32x32x16_bf16 v[48:63], v[92:95], a[28:31], v[48:63]
    ds_read_b64_tr_b16 v[92:93], v9 offset:22528
    ds_read_b64_tr_b16 v[94:95], v9 offset:23040
    buffer_load_dwordx4 a[28:31], v10, s[36:39], s77 offen offset:3072 sc1
    s_add_u32 s77, s77, 4096
    v_and_b32 v237, s18, v236
    v_and_b32 v239, s18, v238
    v_lshlrev_b32 v236, 16, v236
    v_lshlrev_b32 v238, 16, v238
    v_mul_f32 v236, v236, v162
    s_waitcnt vmcnt(22) lgkmcnt(12)
    v_mfma_f32_32x32x16_bf16 v[32:47], v[64:67], a[32:35], v[32:47]
    ds_read_b64_tr_b16 v[64:65], v8 offset:24576
    ds_read_b64_tr_b16 v[66:67], v8 offset:25088
    buffer_load_dwordx4 v19, s[56:59], s72 offen offset:2048 sc1 lds
    v_mfma_f32_32x32x16_bf16 v[48:63], v[68:71], a[32:35], v[48:63]
    ds_read_b64_tr_b16 v[68:69], v9 offset:24576
    ds_read_b64_tr_b16 v[70:71], v9 offset:25088
    buffer_load_dwordx4 a[32:35], v10, s[36:39], s77 offen offset:0 sc1
    v_mul_f32 v238, v238, v162
    s_waitcnt vmcnt(23) lgkmcnt(12)
    v_mfma_f32_32x32x16_bf16 v[32:47], v[72:75], a[36:39], v[32:47]
    ds_read_b64_tr_b16 v[72:73], v8 offset:26624
    ds_read_b64_tr_b16 v[74:75], v8 offset:27136
    v_mfma_f32_32x32x16_bf16 v[48:63], v[76:79], a[36:39], v[48:63]
    ds_read_b64_tr_b16 v[76:77], v9 offset:26624
    ds_read_b64_tr_b16 v[78:79], v9 offset:27136
    buffer_load_dwordx4 a[36:39], v10, s[36:39], s77 offen offset:1024 sc1
    s_waitcnt vmcnt(22) lgkmcnt(12)
    v_mfma_f32_32x32x16_bf16 v[32:47], v[80:83], a[40:43], v[32:47]
    ds_read_b64_tr_b16 v[80:81], v8 offset:28672
    ds_read_b64_tr_b16 v[82:83], v8 offset:29184
    buffer_load_dwordx4 v5, s[56:59], s72 offen offset:3072 sc1 lds
    s_add_u32 s72, s72, s76
    v_mfma_f32_32x32x16_bf16 v[48:63], v[84:87], a[40:43], v[48:63]
    ds_read_b64_tr_b16 v[84:85], v9 offset:28672
    ds_read_b64_tr_b16 v[86:87], v9 offset:29184
    buffer_load_dwordx4 a[40:43], v10, s[36:39], s77 offen offset:2048 sc1
    s_waitcnt vmcnt(23) lgkmcnt(12)
    v_mfma_f32_32x32x16_bf16 v[32:47], v[88:91], a[44:47], v[32:47]
    ds_read_b64_tr_b16 v[88:89], v8 offset:30720
    ds_read_b64_tr_b16 v[90:91], v8 offset:31232
    v_mfma_f32_32x32x16_bf16 v[48:63], v[92:95], a[44:47], v[48:63]
    ds_read_b64_tr_b16 v[92:93], v9 offset:30720
    ds_read_b64_tr_b16 v[94:95], v9 offset:31232
    buffer_load_dwordx4 a[44:47], v10, s[36:39], s77 offen offset:3072 sc1
    s_add_u32 s77, s77, 4096
    s_waitcnt vmcnt(22) lgkmcnt(12)
    v_mfma_f32_32x32x16_bf16 v[32:47], v[64:67], a[48:51], v[32:47]
    s_waitcnt vmcnt(26)
    s_barrier
    ds_read_b64_tr_b16 v[64:65], v8 offset:32768
    ds_read_b64_tr_b16 v[66:67], v8 offset:33280
    s_add_u32 m0, s74, 0
    s_nop 0
    buffer_load_dwordx4 v12, s[56:59], s72 offen offset:0 sc1 lds
    v_mfma_f32_32x32x16_bf16 v[48:63], v[68:71], a[48:51], v[48:63]
    ds_read_b64_tr_b16 v[68:69], v9 offset:32768
    ds_read_b64_tr_b16 v[70:71], v9 offset:33280
    buffer_load_dwordx4 a[48:51], v10, s[36:39], s77 offen offset:0 sc1
    s_waitcnt vmcnt(23) lgkmcnt(12)
    v_mfma_f32_32x32x16_bf16 v[32:47], v[72:75], a[52:55], v[32:47]
    ds_read_b64_tr_b16 v[72:73], v8 offset:34816
    ds_read_b64_tr_b16 v[74:75], v8 offset:35328
    v_mfma_f32_32x32x16_bf16 v[48:63], v[76:79], a[52:55], v[48:63]
    ds_read_b64_tr_b16 v[76:77], v9 offset:34816
    ds_read_b64_tr_b16 v[78:79], v9 offset:35328
    buffer_load_dwordx4 a[52:55], v10, s[36:39], s77 offen offset:1024 sc1
    s_waitcnt vmcnt(22) lgkmcnt(12)
    v_mfma_f32_32x32x16_bf16 v[32:47], v[80:83], a[56:59], v[32:47]
    ds_read_b64_tr_b16 v[80:81], v8 offset:36864
    ds_read_b64_tr_b16 v[82:83], v8 offset:37376
    buffer_load_dwordx4 v18, s[56:59], s72 offen offset:1024 sc1 lds
    v_mfma_f32_32x32x16_bf16 v[48:63], v[84:87], a[56:59], v[48:63]
    ds_read_b64_tr_b16 v[84:85], v9 offset:36864
    ds_read_b64_tr_b16 v[86:87], v9 offset:37376
    buffer_load_dwordx4 a[56:59], v10, s[36:39], s77 offen offset:2048 sc1
    s_waitcnt vmcnt(23) lgkmcnt(12)
    v_mfma_f32_32x32x16_bf16 v[32:47], v[88:91], a[60:63], v[32:47]
    ds_read_b64_tr_b16 v[88:89], v8 offset:38912
    ds_read_b64_tr_b16 v[90:91], v8 offset:39424
    v_mfma_f32_32x32x16_bf16 v[48:63], v[92:95], a[60:63], v[48:63]
    ds_read_b64_tr_b16 v[92:93], v9 offset:38912
    ds_read_b64_tr_b16 v[94:95], v9 offset:39424
    buffer_load_dwordx4 a[60:63], v10, s[36:39], s77 offen offset:3072 sc1
    s_add_u32 s77, s77, 4096
    s_waitcnt vmcnt(22) lgkmcnt(12)
    v_mfma_f32_32x32x16_bf16 v[32:47], v[64:67], a[0:3], v[32:47]
    ds_read_b64_tr_b16 v[64:65], v8 offset:40960
    ds_read_b64_tr_b16 v[66:67], v8 offset:41472
    buffer_load_dwordx4 v19, s[56:59], s72 offen offset:2048 sc1 lds
    v_mfma_f32_32x32x16_bf16 v[48:63], v[68:71], a[0:3], v[48:63]
    ds_read_b64_tr_b16 v[68:69], v9 offset:40960
    ds_read_b64_tr_b16 v[70:71], v9 offset:41472
    buffer_load_dwordx4 a[0:3], v10, s[36:39], s77 offen offset:0 sc1
    s_waitcnt vmcnt(23) lgkmcnt(12)
    v_mfma_f32_32x32x16_bf16 v[32:47], v[72:75], a[4:7], v[32:47]
    ds_read_b64_tr_b16 v[72:73], v8 offset:43008
    ds_read_b64_tr_b16 v[74:75], v8 offset:43520
    v_mfma_f32_32x32x16_bf16 v[48:63], v[76:79], a[4:7], v[48:63]
    ds_read_b64_tr_b16 v[76:77], v9 offset:43008
    ds_read_b64_tr_b16 v[78:79], v9 offset:43520
    buffer_load_dwordx4 a[4:7], v10, s[36:39], s77 offen offset:1024 sc1
    s_waitcnt vmcnt(22) lgkmcnt(12)
    v_mfma_f32_32x32x16_bf16 v[32:47], v[80:83], a[8:11], v[32:47]
    ds_read_b64_tr_b16 v[80:81], v8 offset:45056
    ds_read_b64_tr_b16 v[82:83], v8 offset:45568
    buffer_load_dwordx4 v5, s[56:59], s72 offen offset:3072 sc1 lds
    s_add_u32 s72, s72, s76
    v_mfma_f32_32x32x16_bf16 v[48:63], v[84:87], a[8:11], v[48:63]
    ds_read_b64_tr_b16 v[84:85], v9 offset:45056
    ds_read_b64_tr_b16 v[86:87], v9 offset:45568
    buffer_load_dwordx4 a[8:11], v10, s[36:39], s77 offen offset:2048 sc1
    s_waitcnt vmcnt(23) lgkmcnt(12)
    v_mfma_f32_32x32x16_bf16 v[32:47], v[88:91], a[12:15], v[32:47]
    ds_read_b64_tr_b16 v[88:89], v8 offset:47104
    ds_read_b64_tr_b16 v[90:91], v8 offset:47616
    v_mfma_f32_32x32x16_bf16 v[48:63], v[92:95], a[12:15], v[48:63]
    ds_read_b64_tr_b16 v[92:93], v9 offset:47104
    ds_read_b64_tr_b16 v[94:95], v9 offset:47616
    buffer_load_dwordx4 a[12:15], v10, s[36:39], s77 offen offset:3072 sc1
    s_add_u32 s77, s77, 4096
    s_waitcnt vmcnt(22) lgkmcnt(12)
    v_mfma_f32_32x32x16_bf16 v[32:47], v[64:67], a[16:19], v[32:47]
    s_waitcnt vmcnt(26)
    s_barrier
    ds_read_b64_tr_b16 v[64:65], v8 offset:49152
    ds_read_b64_tr_b16 v[66:67], v8 offset:49664
    s_add_u32 m0, s74, 16384
    s_nop 0
    buffer_load_dwordx4 v12, s[56:59], s72 offen offset:0 sc1 lds
    v_mfma_f32_32x32x16_bf16 v[48:63], v[68:71], a[16:19], v[48:63]
    ds_read_b64_tr_b16 v[68:69], v9 offset:49152
    ds_read_b64_tr_b16 v[70:71], v9 offset:49664
    buffer_load_dwordx4 a[16:19], v10, s[36:39], s77 offen offset:0 sc1
    s_waitcnt vmcnt(23) lgkmcnt(12)
    v_mfma_f32_32x32x16_bf16 v[32:47], v[72:75], a[20:23], v[32:47]
    ds_read_b64_tr_b16 v[72:73], v8 offset:51200
    ds_read_b64_tr_b16 v[74:75], v8 offset:51712
    v_mfma_f32_32x32x16_bf16 v[48:63], v[76:79], a[20:23], v[48:63]
    ds_read_b64_tr_b16 v[76:77], v9 offset:51200
    ds_read_b64_tr_b16 v[78:79], v9 offset:51712
    buffer_load_dwordx4 a[20:23], v10, s[36:39], s77 offen offset:1024 sc1
    s_waitcnt vmcnt(22) lgkmcnt(12)
    v_mfma_f32_32x32x16_bf16 v[32:47], v[80:83], a[24:27], v[32:47]
    ds_read_b64_tr_b16 v[80:81], v8 offset:53248
    ds_read_b64_tr_b16 v[82:83], v8 offset:53760
    buffer_load_dwordx4 v18, s[56:59], s72 offen offset:1024 sc1 lds
    v_mfma_f32_32x32x16_bf16 v[48:63], v[84:87], a[24:27], v[48:63]
    ds_read_b64_tr_b16 v[84:85], v9 offset:53248
    ds_read_b64_tr_b16 v[86:87], v9 offset:53760
    buffer_load_dwordx4 a[24:27], v10, s[36:39], s77 offen offset:2048 sc1
    s_waitcnt vmcnt(23) lgkmcnt(12)
    v_mfma_f32_32x32x16_bf16 v[32:47], v[88:91], a[28:31], v[32:47]
    ds_read_b64_tr_b16 v[88:89], v8 offset:55296
    ds_read_b64_tr_b16 v[90:91], v8 offset:55808
    v_mfma_f32_32x32x16_bf16 v[48:63], v[92:95], a[28:31], v[48:63]
    ds_read_b64_tr_b16 v[92:93], v9 offset:55296
    ds_read_b64_tr_b16 v[94:95], v9 offset:55808
    buffer_load_dwordx4 a[28:31], v10, s[36:39], s77 offen offset:3072 sc1
    s_add_u32 s77, s77, 4096
    s_waitcnt vmcnt(22) lgkmcnt(12)
    v_mfma_f32_32x32x16_bf16 v[32:47], v[64:67], a[32:35], v[32:47]
    ds_read_b64_tr_b16 v[64:65], v8 offset:57344
    ds_read_b64_tr_b16 v[66:67], v8 offset:57856
    buffer_load_dwordx4 v19, s[56:59], s72 offen offset:2048 sc1 lds
    v_mfma_f32_32x32x16_bf16 v[48:63], v[68:71], a[32:35], v[48:63]
    ds_read_b64_tr_b16 v[68:69], v9 offset:57344
    ds_read_b64_tr_b16 v[70:71], v9 offset:57856
    buffer_load_dwordx4 a[32:35], v10, s[36:39], s77 offen offset:0 sc1
    s_waitcnt vmcnt(23) lgkmcnt(12)
    v_mfma_f32_32x32x16_bf16 v[32:47], v[72:75], a[36:39], v[32:47]
    ds_read_b64_tr_b16 v[72:73], v8 offset:59392
    ds_read_b64_tr_b16 v[74:75], v8 offset:59904
    v_mfma_f32_32x32x16_bf16 v[48:63], v[76:79], a[36:39], v[48:63]
    ds_read_b64_tr_b16 v[76:77], v9 offset:59392
    ds_read_b64_tr_b16 v[78:79], v9 offset:59904
    buffer_load_dwordx4 a[36:39], v10, s[36:39], s77 offen offset:1024 sc1
    s_waitcnt vmcnt(22) lgkmcnt(12)
    v_mfma_f32_32x32x16_bf16 v[32:47], v[80:83], a[40:43], v[32:47]
    ds_read_b64_tr_b16 v[80:81], v8 offset:61440
    ds_read_b64_tr_b16 v[82:83], v8 offset:61952
    buffer_load_dwordx4 v5, s[56:59], s72 offen offset:3072 sc1 lds
    s_add_u32 s72, s72, s76
    v_mfma_f32_32x32x16_bf16 v[48:63], v[84:87], a[40:43], v[48:63]
    ds_read_b64_tr_b16 v[84:85], v9 offset:61440
    ds_read_b64_tr_b16 v[86:87], v9 offset:61952
    buffer_load_dwordx4 a[40:43], v10, s[36:39], s77 offen offset:2048 sc1
    s_waitcnt vmcnt(23) lgkmcnt(12)
    v_mfma_f32_32x32x16_bf16 v[32:47], v[88:91], a[44:47], v[32:47]
    ds_read_b64_tr_b16 v[88:89], v8 offset:63488
    ds_read_b64_tr_b16 v[90:91], v8 offset:64000
    v_mfma_f32_32x32x16_bf16 v[48:63], v[92:95], a[44:47], v[48:63]
    ds_read_b64_tr_b16 v[92:93], v9 offset:63488
    ds_read_b64_tr_b16 v[94:95], v9 offset:64000
    buffer_load_dwordx4 a[44:47], v10, s[36:39], s77 offen offset:3072 sc1
    s_add_u32 s77, s77, 4096
    s_waitcnt vmcnt(22) lgkmcnt(12)
    v_mfma_f32_32x32x16_bf16 v[32:47], v[64:67], a[48:51], v[32:47]
    s_waitcnt vmcnt(26)
    s_barrier
    ds_read_b64_tr_b16 v[64:65], v3 offset:0
    ds_read_b64_tr_b16 v[66:67], v3 offset:512
    s_add_u32 m0, s74, 32768
    s_nop 0
    buffer_load_dwordx4 v12, s[56:59], s72 offen offset:0 sc1 lds
    v_mfma_f32_32x32x16_bf16 v[48:63], v[68:71], a[48:51], v[48:63]
    ds_read_b64_tr_b16 v[68:69], v4 offset:0
    ds_read_b64_tr_b16 v[70:71], v4 offset:512
    buffer_load_dwordx4 a[48:51], v10, s[36:39], s77 offen offset:0 sc1
    s_waitcnt vmcnt(23) lgkmcnt(12)
    v_mfma_f32_32x32x16_bf16 v[32:47], v[72:75], a[52:55], v[32:47]
    ds_read_b64_tr_b16 v[72:73], v3 offset:2048
    ds_read_b64_tr_b16 v[74:75], v3 offset:2560
    v_mfma_f32_32x32x16_bf16 v[48:63], v[76:79], a[52:55], v[48:63]
    ds_read_b64_tr_b16 v[76:77], v4 offset:2048
    ds_read_b64_tr_b16 v[78:79], v4 offset:2560
    buffer_load_dwordx4 a[52:55], v10, s[36:39], s77 offen offset:1024 sc1
    s_waitcnt vmcnt(22) lgkmcnt(12)
    v_mfma_f32_32x32x16_bf16 v[32:47], v[80:83], a[56:59], v[32:47]
    ds_read_b64_tr_b16 v[80:81], v3 offset:4096
    ds_read_b64_tr_b16 v[82:83], v3 offset:4608
    buffer_load_dwordx4 v18, s[56:59], s72 offen offset:1024 sc1 lds
    v_mfma_f32_32x32x16_bf16 v[48:63], v[84:87], a[56:59], v[48:63]
    ds_read_b64_tr_b16 v[84:85], v4 offset:4096
    ds_read_b64_tr_b16 v[86:87], v4 offset:4608
    buffer_load_dwordx4 a[56:59], v10, s[36:39], s77 offen offset:2048 sc1
    s_waitcnt vmcnt(23) lgkmcnt(12)
    v_mfma_f32_32x32x16_bf16 v[32:47], v[88:91], a[60:63], v[32:47]
    ds_read_b64_tr_b16 v[88:89], v3 offset:6144
    ds_read_b64_tr_b16 v[90:91], v3 offset:6656
    v_mfma_f32_32x32x16_bf16 v[48:63], v[92:95], a[60:63], v[48:63]
    ds_read_b64_tr_b16 v[92:93], v4 offset:6144
    ds_read_b64_tr_b16 v[94:95], v4 offset:6656
    buffer_load_dwordx4 a[60:63], v10, s[36:39], s77 offen offset:3072 sc1
    s_add_u32 s77, s77, 4096
    s_waitcnt vmcnt(22) lgkmcnt(12)
    v_mfma_f32_32x32x16_bf16 v[32:47], v[64:67], a[0:3], v[32:47]
    ds_read_b64_tr_b16 v[64:65], v3 offset:8192
    ds_read_b64_tr_b16 v[66:67], v3 offset:8704
    buffer_load_dwordx4 v19, s[56:59], s72 offen offset:2048 sc1 lds
    v_mfma_f32_32x32x16_bf16 v[48:63], v[68:71], a[0:3], v[48:63]
    ds_read_b64_tr_b16 v[68:69], v4 offset:8192
    ds_read_b64_tr_b16 v[70:71], v4 offset:8704
    buffer_load_dwordx4 a[0:3], v10, s[36:39], s77 offen offset:0 sc1
    s_waitcnt vmcnt(23) lgkmcnt(12)
    v_mfma_f32_32x32x16_bf16 v[32:47], v[72:75], a[4:7], v[32:47]
    ds_read_b64_tr_b16 v[72:73], v3 offset:10240
    ds_read_b64_tr_b16 v[74:75], v3 offset:10752
    v_mfma_f32_32x32x16_bf16 v[48:63], v[76:79], a[4:7], v[48:63]
    ds_read_b64_tr_b16 v[76:77], v4 offset:10240
    ds_read_b64_tr_b16 v[78:79], v4 offset:10752
    buffer_load_dwordx4 a[4:7], v10, s[36:39], s77 offen offset:1024 sc1
    s_waitcnt vmcnt(22) lgkmcnt(12)
    v_mfma_f32_32x32x16_bf16 v[32:47], v[80:83], a[8:11], v[32:47]
    ds_read_b64_tr_b16 v[80:81], v3 offset:12288
    ds_read_b64_tr_b16 v[82:83], v3 offset:12800
    buffer_load_dwordx4 v5, s[56:59], s72 offen offset:3072 sc1 lds
    s_add_u32 s72, s72, s76
    v_mfma_f32_32x32x16_bf16 v[48:63], v[84:87], a[8:11], v[48:63]
    ds_read_b64_tr_b16 v[84:85], v4 offset:12288
    ds_read_b64_tr_b16 v[86:87], v4 offset:12800
    buffer_load_dwordx4 a[8:11], v10, s[36:39], s77 offen offset:2048 sc1
    s_waitcnt vmcnt(23) lgkmcnt(12)
    v_mfma_f32_32x32x16_bf16 v[32:47], v[88:91], a[12:15], v[32:47]
    ds_read_b64_tr_b16 v[88:89], v3 offset:14336
    ds_read_b64_tr_b16 v[90:91], v3 offset:14848
    v_mfma_f32_32x32x16_bf16 v[48:63], v[92:95], a[12:15], v[48:63]
    ds_read_b64_tr_b16 v[92:93], v4 offset:14336
    ds_read_b64_tr_b16 v[94:95], v4 offset:14848
    buffer_load_dwordx4 a[12:15], v10, s[36:39], s77 offen offset:3072 sc1
    s_add_u32 s77, s77, 4096
    s_waitcnt vmcnt(22) lgkmcnt(12)
    v_mfma_f32_32x32x16_bf16 v[32:47], v[64:67], a[16:19], v[32:47]
    s_waitcnt vmcnt(26)
    s_barrier
    ds_read_b64_tr_b16 v[64:65], v8 offset:0
    ds_read_b64_tr_b16 v[66:67], v8 offset:512
    s_add_u32 m0, s74, 49152
    s_nop 0
    buffer_load_dwordx4 v12, s[56:59], s72 offen offset:0 sc1 lds
    v_mfma_f32_32x32x16_bf16 v[48:63], v[68:71], a[16:19], v[48:63]
    ds_read_b64_tr_b16 v[68:69], v9 offset:0
    ds_read_b64_tr_b16 v[70:71], v9 offset:512
    buffer_load_dwordx4 a[16:19], v10, s[36:39], s77 offen offset:0 sc1
    s_waitcnt vmcnt(23) lgkmcnt(12)
    v_mfma_f32_32x32x16_bf16 v[32:47], v[72:75], a[20:23], v[32:47]
    ds_read_b64_tr_b16 v[72:73], v8 offset:2048
    ds_read_b64_tr_b16 v[74:75], v8 offset:2560
    buffer_load_dwordx2 v[14:15], v13, s[60:63], s79 offen sc1
    v_mfma_f32_32x32x16_bf16 v[48:63], v[76:79], a[20:23], v[48:63]
    ds_read_b64_tr_b16 v[76:77], v9 offset:2048
    ds_read_b64_tr_b16 v[78:79], v9 offset:2560
    buffer_load_dwordx4 a[20:23], v10, s[36:39], s77 offen offset:1024 sc1
    v_mul_f32 v237, v237, v163
    v_mul_f32 v239, v239, v163
    v_cvt_pk_bf16_f32 v236, v236, v237
    v_cvt_pk_bf16_f32 v238, v238, v239
    v_and_b32 v237, s18, v236
    s_waitcnt vmcnt(23) lgkmcnt(12)
    v_mfma_f32_32x32x16_bf16 v[32:47], v[80:83], a[24:27], v[32:47]
    ds_read_b64_tr_b16 v[80:81], v8 offset:4096
    ds_read_b64_tr_b16 v[82:83], v8 offset:4608
    buffer_load_dwordx4 v18, s[56:59], s72 offen offset:1024 sc1 lds
    v_mfma_f32_32x32x16_bf16 v[48:63], v[84:87], a[24:27], v[48:63]
    ds_read_b64_tr_b16 v[84:85], v9 offset:4096
    ds_read_b64_tr_b16 v[86:87], v9 offset:4608
    buffer_load_dwordx4 a[24:27], v10, s[36:39], s77 offen offset:2048 sc1
    v_and_b32 v239, s18, v238
    v_lshlrev_b32 v236, 16, v236
    v_lshlrev_b32 v238, 16, v238
    v_accvgpr_read_b32 v26, a228
    v_accvgpr_read_b32 v27, a229
    s_waitcnt vmcnt(24) lgkmcnt(12)
    v_mfma_f32_32x32x16_bf16 v[32:47], v[88:91], a[28:31], v[32:47]
    ds_read_b64_tr_b16 v[88:89], v8 offset:6144
    ds_read_b64_tr_b16 v[90:91], v8 offset:6656
    v_lshlrev_b32 v208, 16, v26
    v_lshlrev_b32 v210, 16, v27
    v_and_b32 v209, s18, v26
    v_and_b32 v211, s18, v27
    v_sub_f32 v240, v208, v160
    v_sub_f32 v242, v210, v160
    v_mfma_f32_32x32x16_bf16 v[48:63], v[92:95], a[28:31], v[48:63]
    ds_read_b64_tr_b16 v[92:93], v9 offset:6144
    ds_read_b64_tr_b16 v[94:95], v9 offset:6656
    buffer_load_dwordx4 a[28:31], v10, s[36:39], s77 offen offset:3072 sc1
    s_add_u32 s77, s77, 4096
    v_sub_f32 v241, v209, v161
    v_sub_f32 v243, v211, v161
    v_cvt_pk_bf16_f32 v240, v240, v241
    v_cvt_pk_bf16_f32 v242, v242, v243
    v_and_b32 v241, s18, v240
    s_waitcnt vmcnt(23) lgkmcnt(12)
    v_mfma_f32_32x32x16_bf16 v[32:47], v[64:67], a[32:35], v[32:47]
    ds_read_b64_tr_b16 v[64:65], v8 offset:8192
    ds_read_b64_tr_b16 v[66:67], v8 offset:8704
    buffer_load_dwordx4 v19, s[56:59], s72 offen offset:2048 sc1 lds
    v_mfma_f32_32x32x16_bf16 v[48:63], v[68:71], a[32:35], v[48:63]
    ds_read_b64_tr_b16 v[68:69], v9 offset:8192
    ds_read_b64_tr_b16 v[70:71], v9 offset:8704
    buffer_load_dwordx4 a[32:35], v10, s[36:39], s77 offen offset:0 sc1
    v_and_b32 v243, s18, v242
    v_lshlrev_b32 v240, 16, v240
    v_lshlrev_b32 v242, 16, v242
    v_mul_f32 v240, v240, v162
    v_mul_f32 v242, v242, v162
    s_waitcnt vmcnt(24) lgkmcnt(12)
    v_mfma_f32_32x32x16_bf16 v[32:47], v[72:75], a[36:39], v[32:47]
    ds_read_b64_tr_b16 v[72:73], v8 offset:10240
    ds_read_b64_tr_b16 v[74:75], v8 offset:10752
    v_mul_f32 v241, v241, v163
    v_mul_f32 v243, v243, v163
    v_cvt_pk_bf16_f32 v240, v240, v241
    v_cvt_pk_bf16_f32 v242, v242, v243
    v_and_b32 v241, s18, v240
    v_and_b32 v243, s18, v242
    v_mfma_f32_32x32x16_bf16 v[48:63], v[76:79], a[36:39], v[48:63]
    ds_read_b64_tr_b16 v[76:77], v9 offset:10240
    ds_read_b64_tr_b16 v[78:79], v9 offset:10752
    buffer_load_dwordx4 a[36:39], v10, s[36:39], s77 offen offset:1024 sc1
    v_lshlrev_b32 v240, 16, v240
    v_lshlrev_b32 v242, 16, v242
    v_accvgpr_read_b32 v26, a230
    v_accvgpr_read_b32 v27, a231
    v_lshlrev_b32 v212, 16, v26
    s_waitcnt vmcnt(23) lgkmcnt(12)
    v_mfma_f32_32x32x16_bf16 v[32:47], v[80:83], a[40:43], v[32:47]
    ds_read_b64_tr_b16 v[80:81], v8 offset:12288
    ds_read_b64_tr_b16 v[82:83], v8 offset:12800
    buffer_load_dwordx4 v5, s[56:59], s72 offen offset:3072 sc1 lds
    s_add_u32 s72, s72, s76
    v_mfma_f32_32x32x16_bf16 v[48:63], v[84:87], a[40:43], v[48:63]
    ds_read_b64_tr_b16 v[84:85], v9 offset:12288
    ds_read_b64_tr_b16 v[86:87], v9 offset:12800
    buffer_load_dwordx4 a[40:43], v10, s[36:39], s77 offen offset:2048 sc1
    v_lshlrev_b32 v214, 16, v27
    v_and_b32 v213, s18, v26
    v_and_b32 v215, s18, v27
    v_sub_f32 v244, v212, v160
    v_sub_f32 v246, v214, v160
    s_waitcnt vmcnt(24) lgkmcnt(12)
    v_mfma_f32_32x32x16_bf16 v[32:47], v[88:91], a[44:47], v[32:47]
    ds_read_b64_tr_b16 v[88:89], v8 offset:14336
    ds_read_b64_tr_b16 v[90:91], v8 offset:14848
    v_sub_f32 v245, v213, v161
    v_sub_f32 v247, v215, v161
    v_cvt_pk_bf16_f32 v244, v244, v245
    v_cvt_pk_bf16_f32 v246, v246, v247
    v_and_b32 v245, s18, v244
    v_and_b32 v247, s18, v246
    v_mfma_f32_32x32x16_bf16 v[48:63], v[92:95], a[44:47], v[48:63]
    ds_read_b64_tr_b16 v[92:93], v9 offset:14336
    ds_read_b64_tr_b16 v[94:95], v9 offset:14848
    buffer_load_dwordx4 a[44:47], v10, s[36:39], s77 offen offset:3072 sc1
    s_add_u32 s77, s77, 4096
    v_lshlrev_b32 v244, 16, v244
    v_lshlrev_b32 v246, 16, v246
    v_mul_f32 v244, v244, v162
    v_mul_f32 v246, v246, v162
    v_mul_f32 v245, v245, v163
    v_mul_f32 v247, v247, v163
    v_cvt_pk_bf16_f32 v244, v244, v245
    v_cvt_pk_bf16_f32 v246, v246, v247
    s_waitcnt vmcnt(23) lgkmcnt(12)
    v_mfma_f32_32x32x16_bf16 v[32:47], v[64:67], a[48:51], v[32:47]
    s_waitcnt vmcnt(27)
    s_barrier
    ds_read_b64_tr_b16 v[64:65], v8 offset:16384
    ds_read_b64_tr_b16 v[66:67], v8 offset:16896
    s_add_u32 m0, s74, 65536
    s_nop 0
    buffer_load_dwordx4 v12, s[56:59], s72 offen offset:0 sc1 lds
    v_mfma_f32_32x32x16_bf16 v[48:63], v[68:71], a[48:51], v[48:63]
    ds_read_b64_tr_b16 v[68:69], v9 offset:16384
    ds_read_b64_tr_b16 v[70:71], v9 offset:16896
    buffer_load_dwordx4 a[48:51], v10, s[36:39], s77 offen offset:0 sc1
    v_and_b32 v245, s18, v244
    v_and_b32 v247, s18, v246
    v_lshlrev_b32 v244, 16, v244
    v_lshlrev_b32 v246, 16, v246
    v_accvgpr_read_b32 v26, a232
    s_waitcnt vmcnt(24) lgkmcnt(12)
    v_mfma_f32_32x32x16_bf16 v[32:47], v[72:75], a[52:55], v[32:47]
    ds_read_b64_tr_b16 v[72:73], v8 offset:18432
    ds_read_b64_tr_b16 v[74:75], v8 offset:18944
    v_accvgpr_read_b32 v27, a233
    v_lshlrev_b32 v216, 16, v26
    v_lshlrev_b32 v218, 16, v27
    v_and_b32 v217, s18, v26
    v_and_b32 v219, s18, v27
    v_sub_f32 v248, v216, v160
    v_mfma_f32_32x32x16_bf16 v[48:63], v[76:79], a[52:55], v[48:63]
    ds_read_b64_tr_b16 v[76:77], v9 offset:18432
    ds_read_b64_tr_b16 v[78:79], v9 offset:18944
    buffer_load_dwordx4 a[52:55], v10, s[36:39], s77 offen offset:1024 sc1
    v_sub_f32 v250, v218, v160
    v_sub_f32 v249, v217, v161
    v_sub_f32 v251, v219, v161
    v_cvt_pk_bf16_f32 v248, v248, v249
    v_cvt_pk_bf16_f32 v250, v250, v251
    s_waitcnt vmcnt(23) lgkmcnt(12)
    v_mfma_f32_32x32x16_bf16 v[32:47], v[80:83], a[56:59], v[32:47]
    ds_read_b64_tr_b16 v[80:81], v8 offset:20480
    ds_read_b64_tr_b16 v[82:83], v8 offset:20992
    buffer_load_dwordx4 v18, s[56:59], s72 offen offset:1024 sc1 lds
    v_mfma_f32_32x32x16_bf16 v[48:63], v[84:87], a[56:59], v[48:63]
    ds_read_b64_tr_b16 v[84:85], v9 offset:20480
    ds_read_b64_tr_b16 v[86:87], v9 offset:20992
    buffer_load_dwordx4 a[56:59], v10, s[36:39], s77 offen offset:2048 sc1
    v_and_b32 v249, s18, v248
    v_and_b32 v251, s18, v250
    v_lshlrev_b32 v248, 16, v248
    v_lshlrev_b32 v250, 16, v250
    v_mul_f32 v248, v248, v162
    s_waitcnt vmcnt(24) lgkmcnt(12)
    v_mfma_f32_32x32x16_bf16 v[32:47], v[88:91], a[60:63], v[32:47]
    ds_read_b64_tr_b16 v[88:89], v8 offset:22528
    ds_read_b64_tr_b16 v[90:91], v8 offset:23040
    v_mul_f32 v250, v250, v162
    v_mul_f32 v249, v249, v163
    v_mul_f32 v251, v251, v163
    v_cvt_pk_bf16_f32 v248, v248, v249
    v_cvt_pk_bf16_f32 v250, v250, v251
    v_and_b32 v249, s18, v248
    v_mfma_f32_32x32x16_bf16 v[48:63], v[92:95], a[60:63], v[48:63]
    ds_read_b64_tr_b16 v[92:93], v9 offset:22528
    ds_read_b64_tr_b16 v[94:95], v9 offset:23040
    buffer_load_dwordx4 a[60:63], v10, s[36:39], s77 offen offset:3072 sc1
    s_add_u32 s77, s77, 4096
    v_and_b32 v251, s18, v250
    v_lshlrev_b32 v248, 16, v248
    v_lshlrev_b32 v250, 16, v250
    v_accvgpr_read_b32 v26, a234
    v_accvgpr_read_b32 v27, a235
    s_waitcnt vmcnt(23) lgkmcnt(12)
    v_mfma_f32_32x32x16_bf16 v[32:47], v[64:67], a[0:3], v[32:47]
    ds_read_b64_tr_b16 v[64:65], v8 offset:24576
    ds_read_b64_tr_b16 v[66:67], v8 offset:25088
    buffer_load_dwordx4 v19, s[56:59], s72 offen offset:2048 sc1 lds
    v_mfma_f32_32x32x16_bf16 v[48:63], v[68:71], a[0:3], v[48:63]
    ds_read_b64_tr_b16 v[68:69], v9 offset:24576
    ds_read_b64_tr_b16 v[70:71], v9 offset:25088
    buffer_load_dwordx4 a[0:3], v10, s[36:39], s77 offen offset:0 sc1
    v_lshlrev_b32 v220, 16, v26
    v_lshlrev_b32 v222, 16, v27
    v_and_b32 v221, s18, v26
    v_and_b32 v223, s18, v27
    v_sub_f32 v252, v220, v160
    s_waitcnt vmcnt(24) lgkmcnt(12)
    v_mfma_f32_32x32x16_bf16 v[32:47], v[72:75], a[4:7], v[32:47]
    ds_read_b64_tr_b16 v[72:73], v8 offset:26624
    ds_read_b64_tr_b16 v[74:75], v8 offset:27136
    v_sub_f32 v254, v222, v160
    v_sub_f32 v253, v221, v161
    v_sub_f32 v255, v223, v161
    v_cvt_pk_bf16_f32 v252, v252, v253
    v_cvt_pk_bf16_f32 v254, v254, v255
    v_and_b32 v253, s18, v252
    v_mfma_f32_32x32x16_bf16 v[48:63], v[76:79], a[4:7], v[48:63]
    ds_read_b64_tr_b16 v[76:77], v9 offset:26624
    ds_read_b64_tr_b16 v[78:79], v9 offset:27136
    buffer_load_dwordx4 a[4:7], v10, s[36:39], s77 offen offset:1024 sc1
    v_and_b32 v255, s18, v254
    v_lshlrev_b32 v252, 16, v252
    v_lshlrev_b32 v254, 16, v254
    v_mul_f32 v252, v252, v162
    v_mul_f32 v254, v254, v162
    s_waitcnt vmcnt(23) lgkmcnt(12)
    v_mfma_f32_32x32x16_bf16 v[32:47], v[80:83], a[8:11], v[32:47]
    ds_read_b64_tr_b16 v[80:81], v8 offset:28672
    ds_read_b64_tr_b16 v[82:83], v8 offset:29184
    buffer_load_dwordx4 v5, s[56:59], s72 offen offset:3072 sc1 lds
    s_add_u32 s72, s72, s76
    v_mfma_f32_32x32x16_bf16 v[48:63], v[84:87], a[8:11], v[48:63]
    ds_read_b64_tr_b16 v[84:85], v9 offset:28672
    ds_read_b64_tr_b16 v[86:87], v9 offset:29184
    buffer_load_dwordx4 a[8:11], v10, s[36:39], s77 offen offset:2048 sc1
    v_mul_f32 v253, v253, v163
    v_mul_f32 v255, v255, v163
    v_cvt_pk_bf16_f32 v252, v252, v253
    v_cvt_pk_bf16_f32 v254, v254, v255
    v_and_b32 v253, s18, v252
    s_waitcnt vmcnt(24) lgkmcnt(12)
    v_mfma_f32_32x32x16_bf16 v[32:47], v[88:91], a[12:15], v[32:47]
    ds_read_b64_tr_b16 v[88:89], v8 offset:30720
    ds_read_b64_tr_b16 v[90:91], v8 offset:31232
    v_and_b32 v255, s18, v254
    v_lshlrev_b32 v252, 16, v252
    v_lshlrev_b32 v254, 16, v254
    s_waitcnt vmcnt(21)
    s_mov_b32 exec_lo, 0xffff
    s_mov_b32 exec_hi, 0
    s_mov_b32 s66, 0
poll_17:
    v_cmp_ne_u64 vcc, s[64:65], v[14:15]
    s_nop 1
    s_cmp_eq_u64 vcc, 0
    s_cbranch_scc1 polled_18
    s_add_u32 s66, s66, 1
    s_cmp_ge_u32 s66, 0x40000
    s_cbranch_scc1 polled_18
    buffer_load_dwordx2 v[14:15], v13, s[60:63], s79 offen sc1
    s_waitcnt vmcnt(0)
    s_branch poll_17
polled_18:
    s_mov_b64 exec, -1
    v_mfma_f32_32x32x16_bf16 v[48:63], v[92:95], a[12:15], v[48:63]
    ds_read_b64_tr_b16 v[92:93], v9 offset:30720
    ds_read_b64_tr_b16 v[94:95], v9 offset:31232
    buffer_load_dwordx4 a[12:15], v10, s[36:39], s77 offen offset:3072 sc1
    s_add_u32 s77, s77, 4096
    buffer_load_dwordx4 v[128:131], v20, s[40:43], s70 offen sc1
    s_add_u32 s70, s70, 16384
    s_waitcnt vmcnt(24) lgkmcnt(12)
    v_mfma_f32_32x32x16_bf16 v[32:47], v[64:67], a[16:19], v[32:47]
    s_waitcnt vmcnt(28)
    s_barrier
    ds_read_b64_tr_b16 v[64:65], v8 offset:32768
    ds_read_b64_tr_b16 v[66:67], v8 offset:33280
    v_mfma_f32_32x32x16_bf16 v[48:63], v[68:71], a[16:19], v[48:63]
    ds_read_b64_tr_b16 v[68:69], v9 offset:32768
    ds_read_b64_tr_b16 v[70:71], v9 offset:33280
    buffer_load_dwordx4 a[16:19], v10, s[36:39], s77 offen offset:0 sc1
    buffer_load_dwordx4 v[132:135], v20, s[40:43], s70 offen sc1
    s_add_u32 s70, s70, 16384
    buffer_load_dwordx4 v[136:139], v20, s[40:43], s70 offen sc1
    s_add_u32 s70, s70, 16384
    s_waitcnt vmcnt(25) lgkmcnt(12)
    v_mfma_f32_32x32x16_bf16 v[32:47], v[72:75], a[20:23], v[32:47]
    ds_read_b64_tr_b16 v[72:73], v8 offset:34816
    ds_read_b64_tr_b16 v[74:75], v8 offset:35328
    v_mfma_f32_32x32x16_bf16 v[48:63], v[76:79], a[20:23], v[48:63]
    ds_read_b64_tr_b16 v[76:77], v9 offset:34816
    ds_read_b64_tr_b16 v[78:79], v9 offset:35328
    buffer_load_dwordx4 a[20:23], v10, s[36:39], s77 offen offset:1024 sc1
    buffer_load_dwordx4 v[140:143], v20, s[40:43], s70 offen sc1
    s_add_u32 s70, s70, 16384
    s_mov_b32 s52, s24
    s_waitcnt vmcnt(25) lgkmcnt(12)
    v_mfma_f32_32x32x16_bf16 v[32:47], v[80:83], a[24:27], v[32:47]
    ds_read_b64_tr_b16 v[80:81], v8 offset:36864
    ds_read_b64_tr_b16 v[82:83], v8 offset:37376
    s_mov_b32 s53, s25
    s_mov_b32 s54, 4194304
    s_mov_b32 s55, 0x20000
    s_mul_i32 s78, s3, 4608
    s_add_u32 s78, s78, 114688
    v_and_b32 v24, 31, v1
    v_mfma_f32_32x32x16_bf16 v[48:63], v[84:87], a[24:27], v[48:63]
    ds_read_b64_tr_b16 v[84:85], v9 offset:36864
    ds_read_b64_tr_b16 v[86:87], v9 offset:37376
    buffer_load_dwordx4 a[24:27], v10, s[36:39], s77 offen offset:2048 sc1
    v_mul_u32_u24 v24, 144, v24
    v_lshrrev_b32 v25, 5, v1
    v_lshl_add_u32 v24, v25, 3, v24
    v_add_u32 v24, s78, v24
    v_lshrrev_b32 v11, 3, v1
    v_mul_u32_u24 v25, 144, v11
    v_and_b32 v23, 7, v1
    v_lshl_add_u32 v25, v23, 4, v25
    s_waitcnt vmcnt(25) lgkmcnt(12)
    v_mfma_f32_32x32x16_bf16 v[32:47], v[88:91], a[28:31], v[32:47]
    ds_read_b64_tr_b16 v[88:89], v8 offset:38912
    ds_read_b64_tr_b16 v[90:91], v8 offset:39424
    v_add_u32 v25, s78, v25
    v_lshlrev_b32 v11, 11, v11
    v_lshl_add_u32 v11, v23, 4, v11
    v_mfma_f32_32x32x16_bf16 v[48:63], v[92:95], a[28:31], v[48:63]
    ds_read_b64_tr_b16 v[92:93], v9 offset:38912
    ds_read_b64_tr_b16 v[94:95], v9 offset:39424
    buffer_load_dwordx4 a[28:31], v10, s[36:39], s77 offen offset:3072 sc1
    s_add_u32 s77, s77, 4096
    s_waitcnt vmcnt(24) lgkmcnt(12)
    v_mfma_f32_32x32x16_bf16 v[32:47], v[64:67], a[32:35], v[32:47]
    ds_read_b64_tr_b16 v[64:65], v8 offset:40960
    ds_read_b64_tr_b16 v[66:67], v8 offset:41472
    v_mfma_f32_32x32x16_bf16 v[48:63], v[68:71], a[32:35], v[48:63]
    ds_read_b64_tr_b16 v[68:69], v9 offset:40960
    ds_read_b64_tr_b16 v[70:71], v9 offset:41472
    buffer_load_dwordx4 a[32:35], v10, s[36:39], s77 offen offset:0 sc1
    s_waitcnt vmcnt(24) lgkmcnt(12)
    v_mfma_f32_32x32x16_bf16 v[32:47], v[72:75], a[36:39], v[32:47]
    ds_read_b64_tr_b16 v[72:73], v8 offset:43008
    ds_read_b64_tr_b16 v[74:75], v8 offset:43520
    v_mfma_f32_32x32x16_bf16 v[48:63], v[76:79], a[36:39], v[48:63]
    ds_read_b64_tr_b16 v[76:77], v9 offset:43008
    ds_read_b64_tr_b16 v[78:79], v9 offset:43520
    buffer_load_dwordx4 a[36:39], v10, s[36:39], s77 offen offset:1024 sc1
    s_waitcnt vmcnt(23) lgkmcnt(12)
    v_mfma_f32_32x32x16_bf16 v[32:47], v[80:83], a[40:43], v[32:47]
    ds_read_b64_tr_b16 v[80:81], v8 offset:45056
    ds_read_b64_tr_b16 v[82:83], v8 offset:45568
    v_mfma_f32_32x32x16_bf16 v[48:63], v[84:87], a[40:43], v[48:63]
    ds_read_b64_tr_b16 v[84:85], v9 offset:45056
    ds_read_b64_tr_b16 v[86:87], v9 offset:45568
    buffer_load_dwordx4 a[40:43], v10, s[36:39], s77 offen offset:2048 sc1
    s_waitcnt vmcnt(23) lgkmcnt(12)
    v_mfma_f32_32x32x16_bf16 v[32:47], v[88:91], a[44:47], v[32:47]
    ds_read_b64_tr_b16 v[88:89], v8 offset:47104
    ds_read_b64_tr_b16 v[90:91], v8 offset:47616
    v_mfma_f32_32x32x16_bf16 v[48:63], v[92:95], a[44:47], v[48:63]
    ds_read_b64_tr_b16 v[92:93], v9 offset:47104
    ds_read_b64_tr_b16 v[94:95], v9 offset:47616
    buffer_load_dwordx4 a[44:47], v10, s[36:39], s77 offen offset:3072 sc1
    s_add_u32 s77, s77, 4096
    s_waitcnt vmcnt(22) lgkmcnt(12)
    v_mfma_f32_32x32x16_bf16 v[32:47], v[64:67], a[48:51], v[32:47]
    s_waitcnt vmcnt(26)
    s_barrier
    ds_read_b64_tr_b16 v[64:65], v8 offset:49152
    ds_read_b64_tr_b16 v[66:67], v8 offset:49664
    v_mfma_f32_32x32x16_bf16 v[48:63], v[68:71], a[48:51], v[48:63]
    ds_read_b64_tr_b16 v[68:69], v9 offset:49152
    ds_read_b64_tr_b16 v[70:71], v9 offset:49664
    buffer_load_dwordx4 a[48:51], v10, s[36:39], s77 offen offset:0 sc1
    s_waitcnt vmcnt(22) lgkmcnt(12)
    v_mfma_f32_32x32x16_bf16 v[32:47], v[72:75], a[52:55], v[32:47]
    ds_read_b64_tr_b16 v[72:73], v8 offset:51200
    ds_read_b64_tr_b16 v[74:75], v8 offset:51712
    s_waitcnt vmcnt(7)
    ds_write_b128 v21, v[128:131] offset:0
    ds_write_b128 v21, v[132:135] offset:1024
    v_mfma_f32_32x32x16_bf16 v[48:63], v[76:79], a[52:55], v[48:63]
    ds_read_b64_tr_b16 v[76:77], v9 offset:51200
    ds_read_b64_tr_b16 v[78:79], v9 offset:51712
    buffer_load_dwordx4 a[52:55], v10, s[36:39], s77 offen offset:1024 sc1
    ds_write_b128 v21, v[136:139] offset:2048
    s_waitcnt vmcnt(21) lgkmcnt(15)
    v_mfma_f32_32x32x16_bf16 v[32:47], v[80:83], a[56:59], v[32:47]
    ds_read_b64_tr_b16 v[80:81], v8 offset:53248
    ds_read_b64_tr_b16 v[82:83], v8 offset:53760
    ds_write_b128 v21, v[140:143] offset:3072
    v_mfma_f32_32x32x16_bf16 v[48:63], v[84:87], a[56:59], v[48:63]
    ds_read_b64_tr_b16 v[84:85], v9 offset:53248
    ds_read_b64_tr_b16 v[86:87], v9 offset:53760
    buffer_load_dwordx4 a[56:59], v10, s[36:39], s77 offen offset:2048 sc1
    s_waitcnt vmcnt(21) lgkmcnt(15)
    v_mfma_f32_32x32x16_bf16 v[32:47], v[88:91], a[60:63], v[32:47]
    ds_read_b64_tr_b16 v[88:89], v8 offset:55296
    ds_read_b64_tr_b16 v[90:91], v8 offset:55808
    v_mfma_f32_32x32x16_bf16 v[48:63], v[92:95], a[60:63], v[48:63]
    ds_read_b64_tr_b16 v[92:93], v9 offset:55296
    ds_read_b64_tr_b16 v[94:95], v9 offset:55808
    buffer_load_dwordx4 a[60:63], v10, s[36:39], s77 offen offset:3072 sc1
    s_add_u32 s77, s77, 4096
    s_waitcnt vmcnt(20) lgkmcnt(15)
    v_mfma_f32_32x32x16_bf16 v[32:47], v[64:67], a[0:3], v[32:47]
    ds_read_b64_tr_b16 v[64:65], v8 offset:57344
    ds_read_b64_tr_b16 v[66:67], v8 offset:57856
    v_mfma_f32_32x32x16_bf16 v[48:63], v[68:71], a[0:3], v[48:63]
    ds_read_b64_tr_b16 v[68:69], v9 offset:57344
    ds_read_b64_tr_b16 v[70:71], v9 offset:57856
    s_waitcnt vmcnt(19) lgkmcnt(14)
    v_mfma_f32_32x32x16_bf16 v[32:47], v[72:75], a[4:7], v[32:47]
    ds_read_b64_tr_b16 v[72:73], v8 offset:59392
    ds_read_b64_tr_b16 v[74:75], v8 offset:59904
    v_mfma_f32_32x32x16_bf16 v[48:63], v[76:79], a[4:7], v[48:63]
    ds_read_b64_tr_b16 v[76:77], v9 offset:59392
    ds_read_b64_tr_b16 v[78:79], v9 offset:59904
    s_waitcnt vmcnt(17) lgkmcnt(12)
    v_mfma_f32_32x32x16_bf16 v[32:47], v[80:83], a[8:11], v[32:47]
    ds_read_b64_tr_b16 v[80:81], v8 offset:61440
    ds_read_b64_tr_b16 v[82:83], v8 offset:61952
    v_mfma_f32_32x32x16_bf16 v[48:63], v[84:87], a[8:11], v[48:63]
    ds_read_b64_tr_b16 v[84:85], v9 offset:61440
    ds_read_b64_tr_b16 v[86:87], v9 offset:61952
    s_waitcnt vmcnt(16) lgkmcnt(12)
    v_mfma_f32_32x32x16_bf16 v[32:47], v[88:91], a[12:15], v[32:47]
    ds_read_b64_tr_b16 v[88:89], v8 offset:63488
    ds_read_b64_tr_b16 v[90:91], v8 offset:64000
    v_mfma_f32_32x32x16_bf16 v[48:63], v[92:95], a[12:15], v[48:63]
    ds_read_b64_tr_b16 v[92:93], v9 offset:63488
    ds_read_b64_tr_b16 v[94:95], v9 offset:64000
    s_waitcnt vmcnt(14) lgkmcnt(12)
    v_mfma_f32_32x32x16_bf16 v[32:47], v[64:67], a[16:19], v[32:47]
    s_waitcnt vmcnt(18) lgkmcnt(15)
    s_barrier
    ds_read_b64_tr_b16 v[64:65], v3 offset:0
    ds_read_b64_tr_b16 v[66:67], v3 offset:512
    ds_read_b64_tr_b16 v[144:145], v22 offset:0
    ds_read_b64_tr_b16 v[146:147], v22 offset:2048
    ds_read_b64_tr_b16 v[148:149], v22 offset:4096
    ds_read_b64_tr_b16 v[150:151], v22 offset:6144
    ds_read_b64_tr_b16 v[152:153], v22 offset:8192
    ds_read_b64_tr_b16 v[154:155], v22 offset:10240
    v_mfma_f32_32x32x16_bf16 v[48:63], v[68:71], a[16:19], v[48:63]
    ds_read_b64_tr_b16 v[68:69], v4 offset:0
    ds_read_b64_tr_b16 v[70:71], v4 offset:512
    ds_read_b64_tr_b16 v[156:157], v22 offset:12288
    ds_read_b64_tr_b16 v[158:159], v22 offset:14336
    s_waitcnt lgkmcnt(9)
    v_lshlrev_b32 v26, 16, v144
    v_lshlrev_b32 v164, 16, v145
    v_and_b32 v27, s18, v144
    v_and_b32 v165, s18, v145
    v_mul_f32 v224, v224, v26
    v_mul_f32 v226, v226, v164
    v_mul_f32 v225, v225, v27
    v_mul_f32 v227, v227, v165
    v_cvt_pk_bf16_f32 v224, v224, v225
    s_waitcnt vmcnt(11) lgkmcnt(15)
    v_mfma_f32_32x32x16_bf16 v[32:47], v[72:75], a[20:23], v[32:47]
    ds_read_b64_tr_b16 v[72:73], v3 offset:2048
    ds_read_b64_tr_b16 v[74:75], v3 offset:2560
    v_cvt_pk_bf16_f32 v226, v226, v227
    v_and_b32 v225, s18, v224
    v_and_b32 v227, s18, v226
    v_lshlrev_b32 v224, 16, v224
    v_lshlrev_b32 v226, 16, v226
    v_add_f32 v192, v192, v224
    v_add_f32 v194, v194, v226
    v_add_f32 v193, v193, v225
    v_mfma_f32_32x32x16_bf16 v[48:63], v[76:79], a[20:23], v[48:63]
    ds_read_b64_tr_b16 v[76:77], v4 offset:2048
    ds_read_b64_tr_b16 v[78:79], v4 offset:2560
    v_add_f32 v195, v195, v227
    v_cvt_pk_bf16_f32 v192, v192, v193
    v_cvt_pk_bf16_f32 v194, v194, v195
    v_and_b32 v193, s18, v192
    v_and_b32 v195, s18, v194
    v_lshlrev_b32 v192, 16, v192
    v_lshlrev_b32 v194, 16, v194
    s_waitcnt lgkmcnt(12)
    v_lshlrev_b32 v26, 16, v146
    v_lshlrev_b32 v164, 16, v147
    v_and_b32 v27, s18, v146
    v_and_b32 v165, s18, v147
    v_mul_f32 v228, v228, v26
    v_mul_f32 v230, v230, v164
    s_waitcnt vmcnt(9) lgkmcnt(15)
    v_mfma_f32_32x32x16_bf16 v[32:47], v[80:83], a[24:27], v[32:47]
    ds_read_b64_tr_b16 v[80:81], v3 offset:4096
    ds_read_b64_tr_b16 v[82:83], v3 offset:4608
    v_mul_f32 v229, v229, v27
    v_mul_f32 v231, v231, v165
    v_cvt_pk_bf16_f32 v228, v228, v229
    v_cvt_pk_bf16_f32 v230, v230, v231
    v_and_b32 v229, s18, v228
    v_and_b32 v231, s18, v230
    v_lshlrev_b32 v228, 16, v228
    v_lshlrev_b32 v230, 16, v230
    v_mfma_f32_32x32x16_bf16 v[48:63], v[84:87], a[24:27], v[48:63]
    ds_read_b64_tr_b16 v[84:85], v4 offset:4096
    ds_read_b64_tr_b16 v[86:87], v4 offset:4608
    v_add_f32 v196, v196, v228
    v_add_f32 v198, v198, v230
    v_add_f32 v197, v197, v229
    v_add_f32 v199, v199, v231
    v_cvt_pk_bf16_f32 v196, v196, v197
    v_cvt_pk_bf16_f32 v198, v198, v199
    v_and_b32 v197, s18, v196
    v_and_b32 v199, s18, v198
    v_lshlrev_b32 v196, 16, v196
    v_lshlrev_b32 v198, 16, v198
    s_waitcnt lgkmcnt(15)
    v_lshlrev_b32 v26, 16, v148
    v_lshlrev_b32 v164, 16, v149
    v_and_b32 v27, s18, v148
    s_waitcnt vmcnt(8) lgkmcnt(15)
    v_mfma_f32_32x32x16_bf16 v[32:47], v[88:91], a[28:31], v[32:47]
    ds_read_b64_tr_b16 v[88:89], v3 offset:6144
    ds_read_b64_tr_b16 v[90:91], v3 offset:6656
    v_and_b32 v165, s18, v149
    v_mul_f32 v232, v232, v26
    v_mul_f32 v234, v234, v164
    v_mul_f32 v233, v233, v27
    v_mul_f32 v235, v235, v165
    v_cvt_pk_bf16_f32 v232, v232, v233
    v_cvt_pk_bf16_f32 v234, v234, v235
    v_and_b32 v233, s18, v232
    v_mfma_f32_32x32x16_bf16 v[48:63], v[92:95], a[28:31], v[48:63]
    ds_read_b64_tr_b16 v[92:93], v4 offset:6144
    ds_read_b64_tr_b16 v[94:95], v4 offset:6656
    v_and_b32 v235, s18, v234
    v_lshlrev_b32 v232, 16, v232
    v_lshlrev_b32 v234, 16, v234
    v_add_f32 v200, v200, v232
    v_add_f32 v202, v202, v234
    v_add_f32 v201, v201, v233
    v_add_f32 v203, v203, v235
    v_cvt_pk_bf16_f32 v200, v200, v201
    v_cvt_pk_bf16_f32 v202, v202, v203
    v_and_b32 v201, s18, v200
    v_and_b32 v203, s18, v202
    v_lshlrev_b32 v200, 16, v200
    v_lshlrev_b32 v202, 16, v202
    s_waitcnt lgkmcnt(15)
    s_waitcnt vmcnt(7) lgkmcnt(14)
    v_mfma_f32_32x32x16_bf16 v[32:47], v[64:67], a[32:35], v[32:47]
    ds_read_b64_tr_b16 v[64:65], v3 offset:8192
    ds_read_b64_tr_b16 v[66:67], v3 offset:8704
    v_lshlrev_b32 v26, 16, v150
    v_lshlrev_b32 v164, 16, v151
    v_and_b32 v27, s18, v150
    v_and_b32 v165, s18, v151
    v_mul_f32 v236, v236, v26
    v_mul_f32 v238, v238, v164
    v_mul_f32 v237, v237, v27
    v_mul_f32 v239, v239, v165
    v_mfma_f32_32x32x16_bf16 v[48:63], v[68:71], a[32:35], v[48:63]
    ds_read_b64_tr_b16 v[68:69], v4 offset:8192
    ds_read_b64_tr_b16 v[70:71], v4 offset:8704
    v_cvt_pk_bf16_f32 v236, v236, v237
    v_cvt_pk_bf16_f32 v238, v238, v239
    v_and_b32 v237, s18, v236
    v_and_b32 v239, s18, v238
    v_lshlrev_b32 v236, 16, v236
    v_lshlrev_b32 v238, 16, v238
    v_add_f32 v204, v204, v236
    v_add_f32 v206, v206, v238
    v_add_f32 v205, v205, v237
    v_add_f32 v207, v207, v239
    v_cvt_pk_bf16_f32 v204, v204, v205
    v_cvt_pk_bf16_f32 v206, v206, v207
    v_and_b32 v205, s18, v204
    v_and_b32 v207, s18, v206
    s_waitcnt vmcnt(6) lgkmcnt(12)
    v_mfma_f32_32x32x16_bf16 v[32:47], v[72:75], a[36:39], v[32:47]
    ds_read_b64_tr_b16 v[72:73], v3 offset:10240
    ds_read_b64_tr_b16 v[74:75], v3 offset:10752
    v_lshlrev_b32 v204, 16, v204
    v_lshlrev_b32 v206, 16, v206
    s_waitcnt lgkmcnt(15)
    v_lshlrev_b32 v26, 16, v152
    v_lshlrev_b32 v164, 16, v153
    v_and_b32 v27, s18, v152
    v_and_b32 v165, s18, v153
    v_mul_f32 v240, v240, v26
    v_mfma_f32_32x32x16_bf16 v[48:63], v[76:79], a[36:39], v[48:63]
    ds_read_b64_tr_b16 v[76:77], v4 offset:10240
    ds_read_b64_tr_b16 v[78:79], v4 offset:10752
    v_mul_f32 v242, v242, v164
    v_mul_f32 v241, v241, v27
    v_mul_f32 v243, v243, v165
    v_cvt_pk_bf16_f32 v240, v240, v241
    v_cvt_pk_bf16_f32 v242, v242, v243
    v_and_b32 v241, s18, v240
    v_and_b32 v243, s18, v242
    v_lshlrev_b32 v240, 16, v240
    v_lshlrev_b32 v242, 16, v242
    v_add_f32 v208, v208, v240
    v_add_f32 v210, v210, v242
    v_add_f32 v209, v209, v241
    v_add_f32 v211, v211, v243
    v_cvt_pk_bf16_f32 v208, v208, v209
    s_waitcnt vmcnt(5) lgkmcnt(12)
    v_mfma_f32_32x32x16_bf16 v[32:47], v[80:83], a[40:43], v[32:47]
    ds_read_b64_tr_b16 v[80:81], v3 offset:12288
    ds_read_b64_tr_b16 v[82:83], v3 offset:12800
    v_cvt_pk_bf16_f32 v210, v210, v211
    v_and_b32 v209, s18, v208
    v_and_b32 v211, s18, v210
    v_lshlrev_b32 v208, 16, v208
    v_lshlrev_b32 v210, 16, v210
    s_waitcnt lgkmcnt(15)
    v_lshlrev_b32 v26, 16, v154
    v_lshlrev_b32 v164, 16, v155
    v_mfma_f32_32x32x16_bf16 v[48:63], v[84:87], a[40:43], v[48:63]
    ds_read_b64_tr_b16 v[84:85], v4 offset:12288
    ds_read_b64_tr_b16 v[86:87], v4 offset:12800
    v_and_b32 v27, s18, v154
    v_and_b32 v165, s18, v155
    v_mul_f32 v244, v244, v26
    v_mul_f32 v246, v246, v164
    v_mul_f32 v245, v245, v27
    v_mul_f32 v247, v247, v165
    v_cvt_pk_bf16_f32 v244, v244, v245
    v_cvt_pk_bf16_f32 v246, v246, v247
    v_and_b32 v245, s18, v244
    v_and_b32 v247, s18, v246
    v_lshlrev_b32 v244, 16, v244
    v_lshlrev_b32 v246, 16, v246
    v_add_f32 v212, v212, v244
    v_add_f32 v214, v214, v246
    s_waitcnt vmcnt(4) lgkmcnt(12)
    v_mfma_f32_32x32x16_bf16 v[32:47], v[88:91], a[44:47], v[32:47]
    ds_read_b64_tr_b16 v[88:89], v3 offset:14336
    ds_read_b64_tr_b16 v[90:91], v3 offset:14848
    v_add_f32 v213, v213, v245
    v_add_f32 v215, v215, v247
    v_cvt_pk_bf16_f32 v212, v212, v213
    v_cvt_pk_bf16_f32 v214, v214, v215
    v_and_b32 v213, s18, v212
    v_and_b32 v215, s18, v214
    v_lshlrev_b32 v212, 16, v212
    v_lshlrev_b32 v214, 16, v214
    v_mfma_f32_32x32x16_bf16 v[48:63], v[92:95], a[44:47], v[48:63]
    ds_read_b64_tr_b16 v[92:93], v4 offset:14336
    ds_read_b64_tr_b16 v[94:95], v4 offset:14848
    s_waitcnt lgkmcnt(15)
    v_lshlrev_b32 v26, 16, v156
    v_lshlrev_b32 v164, 16, v157
    v_and_b32 v27, s18, v156
    v_and_b32 v165, s18, v157
    v_mul_f32 v248, v248, v26
    v_mul_f32 v250, v250, v164
    v_mul_f32 v249, v249, v27
    v_mul_f32 v251, v251, v165
    v_cvt_pk_bf16_f32 v248, v248, v249
    v_cvt_pk_bf16_f32 v250, v250, v251
    v_and_b32 v249, s18, v248
    v_and_b32 v251, s18, v250
    v_lshlrev_b32 v248, 16, v248
    s_waitcnt vmcnt(3) lgkmcnt(12)
    v_mfma_f32_32x32x16_bf16 v[32:47], v[64:67], a[48:51], v[32:47]
    v_lshlrev_b32 v250, 16, v250
    v_add_f32 v216, v216, v248
    v_add_f32 v218, v218, v250
    v_add_f32 v217, v217, v249
    v_add_f32 v219, v219, v251
    v_cvt_pk_bf16_f32 v216, v216, v217
    v_cvt_pk_bf16_f32 v218, v218, v219
    v_and_b32 v217, s18, v216
    v_mfma_f32_32x32x16_bf16 v[48:63], v[68:71], a[48:51], v[48:63]
    v_and_b32 v219, s18, v218
    v_lshlrev_b32 v216, 16, v216
    v_lshlrev_b32 v218, 16, v218
    s_waitcnt lgkmcnt(15)
    v_lshlrev_b32 v26, 16, v158
    v_lshlrev_b32 v164, 16, v159
    v_and_b32 v27, s18, v158
    v_and_b32 v165, s18, v159
    v_mul_f32 v252, v252, v26
    v_mul_f32 v254, v254, v164
    v_mul_f32 v253, v253, v27
    v_mul_f32 v255, v255, v165
    v_cvt_pk_bf16_f32 v252, v252, v253
    v_cvt_pk_bf16_f32 v254, v254, v255
    s_waitcnt vmcnt(2) lgkmcnt(8)
    v_mfma_f32_32x32x16_bf16 v[32:47], v[72:75], a[52:55], v[32:47]
    v_and_b32 v253, s18, v252
    v_and_b32 v255, s18, v254
    v_lshlrev_b32 v252, 16, v252
    v_lshlrev_b32 v254, 16, v254
    v_add_f32 v220, v220, v252
    v_add_f32 v222, v222, v254
    v_add_f32 v221, v221, v253
    v_add_f32 v223, v223, v255
    v_mfma_f32_32x32x16_bf16 v[48:63], v[76:79], a[52:55], v[48:63]
    v_cvt_pk_bf16_f32 v220, v220, v221
    v_cvt_pk_bf16_f32 v222, v222, v223
    v_and_b32 v221, s18, v220
    v_and_b32 v223, s18, v222
    v_lshlrev_b32 v220, 16, v220
    v_lshlrev_b32 v222, 16, v222
    s_waitcnt vmcnt(1) lgkmcnt(4)
    v_mfma_f32_32x32x16_bf16 v[32:47], v[80:83], a[56:59], v[32:47]
    v_mfma_f32_32x32x16_bf16 v[48:63], v[84:87], a[56:59], v[48:63]
    s_waitcnt vmcnt(0) lgkmcnt(0)
    v_mfma_f32_32x32x16_bf16 v[32:47], v[88:91], a[60:63], v[32:47]
    v_mfma_f32_32x32x16_bf16 v[48:63], v[92:95], a[60:63], v[48:63]
    s_nop 7
    s_nop 3
    v_cvt_pk_bf16_f32 v32, v32, v33
    v_and_b32 v33, s18, v32
    v_lshlrev_b32 v32, 16, v32
    v_pk_add_f32 v[32:33], v[32:33], v[192:193]
    v_cvt_pk_bf16_f32 v224, v32, v33
    v_cvt_pk_bf16_f32 v34, v34, v35
    v_and_b32 v35, s18, v34
    v_lshlrev_b32 v34, 16, v34
    v_pk_add_f32 v[34:35], v[34:35], v[194:195]
    v_cvt_pk_bf16_f32 v225, v34, v35
    ds_write_b64 v24, v[224:225] offset:0
    v_cvt_pk_bf16_f32 v36, v36, v37
    v_and_b32 v37, s18, v36
    v_lshlrev_b32 v36, 16, v36
    v_pk_add_f32 v[36:37], v[36:37], v[196:197]
    v_cvt_pk_bf16_f32 v226, v36, v37
    v_cvt_pk_bf16_f32 v38, v38, v39
    v_and_b32 v39, s18, v38
    v_lshlrev_b32 v38, 16, v38
    v_pk_add_f32 v[38:39], v[38:39], v[198:199]
    v_cvt_pk_bf16_f32 v227, v38, v39
    ds_write_b64 v24, v[226:227] offset:16
    v_cvt_pk_bf16_f32 v40, v40, v41
    v_and_b32 v41, s18, v40
    v_lshlrev_b32 v40, 16, v40
    v_pk_add_f32 v[40:41], v[40:41], v[200:201]
    v_cvt_pk_bf16_f32 v228, v40, v41
    v_cvt_pk_bf16_f32 v42, v42, v43
    v_and_b32 v43, s18, v42
    v_lshlrev_b32 v42, 16, v42
    v_pk_add_f32 v[42:43], v[42:43], v[202:203]
    v_cvt_pk_bf16_f32 v229, v42, v43
    ds_write_b64 v24, v[228:229] offset:32
    v_cvt_pk_bf16_f32 v44, v44, v45
    v_and_b32 v45, s18, v44
    v_lshlrev_b32 v44, 16, v44
    v_pk_add_f32 v[44:45], v[44:45], v[204:205]
    v_cvt_pk_bf16_f32 v230, v44, v45
    v_cvt_pk_bf16_f32 v46, v46, v47
    v_and_b32 v47, s18, v46
    v_lshlrev_b32 v46, 16, v46
    v_pk_add_f32 v[46:47], v[46:47], v[206:207]
    v_cvt_pk_bf16_f32 v231, v46, v47
    ds_write_b64 v24, v[230:231] offset:48
    v_cvt_pk_bf16_f32 v48, v48, v49
    v_and_b32 v49, s18, v48
    v_lshlrev_b32 v48, 16, v48
    v_pk_add_f32 v[48:49], v[48:49], v[208:209]
    v_cvt_pk_bf16_f32 v232, v48, v49
    v_cvt_pk_bf16_f32 v50, v50, v51
    v_and_b32 v51, s18, v50
    v_lshlrev_b32 v50, 16, v50
    v_pk_add_f32 v[50:51], v[50:51], v[210:211]
    v_cvt_pk_bf16_f32 v233, v50, v51
    ds_write_b64 v24, v[232:233] offset:64
    v_cvt_pk_bf16_f32 v52, v52, v53
    v_and_b32 v53, s18, v52
    v_lshlrev_b32 v52, 16, v52
    v_pk_add_f32 v[52:53], v[52:53], v[212:213]
    v_cvt_pk_bf16_f32 v234, v52, v53
    v_cvt_pk_bf16_f32 v54, v54, v55
    v_and_b32 v55, s18, v54
    v_lshlrev_b32 v54, 16, v54
    v_pk_add_f32 v[54:55], v[54:55], v[214:215]
    v_cvt_pk_bf16_f32 v235, v54, v55
    ds_write_b64 v24, v[234:235] offset:80
    v_cvt_pk_bf16_f32 v56, v56, v57
    v_and_b32 v57, s18, v56
    v_lshlrev_b32 v56, 16, v56
    v_pk_add_f32 v[56:57], v[56:57], v[216:217]
    v_cvt_pk_bf16_f32 v236, v56, v57
    v_cvt_pk_bf16_f32 v58, v58, v59
    v_and_b32 v59, s18, v58
    v_lshlrev_b32 v58, 16, v58
    v_pk_add_f32 v[58:59], v[58:59], v[218:219]
    v_cvt_pk_bf16_f32 v237, v58, v59
    ds_write_b64 v24, v[236:237] offset:96
    v_cvt_pk_bf16_f32 v60, v60, v61
    v_and_b32 v61, s18, v60
    v_lshlrev_b32 v60, 16, v60
    v_pk_add_f32 v[60:61], v[60:61], v[220:221]
    v_cvt_pk_bf16_f32 v238, v60, v61
    v_cvt_pk_bf16_f32 v62, v62, v63
    v_and_b32 v63, s18, v62
    v_lshlrev_b32 v62, 16, v62
    v_pk_add_f32 v[62:63], v[62:63], v[222:223]
    v_cvt_pk_bf16_f32 v239, v62, v63
    ds_write_b64 v24, v[238:239] offset:112
    ds_read_b128 v[128:131], v25 offset:0
    ds_read_b128 v[132:135], v25 offset:1152
    ds_read_b128 v[136:139], v25 offset:2304
    ds_read_b128 v[140:143], v25 offset:3456
    s_waitcnt lgkmcnt(3)
    buffer_store_dwordx4 v[128:131], v11, s[52:55], s16 offen
    s_add_u32 s16, s16, 16384
    s_waitcnt lgkmcnt(2)
    buffer_store_dwordx4 v[132:135], v11, s[52:55], s16 offen
    s_add_u32 s16, s16, 16384
    s_waitcnt lgkmcnt(1)
    buffer_store_dwordx4 v[136:139], v11, s[52:55], s16 offen
    s_add_u32 s16, s16, 16384
    s_waitcnt lgkmcnt(0)
    buffer_store_dwordx4 v[140:143], v11, s[52:55], s16 offen
    s_add_u32 s16, s16, 16384
k_end:
    s_endpgm
k_last:
.set CODE_LAST, k_last-parallel_sum__ssm_conv_h3__glu_gated_glu__prompt_kernel-4
.set CODE_WAVES, (k_last-parallel_sum__ssm_conv_h3__glu_gated_glu__prompt_kernel+8191)/8192
.section .rodata,"a"
.p2align 6
.amdhsa_kernel parallel_sum__ssm_conv_h3__glu_gated_glu__prompt_kernel
  .amdhsa_next_free_vgpr 496
  .amdhsa_next_free_sgpr 102
  .amdhsa_accum_offset 256
  .amdhsa_group_segment_fixed_size 0
  .amdhsa_kernarg_size 104
  .amdhsa_user_sgpr_count 2
  .amdhsa_user_sgpr_kernarg_segment_ptr 1
  .amdhsa_system_sgpr_workgroup_id_x 1
.end_amdhsa_kernel
```
